```python
import torch

def _softmax(x, axis=-1):
    return torch.softmax(x, dim=axis)
def _gelu(x):
    return torch.nn.functional.gelu(x, approximate="tanh")
def _silu(x):
    return torch.nn.functional.silu(x)
def _sigmoid(x):
    return torch.sigmoid(x)
def _layernorm(x, axis=-1, eps=1e-5):
    m = x.mean(dim=axis, keepdim=True)
    v = x.var(dim=axis, keepdim=True, unbiased=False)
    return (x - m) / torch.sqrt(v + eps)
def _scatter_add(tgt, idx, src, axis=0):
    return tgt.clone().index_add_(axis, idx, src)
def _segment_sum(src, seg, n):
    out = torch.zeros((n,) + src.shape[1:], dtype=src.dtype)
    return out.index_add_(0, seg, src)
def _pad(x, pw):
    flat = tuple(v for pair in reversed(pw) for v in pair)
    return torch.nn.functional.pad(x, flat)

kernel_name = 'standalone__gqa_softmax__near_ridge'

def setup_inputs():

    _w = (lambda a: (lambda t: t.to(torch.bfloat16) if t.is_floating_point() else t)(torch.as_tensor(a)))
    B, Hq, Hkv, Sq, Sk, D = 8, 32, 32, 384, 1024, 192
    return {
        "q": _w((lambda *s: torch.randn(*s, dtype=torch.bfloat16) * 0.8)(B, Hq, Sq, D)),
        "k": _w((lambda *s: torch.randn(*s, dtype=torch.bfloat16) * 0.8)(B, Hkv, Sk, D)),
        "v": _w((lambda *s: torch.randn(*s, dtype=torch.bfloat16) * 0.05)(B, Hkv, Sk, D)),
    }

def reference(q, k, v):
    B, Hq, Sq, D = q.shape
    Hkv = k.shape[1]
    rep = Hq // Hkv
    k = (lambda x, n, axis: torch.repeat_interleave(x, n, dim=axis))(k, rep, axis=1)
    v = (lambda x, n, axis: torch.repeat_interleave(x, n, dim=axis))(v, rep, axis=1)
    scale = D ** -0.5
    scores = torch.einsum("bhqd,bhkd->bhqk", q, k) * scale
    p = _softmax(scores, axis=-1)
    return torch.einsum("bhqk,bhkd->bhqd", p, v)
```

```asm
; @launch grid=(256,1,1) block=(256,1,1) lds=163840
.amdgcn_target "amdgcn-amd-amdhsa--gfx950"
.text
.globl standalone__gqa_softmax__near_ridge_kernel
.p2align 8
.type standalone__gqa_softmax__near_ridge_kernel,@function
standalone__gqa_softmax__near_ridge_kernel:
    s_load_dwordx8 s[4:11], s[0:1], 0
    s_cmp_ge_u32 s2, 256
    s_cbranch_scc1 L_end
    s_getpc_b64 s[28:29]
L_pc:
    s_and_b32 s29, s29, 0xffff
    s_mov_b32 s30, L_slow-L_pc
    s_mov_b32 s31, 0x20000
    v_lshlrev_b32 v10, 7, v0
    buffer_load_dword v11, v10, s[28:31], 0 offen
    s_getreg_b32 s48, hwreg(HW_REG_XCC_ID, 0, 1)
    s_mov_b32 s49, 0
    s_mov_b64 vcc, s[48:49]
    v_lshrrev_b32 v1, 6, v0
    v_and_b32 v3, 63, v0
    v_readfirstlane_b32 s3, v1
    v_lshlrev_b32 v3, 4, v3
    s_mul_i32 s37, s2, 147456
    s_mul_i32 s40, s2, 393216
    s_mul_i32 s34, s3, 3072
    s_mul_i32 s35, s3, 3104
    s_mul_i32 s53, s3, 36864
    s_add_u32 m0, s35, 50304
    s_mov_b32 s18, 393216
    s_mov_b32 s19, 0x20000
    s_mov_b32 s14, 147456
    s_mov_b32 s15, 0x20000
    s_waitcnt lgkmcnt(0)
    s_add_u32 s16, s6, s40
    s_addc_u32 s17, s7, 0
    s_and_b32 s17, s17, 0xffff
    buffer_load_dwordx4 v3, s[16:19], s34 offen offset:0 nt lds
    buffer_load_dwordx4 v3, s[16:19], s34 offen offset:1024 nt lds
    buffer_load_dwordx4 v3, s[16:19], s34 offen offset:2048 nt lds
    s_add_u32 s12, s4, s37
    s_addc_u32 s13, s5, 0
    s_and_b32 s13, s13, 0xffff
    s_cbranch_vccnz L_thr0
    s_waitcnt vmcnt(2)
L_thr0:
    s_add_u32 m0, s35, 62880
    s_add_u32 s39, s53, 0
    buffer_load_dwordx4 v3, s[12:15], s39 offen offset:0 nt lds
    buffer_load_dwordx4 v3, s[12:15], s39 offen offset:1024 nt lds
    buffer_load_dwordx4 v3, s[12:15], s39 offen offset:2048 nt lds
    s_cbranch_vccnz L_thr3
    s_waitcnt vmcnt(2)
L_thr3:
    s_add_u32 m0, s35, 75456
    s_add_u32 s39, s53, 3072
    buffer_load_dwordx4 v3, s[12:15], s39 offen offset:0 nt lds
    buffer_load_dwordx4 v3, s[12:15], s39 offen offset:1024 nt lds
    buffer_load_dwordx4 v3, s[12:15], s39 offen offset:2048 nt lds
    s_cbranch_vccnz L_thr6
    s_waitcnt vmcnt(2)
L_thr6:
    s_add_u32 m0, s35, 88032
    s_add_u32 s39, s53, 6144
    buffer_load_dwordx4 v3, s[12:15], s39 offen offset:0 nt lds
    buffer_load_dwordx4 v3, s[12:15], s39 offen offset:1024 nt lds
    buffer_load_dwordx4 v3, s[12:15], s39 offen offset:2048 nt lds
    s_cbranch_vccnz L_thr9
    s_waitcnt vmcnt(2)
L_thr9:
    s_add_u32 m0, s35, 100608
    s_add_u32 s39, s53, 9216
    buffer_load_dwordx4 v3, s[12:15], s39 offen offset:0 nt lds
    buffer_load_dwordx4 v3, s[12:15], s39 offen offset:1024 nt lds
    buffer_load_dwordx4 v3, s[12:15], s39 offen offset:2048 nt lds
    s_mov_b32 s22, 393216
    s_mov_b32 s23, 0x20000
    s_mov_b32 s26, 147456
    s_mov_b32 s27, 0x20000
    s_add_u32 s20, s8, s40
    s_addc_u32 s21, s9, 0
    s_and_b32 s21, s21, 0xffff
    s_add_u32 s24, s10, s37
    s_addc_u32 s25, s11, 0
    s_and_b32 s25, s25, 0xffff
    s_mov_b32 s32, 0x3dd53b95
    s_mov_b32 s33, 0xffff0000
    s_mov_b32 s41, 0x51800000
    s_mov_b32 s42, 0x33800000
    s_mov_b32 s54, 0x3f800000
    s_mov_b32 s43, 25152
    s_mov_b32 s44, 0xfffe14c0
    s_add_u32 s45, s35, 125760
    s_add_u32 s52, s35, 50304
    s_add_u32 s47, s34, 73728
    s_mul_i32 s46, s3, 15808
    s_add_u32 s46, s46, 100608
    s_mov_b32 s38, 50304
    s_mov_b32 s36, 3
    s_mov_b32 s79, 0x3e800000
    s_add_u32 s72, s53, 0
    s_add_u32 s73, s53, 6144
    s_add_u32 s74, s53, 12288
    s_add_u32 s75, s53, 18432
    s_add_u32 s76, s53, 24576
    s_add_u32 s77, s53, 30720
    s_mov_b32 s40, 384
    s_waitcnt vmcnt(15)
    v_mbcnt_lo_u32_b32 v0, -1, 0
    v_mbcnt_hi_u32_b32 v0, -1, v0
    v_and_b32 v10, 3, v0
    v_mul_u32_u24 v1, 3104, v10
    v_lshlrev_b32 v2, 3, v10
    v_bfe_u32 v10, v0, 2, 2
    v_mul_u32_u24 v11, 384, v10
    v_add_u32 v1, v1, v11
    v_mul_u32_u24 v11, 3104, v10
    v_add_u32 v2, v2, v11
    v_lshrrev_b32 v10, 4, v0
    v_lshl_add_u32 v1, v10, 4, v1
    v_mul_u32_u24 v11, 384, v10
    v_add_u32 v2, v2, v11
    v_add_u32 v1, 50304, v1
    v_add_u32 v2, 62880, v2
    v_bfe_u32 v10, v0, 3, 1
    v_mul_u32_u24 v10, 12576, v10
    v_and_b32 v11, 7, v0
    v_mul_u32_u24 v11, 384, v11
    v_add_u32 v10, v10, v11
    v_lshrrev_b32 v11, 4, v0
    v_lshl_add_u32 v10, v11, 4, v10
    s_add_u32 s37, s35, 62880
    v_add_u32 v0, s37, v10
    v_lshrrev_b32 v10, 4, v3
    v_and_b32 v172, 1, v10
    v_mul_u32_u24 v172, 0xaaaa, v172
    v_add_u32 v172, 0x4444, v172
    v_lshrrev_b32 v11, 4, v10
    v_xor_b32 v10, v10, v11
    v_bfe_i32 v10, v10, 1, 1
    v_not_b32 v10, v10
    v_and_b32 v12, 0x3f803f80, v10
    v_and_b32 v13, 0x3f803f80, v10
    v_and_b32 v14, 0x3f803f80, v10
    v_and_b32 v15, 0x3f803f80, v10
    v_mov_b32 v4, 0
    v_mov_b32 v5, 0
    v_mov_b32 v6, 0
    v_mov_b32 v7, 0
    v_mov_b32 v8, 0
    v_mov_b32 v9, 0
    v_mov_b32 v10, 0
    v_mov_b32 v11, 0
    v_mov_b32 v76, 0
    v_mov_b32 v77, 0
    v_mov_b32 v78, 0
    v_mov_b32 v79, 0
    s_waitcnt vmcnt(12)
    s_barrier
    ds_read_b128 v[80:83], v1 offset:0
    ds_read_b128 v[84:87], v1 offset:64
    ds_read_b128 v[88:91], v1 offset:128
    ds_read_b128 v[92:95], v1 offset:192
    ds_read_b128 v[96:99], v1 offset:256
    ds_read_b128 v[100:103], v1 offset:320
    ds_read_b128 v[104:107], v1 offset:1536
    ds_read_b128 v[108:111], v1 offset:1600
    ds_read_b128 v[112:115], v1 offset:1664
    ds_read_b128 v[116:119], v1 offset:1728
    ds_read_b128 v[120:123], v1 offset:1792
    ds_read_b128 v[124:127], v1 offset:1856
    s_waitcnt vmcnt(6)
    s_waitcnt lgkmcnt(0)
    ds_read_b128 v[128:131], v0 offset:0
    ds_read_b128 v[132:135], v0 offset:64
    ds_read_b128 v[136:139], v0 offset:128
    ds_read_b128 v[140:143], v0 offset:192
    ds_read_b128 v[144:147], v0 offset:256
    ds_read_b128 v[148:151], v0 offset:320
    v_add_u32 v0, 0x6240, v0
    s_waitcnt lgkmcnt(5)
    s_cbranch_vccnz L_thr12
    s_waitcnt vmcnt(2)
L_thr12:
    s_add_u32 m0, s35, 113184
    s_add_u32 s39, s53, 12288
    buffer_load_dwordx4 v3, s[12:15], s39 offen offset:0 nt lds
    v_lshlrev_b32 v152, 16, v128
    v_and_b32 v153, s33, v128
    v_mul_f32 v152, s32, v152
    v_mul_f32 v153, s32, v153
    v_lshlrev_b32 v154, 16, v129
    v_and_b32 v155, s33, v129
    v_mul_f32 v154, s32, v154
    v_mul_f32 v155, s32, v155
    v_lshlrev_b32 v156, 16, v130
    v_and_b32 v157, s33, v130
    v_mul_f32 v156, s32, v156
    v_mul_f32 v157, s32, v157
    v_lshlrev_b32 v158, 16, v131
    v_and_b32 v159, s33, v131
    v_mul_f32 v158, s32, v158
    v_mul_f32 v159, s32, v159
    v_cvt_pk_bf16_f32 v152, v152, v153
    v_cvt_pk_bf16_f32 v154, v154, v155
    v_cvt_pk_bf16_f32 v156, v156, v157
    v_cvt_pk_bf16_f32 v158, v158, v159
    v_accvgpr_write_b32 a0, v152
    v_accvgpr_write_b32 a1, v154
    v_accvgpr_write_b32 a2, v156
    v_accvgpr_write_b32 a3, v158
    s_waitcnt lgkmcnt(4)
    buffer_load_dwordx4 v3, s[12:15], s39 offen offset:1024 nt lds
    v_lshlrev_b32 v152, 16, v132
    v_and_b32 v153, s33, v132
    v_mul_f32 v152, s32, v152
    v_mul_f32 v153, s32, v153
    v_mfma_f32_16x16x32_bf16 v[16:19], v[80:83], a[0:3], -4.0
    v_lshlrev_b32 v154, 16, v133
    v_and_b32 v155, s33, v133
    v_mul_f32 v154, s32, v154
    v_mul_f32 v155, s32, v155
    v_mfma_f32_16x16x32_bf16 v[160:163], v[104:107], a[0:3], -4.0
    v_lshlrev_b32 v156, 16, v134
    v_and_b32 v157, s33, v134
    v_mul_f32 v156, s32, v156
    v_mul_f32 v157, s32, v157
    v_lshlrev_b32 v158, 16, v135
    v_and_b32 v159, s33, v135
    v_mul_f32 v158, s32, v158
    v_mul_f32 v159, s32, v159
    v_cvt_pk_bf16_f32 v152, v152, v153
    v_cvt_pk_bf16_f32 v154, v154, v155
    v_cvt_pk_bf16_f32 v156, v156, v157
    v_cvt_pk_bf16_f32 v158, v158, v159
    v_accvgpr_write_b32 a4, v152
    v_accvgpr_write_b32 a5, v154
    v_accvgpr_write_b32 a6, v156
    v_accvgpr_write_b32 a7, v158
    s_waitcnt lgkmcnt(3)
    buffer_load_dwordx4 v3, s[12:15], s39 offen offset:2048 nt lds
    v_lshlrev_b32 v152, 16, v136
    v_and_b32 v153, s33, v136
    v_mul_f32 v152, s32, v152
    v_mul_f32 v153, s32, v153
    v_mfma_f32_16x16x32_bf16 v[16:19], v[84:87], a[4:7], v[16:19]
    v_lshlrev_b32 v154, 16, v137
    v_and_b32 v155, s33, v137
    v_mul_f32 v154, s32, v154
    v_mul_f32 v155, s32, v155
    v_mfma_f32_16x16x32_bf16 v[160:163], v[108:111], a[4:7], v[160:163]
    v_lshlrev_b32 v156, 16, v138
    v_and_b32 v157, s33, v138
    v_mul_f32 v156, s32, v156
    v_mul_f32 v157, s32, v157
    v_lshlrev_b32 v158, 16, v139
    v_and_b32 v159, s33, v139
    v_mul_f32 v158, s32, v158
    v_mul_f32 v159, s32, v159
    v_cvt_pk_bf16_f32 v152, v152, v153
    v_cvt_pk_bf16_f32 v154, v154, v155
    v_cvt_pk_bf16_f32 v156, v156, v157
    v_cvt_pk_bf16_f32 v158, v158, v159
    v_accvgpr_write_b32 a8, v152
    v_accvgpr_write_b32 a9, v154
    v_accvgpr_write_b32 a10, v156
    v_accvgpr_write_b32 a11, v158
    s_waitcnt lgkmcnt(2)
    s_cbranch_vccnz L_thr15
    s_waitcnt vmcnt(2)
L_thr15:
    s_add_u32 m0, s35, 125760
    s_add_u32 s39, s53, 15360
    buffer_load_dwordx4 v3, s[12:15], s39 offen offset:0 nt lds
    v_lshlrev_b32 v152, 16, v140
    v_and_b32 v153, s33, v140
    v_mul_f32 v152, s32, v152
    v_mul_f32 v153, s32, v153
    v_mfma_f32_16x16x32_bf16 v[16:19], v[88:91], a[8:11], v[16:19]
    v_lshlrev_b32 v154, 16, v141
    v_and_b32 v155, s33, v141
    v_mul_f32 v154, s32, v154
    v_mul_f32 v155, s32, v155
    v_mfma_f32_16x16x32_bf16 v[160:163], v[112:115], a[8:11], v[160:163]
    v_lshlrev_b32 v156, 16, v142
    v_and_b32 v157, s33, v142
    v_mul_f32 v156, s32, v156
    v_mul_f32 v157, s32, v157
    v_lshlrev_b32 v158, 16, v143
    v_and_b32 v159, s33, v143
    v_mul_f32 v158, s32, v158
    v_mul_f32 v159, s32, v159
    v_cvt_pk_bf16_f32 v152, v152, v153
    v_cvt_pk_bf16_f32 v154, v154, v155
    v_cvt_pk_bf16_f32 v156, v156, v157
    v_cvt_pk_bf16_f32 v158, v158, v159
    v_accvgpr_write_b32 a12, v152
    v_accvgpr_write_b32 a13, v154
    v_accvgpr_write_b32 a14, v156
    v_accvgpr_write_b32 a15, v158
    s_waitcnt lgkmcnt(1)
    buffer_load_dwordx4 v3, s[12:15], s39 offen offset:1024 nt lds
    v_lshlrev_b32 v152, 16, v144
    v_and_b32 v153, s33, v144
    v_mul_f32 v152, s32, v152
    v_mul_f32 v153, s32, v153
    v_mfma_f32_16x16x32_bf16 v[16:19], v[92:95], a[12:15], v[16:19]
    v_lshlrev_b32 v154, 16, v145
    v_and_b32 v155, s33, v145
    v_mul_f32 v154, s32, v154
    v_mul_f32 v155, s32, v155
    v_mfma_f32_16x16x32_bf16 v[160:163], v[116:119], a[12:15], v[160:163]
    v_lshlrev_b32 v156, 16, v146
    v_and_b32 v157, s33, v146
    v_mul_f32 v156, s32, v156
    v_mul_f32 v157, s32, v157
    v_lshlrev_b32 v158, 16, v147
    v_and_b32 v159, s33, v147
    v_mul_f32 v158, s32, v158
    v_mul_f32 v159, s32, v159
    v_cvt_pk_bf16_f32 v152, v152, v153
    v_cvt_pk_bf16_f32 v154, v154, v155
    v_cvt_pk_bf16_f32 v156, v156, v157
    v_cvt_pk_bf16_f32 v158, v158, v159
    v_accvgpr_write_b32 a16, v152
    v_accvgpr_write_b32 a17, v154
    v_accvgpr_write_b32 a18, v156
    v_accvgpr_write_b32 a19, v158
    s_waitcnt lgkmcnt(0)
    buffer_load_dwordx4 v3, s[12:15], s39 offen offset:2048 nt lds
    v_lshlrev_b32 v152, 16, v148
    v_and_b32 v153, s33, v148
    v_mul_f32 v152, s32, v152
    v_mul_f32 v153, s32, v153
    v_mfma_f32_16x16x32_bf16 v[16:19], v[96:99], a[16:19], v[16:19]
    v_lshlrev_b32 v154, 16, v149
    v_and_b32 v155, s33, v149
    v_mul_f32 v154, s32, v154
    v_mul_f32 v155, s32, v155
    v_mfma_f32_16x16x32_bf16 v[160:163], v[120:123], a[16:19], v[160:163]
    v_lshlrev_b32 v156, 16, v150
    v_and_b32 v157, s33, v150
    v_mul_f32 v156, s32, v156
    v_mul_f32 v157, s32, v157
    v_lshlrev_b32 v158, 16, v151
    v_and_b32 v159, s33, v151
    v_mul_f32 v158, s32, v158
    v_mul_f32 v159, s32, v159
    v_cvt_pk_bf16_f32 v152, v152, v153
    v_cvt_pk_bf16_f32 v154, v154, v155
    v_cvt_pk_bf16_f32 v156, v156, v157
    v_cvt_pk_bf16_f32 v158, v158, v159
    v_accvgpr_write_b32 a20, v152
    v_accvgpr_write_b32 a21, v154
    v_accvgpr_write_b32 a22, v156
    v_accvgpr_write_b32 a23, v158
    s_nop 1
    v_mfma_f32_16x16x32_bf16 v[16:19], v[100:103], a[20:23], v[16:19]
    v_mfma_f32_16x16x32_bf16 v[160:163], v[124:127], a[20:23], v[160:163]
    s_nop 6
    v_exp_f32 v16, v16
    v_exp_f32 v17, v17
    v_exp_f32 v18, v18
    v_exp_f32 v19, v19
    v_exp_f32 v160, v160
    v_exp_f32 v161, v161
    v_exp_f32 v162, v162
    v_exp_f32 v163, v163
    v_cvt_pk_bf16_f32 v16, v16, v17
    v_cvt_pk_bf16_f32 v17, v18, v19
    v_cvt_pk_bf16_f32 v18, v160, v161
    v_cvt_pk_bf16_f32 v19, v162, v163
    s_waitcnt vmcnt(6)
    ds_read_b128 v[128:131], v0 offset:0
    ds_read_b128 v[132:135], v0 offset:64
    ds_read_b128 v[136:139], v0 offset:128
    ds_read_b128 v[140:143], v0 offset:192
    ds_read_b128 v[144:147], v0 offset:256
    ds_read_b128 v[148:151], v0 offset:320
    v_add_u32 v0, 0x6240, v0
    s_waitcnt lgkmcnt(5)
    s_add_u32 m0, s35, 138336
    s_add_u32 s39, s53, 18432
    buffer_load_dwordx4 v3, s[12:15], s39 offen offset:0 nt lds
    v_lshlrev_b32 v152, 16, v128
    v_and_b32 v153, s33, v128
    v_mul_f32 v152, s32, v152
    v_mul_f32 v153, s32, v153
    v_lshlrev_b32 v154, 16, v129
    v_and_b32 v155, s33, v129
    v_mul_f32 v154, s32, v154
    v_mul_f32 v155, s32, v155
    v_lshlrev_b32 v156, 16, v130
    v_and_b32 v157, s33, v130
    v_mul_f32 v156, s32, v156
    v_mul_f32 v157, s32, v157
    v_lshlrev_b32 v158, 16, v131
    v_and_b32 v159, s33, v131
    v_mul_f32 v158, s32, v158
    v_mul_f32 v159, s32, v159
    v_cvt_pk_bf16_f32 v152, v152, v153
    v_cvt_pk_bf16_f32 v154, v154, v155
    v_cvt_pk_bf16_f32 v156, v156, v157
    v_cvt_pk_bf16_f32 v158, v158, v159
    v_accvgpr_write_b32 a24, v152
    v_accvgpr_write_b32 a25, v154
    v_accvgpr_write_b32 a26, v156
    v_accvgpr_write_b32 a27, v158
    s_waitcnt lgkmcnt(4)
    buffer_load_dwordx4 v3, s[12:15], s39 offen offset:1024 nt lds
    v_lshlrev_b32 v152, 16, v132
    v_and_b32 v153, s33, v132
    v_mul_f32 v152, s32, v152
    v_mul_f32 v153, s32, v153
    v_mfma_f32_16x16x32_bf16 v[20:23], v[80:83], a[24:27], -4.0
    v_lshlrev_b32 v154, 16, v133
    v_and_b32 v155, s33, v133
    v_mul_f32 v154, s32, v154
    v_mul_f32 v155, s32, v155
    v_mfma_f32_16x16x32_bf16 v[160:163], v[104:107], a[24:27], -4.0
    v_lshlrev_b32 v156, 16, v134
    v_and_b32 v157, s33, v134
    v_mul_f32 v156, s32, v156
    v_mul_f32 v157, s32, v157
    v_lshlrev_b32 v158, 16, v135
    v_and_b32 v159, s33, v135
    v_mul_f32 v158, s32, v158
    v_mul_f32 v159, s32, v159
    v_cvt_pk_bf16_f32 v152, v152, v153
    v_cvt_pk_bf16_f32 v154, v154, v155
    v_cvt_pk_bf16_f32 v156, v156, v157
    v_cvt_pk_bf16_f32 v158, v158, v159
    v_accvgpr_write_b32 a28, v152
    v_accvgpr_write_b32 a29, v154
    v_accvgpr_write_b32 a30, v156
    v_accvgpr_write_b32 a31, v158
    s_waitcnt lgkmcnt(3)
    buffer_load_dwordx4 v3, s[12:15], s39 offen offset:2048 nt lds
    v_lshlrev_b32 v152, 16, v136
    v_and_b32 v153, s33, v136
    v_mul_f32 v152, s32, v152
    v_mul_f32 v153, s32, v153
    v_mfma_f32_16x16x32_bf16 v[20:23], v[84:87], a[28:31], v[20:23]
    v_lshlrev_b32 v154, 16, v137
    v_and_b32 v155, s33, v137
    v_mul_f32 v154, s32, v154
    v_mul_f32 v155, s32, v155
    v_mfma_f32_16x16x32_bf16 v[160:163], v[108:111], a[28:31], v[160:163]
    v_lshlrev_b32 v156, 16, v138
    v_and_b32 v157, s33, v138
    v_mul_f32 v156, s32, v156
    v_mul_f32 v157, s32, v157
    v_lshlrev_b32 v158, 16, v139
    v_and_b32 v159, s33, v139
    v_mul_f32 v158, s32, v158
    v_mul_f32 v159, s32, v159
    v_cvt_pk_bf16_f32 v152, v152, v153
    v_cvt_pk_bf16_f32 v154, v154, v155
    v_cvt_pk_bf16_f32 v156, v156, v157
    v_cvt_pk_bf16_f32 v158, v158, v159
    v_accvgpr_write_b32 a32, v152
    v_accvgpr_write_b32 a33, v154
    v_accvgpr_write_b32 a34, v156
    v_accvgpr_write_b32 a35, v158
    s_waitcnt lgkmcnt(2)
    s_add_u32 m0, s35, 150912
    s_add_u32 s39, s53, 21504
    buffer_load_dwordx4 v3, s[12:15], s39 offen offset:0 nt lds
    v_lshlrev_b32 v152, 16, v140
    v_and_b32 v153, s33, v140
    v_mul_f32 v152, s32, v152
    v_mul_f32 v153, s32, v153
    v_mfma_f32_16x16x32_bf16 v[20:23], v[88:91], a[32:35], v[20:23]
    v_lshlrev_b32 v154, 16, v141
    v_and_b32 v155, s33, v141
    v_mul_f32 v154, s32, v154
    v_mul_f32 v155, s32, v155
    v_mfma_f32_16x16x32_bf16 v[160:163], v[112:115], a[32:35], v[160:163]
    v_lshlrev_b32 v156, 16, v142
    v_and_b32 v157, s33, v142
    v_mul_f32 v156, s32, v156
    v_mul_f32 v157, s32, v157
    v_lshlrev_b32 v158, 16, v143
    v_and_b32 v159, s33, v143
    v_mul_f32 v158, s32, v158
    v_mul_f32 v159, s32, v159
    v_cvt_pk_bf16_f32 v152, v152, v153
    v_cvt_pk_bf16_f32 v154, v154, v155
    v_cvt_pk_bf16_f32 v156, v156, v157
    v_cvt_pk_bf16_f32 v158, v158, v159
    v_accvgpr_write_b32 a36, v152
    v_accvgpr_write_b32 a37, v154
    v_accvgpr_write_b32 a38, v156
    v_accvgpr_write_b32 a39, v158
    s_waitcnt lgkmcnt(1)
    buffer_load_dwordx4 v3, s[12:15], s39 offen offset:1024 nt lds
    v_lshlrev_b32 v152, 16, v144
    v_and_b32 v153, s33, v144
    v_mul_f32 v152, s32, v152
    v_mul_f32 v153, s32, v153
    v_mfma_f32_16x16x32_bf16 v[20:23], v[92:95], a[36:39], v[20:23]
    v_lshlrev_b32 v154, 16, v145
    v_and_b32 v155, s33, v145
    v_mul_f32 v154, s32, v154
    v_mul_f32 v155, s32, v155
    v_mfma_f32_16x16x32_bf16 v[160:163], v[116:119], a[36:39], v[160:163]
    v_lshlrev_b32 v156, 16, v146
    v_and_b32 v157, s33, v146
    v_mul_f32 v156, s32, v156
    v_mul_f32 v157, s32, v157
    v_lshlrev_b32 v158, 16, v147
    v_and_b32 v159, s33, v147
    v_mul_f32 v158, s32, v158
    v_mul_f32 v159, s32, v159
    v_cvt_pk_bf16_f32 v152, v152, v153
    v_cvt_pk_bf16_f32 v154, v154, v155
    v_cvt_pk_bf16_f32 v156, v156, v157
    v_cvt_pk_bf16_f32 v158, v158, v159
    v_accvgpr_write_b32 a40, v152
    v_accvgpr_write_b32 a41, v154
    v_accvgpr_write_b32 a42, v156
    v_accvgpr_write_b32 a43, v158
    s_waitcnt lgkmcnt(0)
    buffer_load_dwordx4 v3, s[12:15], s39 offen offset:2048 nt lds
    v_lshlrev_b32 v152, 16, v148
    v_and_b32 v153, s33, v148
    v_mul_f32 v152, s32, v152
    v_mul_f32 v153, s32, v153
    v_mfma_f32_16x16x32_bf16 v[20:23], v[96:99], a[40:43], v[20:23]
    v_lshlrev_b32 v154, 16, v149
    v_and_b32 v155, s33, v149
    v_mul_f32 v154, s32, v154
    v_mul_f32 v155, s32, v155
    v_mfma_f32_16x16x32_bf16 v[160:163], v[120:123], a[40:43], v[160:163]
    v_lshlrev_b32 v156, 16, v150
    v_and_b32 v157, s33, v150
    v_mul_f32 v156, s32, v156
    v_mul_f32 v157, s32, v157
    v_lshlrev_b32 v158, 16, v151
    v_and_b32 v159, s33, v151
    v_mul_f32 v158, s32, v158
    v_mul_f32 v159, s32, v159
    v_cvt_pk_bf16_f32 v152, v152, v153
    v_cvt_pk_bf16_f32 v154, v154, v155
    v_cvt_pk_bf16_f32 v156, v156, v157
    v_cvt_pk_bf16_f32 v158, v158, v159
    v_accvgpr_write_b32 a44, v152
    v_accvgpr_write_b32 a45, v154
    v_accvgpr_write_b32 a46, v156
    v_accvgpr_write_b32 a47, v158
    s_nop 1
    v_mfma_f32_16x16x32_bf16 v[20:23], v[100:103], a[44:47], v[20:23]
    v_mfma_f32_16x16x32_bf16 v[160:163], v[124:127], a[44:47], v[160:163]
    s_nop 6
    v_exp_f32 v20, v20
    v_exp_f32 v21, v21
    v_exp_f32 v22, v22
    v_exp_f32 v23, v23
    v_exp_f32 v160, v160
    v_exp_f32 v161, v161
    v_exp_f32 v162, v162
    v_exp_f32 v163, v163
    v_cvt_pk_bf16_f32 v20, v20, v21
    v_cvt_pk_bf16_f32 v21, v22, v23
    v_cvt_pk_bf16_f32 v22, v160, v161
    v_cvt_pk_bf16_f32 v23, v162, v163
    s_waitcnt vmcnt(6)
    ds_read_b128 v[128:131], v0 offset:0
    ds_read_b128 v[132:135], v0 offset:64
    ds_read_b128 v[136:139], v0 offset:128
    ds_read_b128 v[140:143], v0 offset:192
    ds_read_b128 v[144:147], v0 offset:256
    ds_read_b128 v[148:151], v0 offset:320
    v_add_u32 v0, 0x6240, v0
    s_waitcnt lgkmcnt(5)
    s_add_u32 m0, s35, 0
    s_add_u32 s39, s53, 24576
    buffer_load_dwordx4 v3, s[12:15], s39 offen offset:0 nt lds
    v_lshlrev_b32 v152, 16, v128
    v_and_b32 v153, s33, v128
    v_mul_f32 v152, s32, v152
    v_mul_f32 v153, s32, v153
    v_lshlrev_b32 v154, 16, v129
    v_and_b32 v155, s33, v129
    v_mul_f32 v154, s32, v154
    v_mul_f32 v155, s32, v155
    v_lshlrev_b32 v156, 16, v130
    v_and_b32 v157, s33, v130
    v_mul_f32 v156, s32, v156
    v_mul_f32 v157, s32, v157
    v_lshlrev_b32 v158, 16, v131
    v_and_b32 v159, s33, v131
    v_mul_f32 v158, s32, v158
    v_mul_f32 v159, s32, v159
    v_cvt_pk_bf16_f32 v152, v152, v153
    v_cvt_pk_bf16_f32 v154, v154, v155
    v_cvt_pk_bf16_f32 v156, v156, v157
    v_cvt_pk_bf16_f32 v158, v158, v159
    v_accvgpr_write_b32 a48, v152
    v_accvgpr_write_b32 a49, v154
    v_accvgpr_write_b32 a50, v156
    v_accvgpr_write_b32 a51, v158
    s_waitcnt lgkmcnt(4)
    buffer_load_dwordx4 v3, s[12:15], s39 offen offset:1024 nt lds
    v_lshlrev_b32 v152, 16, v132
    v_and_b32 v153, s33, v132
    v_mul_f32 v152, s32, v152
    v_mul_f32 v153, s32, v153
    v_mfma_f32_16x16x32_bf16 v[24:27], v[80:83], a[48:51], -4.0
    v_lshlrev_b32 v154, 16, v133
    v_and_b32 v155, s33, v133
    v_mul_f32 v154, s32, v154
    v_mul_f32 v155, s32, v155
    v_mfma_f32_16x16x32_bf16 v[160:163], v[104:107], a[48:51], -4.0
    v_lshlrev_b32 v156, 16, v134
    v_and_b32 v157, s33, v134
    v_mul_f32 v156, s32, v156
    v_mul_f32 v157, s32, v157
    v_lshlrev_b32 v158, 16, v135
    v_and_b32 v159, s33, v135
    v_mul_f32 v158, s32, v158
    v_mul_f32 v159, s32, v159
    v_cvt_pk_bf16_f32 v152, v152, v153
    v_cvt_pk_bf16_f32 v154, v154, v155
    v_cvt_pk_bf16_f32 v156, v156, v157
    v_cvt_pk_bf16_f32 v158, v158, v159
    v_accvgpr_write_b32 a52, v152
    v_accvgpr_write_b32 a53, v154
    v_accvgpr_write_b32 a54, v156
    v_accvgpr_write_b32 a55, v158
    s_waitcnt lgkmcnt(3)
    buffer_load_dwordx4 v3, s[12:15], s39 offen offset:2048 nt lds
    v_lshlrev_b32 v152, 16, v136
    v_and_b32 v153, s33, v136
    v_mul_f32 v152, s32, v152
    v_mul_f32 v153, s32, v153
    v_mfma_f32_16x16x32_bf16 v[24:27], v[84:87], a[52:55], v[24:27]
    v_lshlrev_b32 v154, 16, v137
    v_and_b32 v155, s33, v137
    v_mul_f32 v154, s32, v154
    v_mul_f32 v155, s32, v155
    v_mfma_f32_16x16x32_bf16 v[160:163], v[108:111], a[52:55], v[160:163]
    v_lshlrev_b32 v156, 16, v138
    v_and_b32 v157, s33, v138
    v_mul_f32 v156, s32, v156
    v_mul_f32 v157, s32, v157
    v_lshlrev_b32 v158, 16, v139
    v_and_b32 v159, s33, v139
    v_mul_f32 v158, s32, v158
    v_mul_f32 v159, s32, v159
    v_cvt_pk_bf16_f32 v152, v152, v153
    v_cvt_pk_bf16_f32 v154, v154, v155
    v_cvt_pk_bf16_f32 v156, v156, v157
    v_cvt_pk_bf16_f32 v158, v158, v159
    v_accvgpr_write_b32 a56, v152
    v_accvgpr_write_b32 a57, v154
    v_accvgpr_write_b32 a58, v156
    v_accvgpr_write_b32 a59, v158
    s_waitcnt lgkmcnt(2)
    s_add_u32 m0, s35, 12576
    s_add_u32 s39, s53, 27648
    buffer_load_dwordx4 v3, s[12:15], s39 offen offset:0 nt lds
    v_lshlrev_b32 v152, 16, v140
    v_and_b32 v153, s33, v140
    v_mul_f32 v152, s32, v152
    v_mul_f32 v153, s32, v153
    v_mfma_f32_16x16x32_bf16 v[24:27], v[88:91], a[56:59], v[24:27]
    v_lshlrev_b32 v154, 16, v141
    v_and_b32 v155, s33, v141
    v_mul_f32 v154, s32, v154
    v_mul_f32 v155, s32, v155
    v_mfma_f32_16x16x32_bf16 v[160:163], v[112:115], a[56:59], v[160:163]
    v_lshlrev_b32 v156, 16, v142
    v_and_b32 v157, s33, v142
    v_mul_f32 v156, s32, v156
    v_mul_f32 v157, s32, v157
    v_lshlrev_b32 v158, 16, v143
    v_and_b32 v159, s33, v143
    v_mul_f32 v158, s32, v158
    v_mul_f32 v159, s32, v159
    v_cvt_pk_bf16_f32 v152, v152, v153
    v_cvt_pk_bf16_f32 v154, v154, v155
    v_cvt_pk_bf16_f32 v156, v156, v157
    v_cvt_pk_bf16_f32 v158, v158, v159
    v_accvgpr_write_b32 a60, v152
    v_accvgpr_write_b32 a61, v154
    v_accvgpr_write_b32 a62, v156
    v_accvgpr_write_b32 a63, v158
    s_waitcnt lgkmcnt(1)
    buffer_load_dwordx4 v3, s[12:15], s39 offen offset:1024 nt lds
    v_lshlrev_b32 v152, 16, v144
    v_and_b32 v153, s33, v144
    v_mul_f32 v152, s32, v152
    v_mul_f32 v153, s32, v153
    v_mfma_f32_16x16x32_bf16 v[24:27], v[92:95], a[60:63], v[24:27]
    v_lshlrev_b32 v154, 16, v145
    v_and_b32 v155, s33, v145
    v_mul_f32 v154, s32, v154
    v_mul_f32 v155, s32, v155
    v_mfma_f32_16x16x32_bf16 v[160:163], v[116:119], a[60:63], v[160:163]
    v_lshlrev_b32 v156, 16, v146
    v_and_b32 v157, s33, v146
    v_mul_f32 v156, s32, v156
    v_mul_f32 v157, s32, v157
    v_lshlrev_b32 v158, 16, v147
    v_and_b32 v159, s33, v147
    v_mul_f32 v158, s32, v158
    v_mul_f32 v159, s32, v159
    v_cvt_pk_bf16_f32 v152, v152, v153
    v_cvt_pk_bf16_f32 v154, v154, v155
    v_cvt_pk_bf16_f32 v156, v156, v157
    v_cvt_pk_bf16_f32 v158, v158, v159
    v_accvgpr_write_b32 a64, v152
    v_accvgpr_write_b32 a65, v154
    v_accvgpr_write_b32 a66, v156
    v_accvgpr_write_b32 a67, v158
    s_waitcnt lgkmcnt(0)
    buffer_load_dwordx4 v3, s[12:15], s39 offen offset:2048 nt lds
    v_lshlrev_b32 v152, 16, v148
    v_and_b32 v153, s33, v148
    v_mul_f32 v152, s32, v152
    v_mul_f32 v153, s32, v153
    v_mfma_f32_16x16x32_bf16 v[24:27], v[96:99], a[64:67], v[24:27]
    v_lshlrev_b32 v154, 16, v149
    v_and_b32 v155, s33, v149
    v_mul_f32 v154, s32, v154
    v_mul_f32 v155, s32, v155
    v_mfma_f32_16x16x32_bf16 v[160:163], v[120:123], a[64:67], v[160:163]
    v_lshlrev_b32 v156, 16, v150
    v_and_b32 v157, s33, v150
    v_mul_f32 v156, s32, v156
    v_mul_f32 v157, s32, v157
    v_lshlrev_b32 v158, 16, v151
    v_and_b32 v159, s33, v151
    v_mul_f32 v158, s32, v158
    v_mul_f32 v159, s32, v159
    v_cvt_pk_bf16_f32 v152, v152, v153
    v_cvt_pk_bf16_f32 v154, v154, v155
    v_cvt_pk_bf16_f32 v156, v156, v157
    v_cvt_pk_bf16_f32 v158, v158, v159
    v_accvgpr_write_b32 a68, v152
    v_accvgpr_write_b32 a69, v154
    v_accvgpr_write_b32 a70, v156
    v_accvgpr_write_b32 a71, v158
    s_nop 1
    v_mfma_f32_16x16x32_bf16 v[24:27], v[100:103], a[68:71], v[24:27]
    v_mfma_f32_16x16x32_bf16 v[160:163], v[124:127], a[68:71], v[160:163]
    s_nop 6
    v_exp_f32 v24, v24
    v_exp_f32 v25, v25
    v_exp_f32 v26, v26
    v_exp_f32 v27, v27
    v_exp_f32 v160, v160
    v_exp_f32 v161, v161
    v_exp_f32 v162, v162
    v_exp_f32 v163, v163
    v_cvt_pk_bf16_f32 v24, v24, v25
    v_cvt_pk_bf16_f32 v25, v26, v27
    v_cvt_pk_bf16_f32 v26, v160, v161
    v_cvt_pk_bf16_f32 v27, v162, v163
    s_waitcnt vmcnt(6)
    ds_read_b128 v[128:131], v0 offset:0
    ds_read_b128 v[132:135], v0 offset:64
    ds_read_b128 v[136:139], v0 offset:128
    ds_read_b128 v[140:143], v0 offset:192
    ds_read_b128 v[144:147], v0 offset:256
    ds_read_b128 v[148:151], v0 offset:320
    v_add_u32 v0, 0xfffde3a0, v0
    s_waitcnt lgkmcnt(5)
    s_add_u32 m0, s35, 25152
    s_add_u32 s39, s53, 30720
    buffer_load_dwordx4 v3, s[12:15], s39 offen offset:0 nt lds
    v_lshlrev_b32 v152, 16, v128
    v_and_b32 v153, s33, v128
    v_mul_f32 v152, s32, v152
    v_mul_f32 v153, s32, v153
    v_lshlrev_b32 v154, 16, v129
    v_and_b32 v155, s33, v129
    v_mul_f32 v154, s32, v154
    v_mul_f32 v155, s32, v155
    v_lshlrev_b32 v156, 16, v130
    v_and_b32 v157, s33, v130
    v_mul_f32 v156, s32, v156
    v_mul_f32 v157, s32, v157
    v_lshlrev_b32 v158, 16, v131
    v_and_b32 v159, s33, v131
    v_mul_f32 v158, s32, v158
    v_mul_f32 v159, s32, v159
    v_cvt_pk_bf16_f32 v152, v152, v153
    v_cvt_pk_bf16_f32 v154, v154, v155
    v_cvt_pk_bf16_f32 v156, v156, v157
    v_cvt_pk_bf16_f32 v158, v158, v159
    v_accvgpr_write_b32 a72, v152
    v_accvgpr_write_b32 a73, v154
    v_accvgpr_write_b32 a74, v156
    v_accvgpr_write_b32 a75, v158
    s_waitcnt lgkmcnt(4)
    buffer_load_dwordx4 v3, s[12:15], s39 offen offset:1024 nt lds
    v_lshlrev_b32 v152, 16, v132
    v_and_b32 v153, s33, v132
    v_mul_f32 v152, s32, v152
    v_mul_f32 v153, s32, v153
    v_mfma_f32_16x16x32_bf16 v[28:31], v[80:83], a[72:75], -4.0
    v_lshlrev_b32 v154, 16, v133
    v_and_b32 v155, s33, v133
    v_mul_f32 v154, s32, v154
    v_mul_f32 v155, s32, v155
    v_mfma_f32_16x16x32_bf16 v[160:163], v[104:107], a[72:75], -4.0
    v_lshlrev_b32 v156, 16, v134
    v_and_b32 v157, s33, v134
    v_mul_f32 v156, s32, v156
    v_mul_f32 v157, s32, v157
    v_lshlrev_b32 v158, 16, v135
    v_and_b32 v159, s33, v135
    v_mul_f32 v158, s32, v158
    v_mul_f32 v159, s32, v159
    v_cvt_pk_bf16_f32 v152, v152, v153
    v_cvt_pk_bf16_f32 v154, v154, v155
    v_cvt_pk_bf16_f32 v156, v156, v157
    v_cvt_pk_bf16_f32 v158, v158, v159
    v_accvgpr_write_b32 a76, v152
    v_accvgpr_write_b32 a77, v154
    v_accvgpr_write_b32 a78, v156
    v_accvgpr_write_b32 a79, v158
    s_waitcnt lgkmcnt(3)
    buffer_load_dwordx4 v3, s[12:15], s39 offen offset:2048 nt lds
    v_lshlrev_b32 v152, 16, v136
    v_and_b32 v153, s33, v136
    v_mul_f32 v152, s32, v152
    v_mul_f32 v153, s32, v153
    v_mfma_f32_16x16x32_bf16 v[28:31], v[84:87], a[76:79], v[28:31]
    v_lshlrev_b32 v154, 16, v137
    v_and_b32 v155, s33, v137
    v_mul_f32 v154, s32, v154
    v_mul_f32 v155, s32, v155
    v_mfma_f32_16x16x32_bf16 v[160:163], v[108:111], a[76:79], v[160:163]
    v_lshlrev_b32 v156, 16, v138
    v_and_b32 v157, s33, v138
    v_mul_f32 v156, s32, v156
    v_mul_f32 v157, s32, v157
    v_lshlrev_b32 v158, 16, v139
    v_and_b32 v159, s33, v139
    v_mul_f32 v158, s32, v158
    v_mul_f32 v159, s32, v159
    v_cvt_pk_bf16_f32 v152, v152, v153
    v_cvt_pk_bf16_f32 v154, v154, v155
    v_cvt_pk_bf16_f32 v156, v156, v157
    v_cvt_pk_bf16_f32 v158, v158, v159
    v_accvgpr_write_b32 a80, v152
    v_accvgpr_write_b32 a81, v154
    v_accvgpr_write_b32 a82, v156
    v_accvgpr_write_b32 a83, v158
    s_waitcnt lgkmcnt(2)
    s_add_u32 m0, s35, 37728
    s_add_u32 s39, s53, 33792
    buffer_load_dwordx4 v3, s[12:15], s39 offen offset:0 nt lds
    v_lshlrev_b32 v152, 16, v140
    v_and_b32 v153, s33, v140
    v_mul_f32 v152, s32, v152
    v_mul_f32 v153, s32, v153
    v_mfma_f32_16x16x32_bf16 v[28:31], v[88:91], a[80:83], v[28:31]
    v_lshlrev_b32 v154, 16, v141
    v_and_b32 v155, s33, v141
    v_mul_f32 v154, s32, v154
    v_mul_f32 v155, s32, v155
    v_mfma_f32_16x16x32_bf16 v[160:163], v[112:115], a[80:83], v[160:163]
    v_lshlrev_b32 v156, 16, v142
    v_and_b32 v157, s33, v142
    v_mul_f32 v156, s32, v156
    v_mul_f32 v157, s32, v157
    v_lshlrev_b32 v158, 16, v143
    v_and_b32 v159, s33, v143
    v_mul_f32 v158, s32, v158
    v_mul_f32 v159, s32, v159
    v_cvt_pk_bf16_f32 v152, v152, v153
    v_cvt_pk_bf16_f32 v154, v154, v155
    v_cvt_pk_bf16_f32 v156, v156, v157
    v_cvt_pk_bf16_f32 v158, v158, v159
    v_accvgpr_write_b32 a84, v152
    v_accvgpr_write_b32 a85, v154
    v_accvgpr_write_b32 a86, v156
    v_accvgpr_write_b32 a87, v158
    s_waitcnt lgkmcnt(1)
    buffer_load_dwordx4 v3, s[12:15], s39 offen offset:1024 nt lds
    v_lshlrev_b32 v152, 16, v144
    v_and_b32 v153, s33, v144
    v_mul_f32 v152, s32, v152
    v_mul_f32 v153, s32, v153
    v_mfma_f32_16x16x32_bf16 v[28:31], v[92:95], a[84:87], v[28:31]
    v_lshlrev_b32 v154, 16, v145
    v_and_b32 v155, s33, v145
    v_mul_f32 v154, s32, v154
    v_mul_f32 v155, s32, v155
    v_mfma_f32_16x16x32_bf16 v[160:163], v[116:119], a[84:87], v[160:163]
    v_lshlrev_b32 v156, 16, v146
    v_and_b32 v157, s33, v146
    v_mul_f32 v156, s32, v156
    v_mul_f32 v157, s32, v157
    v_lshlrev_b32 v158, 16, v147
    v_and_b32 v159, s33, v147
    v_mul_f32 v158, s32, v158
    v_mul_f32 v159, s32, v159
    v_cvt_pk_bf16_f32 v152, v152, v153
    v_cvt_pk_bf16_f32 v154, v154, v155
    v_cvt_pk_bf16_f32 v156, v156, v157
    v_cvt_pk_bf16_f32 v158, v158, v159
    v_accvgpr_write_b32 a88, v152
    v_accvgpr_write_b32 a89, v154
    v_accvgpr_write_b32 a90, v156
    v_accvgpr_write_b32 a91, v158
    s_waitcnt lgkmcnt(0)
    buffer_load_dwordx4 v3, s[12:15], s39 offen offset:2048 nt lds
    v_lshlrev_b32 v152, 16, v148
    v_and_b32 v153, s33, v148
    v_mul_f32 v152, s32, v152
    v_mul_f32 v153, s32, v153
    v_mfma_f32_16x16x32_bf16 v[28:31], v[96:99], a[88:91], v[28:31]
    v_lshlrev_b32 v154, 16, v149
    v_and_b32 v155, s33, v149
    v_mul_f32 v154, s32, v154
    v_mul_f32 v155, s32, v155
    v_mfma_f32_16x16x32_bf16 v[160:163], v[120:123], a[88:91], v[160:163]
    v_lshlrev_b32 v156, 16, v150
    v_and_b32 v157, s33, v150
    v_mul_f32 v156, s32, v156
    v_mul_f32 v157, s32, v157
    v_lshlrev_b32 v158, 16, v151
    v_and_b32 v159, s33, v151
    v_mul_f32 v158, s32, v158
    v_mul_f32 v159, s32, v159
    v_cvt_pk_bf16_f32 v152, v152, v153
    v_cvt_pk_bf16_f32 v154, v154, v155
    v_cvt_pk_bf16_f32 v156, v156, v157
    v_cvt_pk_bf16_f32 v158, v158, v159
    v_accvgpr_write_b32 a92, v152
    v_accvgpr_write_b32 a93, v154
    v_accvgpr_write_b32 a94, v156
    v_accvgpr_write_b32 a95, v158
    s_nop 1
    v_mfma_f32_16x16x32_bf16 v[28:31], v[100:103], a[92:95], v[28:31]
    v_mfma_f32_16x16x32_bf16 v[160:163], v[124:127], a[92:95], v[160:163]
    s_nop 6
    v_exp_f32 v28, v28
    v_exp_f32 v29, v29
    v_exp_f32 v30, v30
    v_exp_f32 v31, v31
    v_exp_f32 v160, v160
    v_exp_f32 v161, v161
    v_exp_f32 v162, v162
    v_exp_f32 v163, v163
    v_cvt_pk_bf16_f32 v28, v28, v29
    v_cvt_pk_bf16_f32 v29, v30, v31
    v_cvt_pk_bf16_f32 v30, v160, v161
    v_cvt_pk_bf16_f32 v31, v162, v163
    s_waitcnt vmcnt(6)
    ds_read_b128 v[128:131], v0 offset:0
    ds_read_b128 v[132:135], v0 offset:64
    ds_read_b128 v[136:139], v0 offset:128
    ds_read_b128 v[140:143], v0 offset:192
    ds_read_b128 v[144:147], v0 offset:256
    ds_read_b128 v[148:151], v0 offset:320
    v_add_u32 v0, 0x6240, v0
    s_waitcnt lgkmcnt(5)
    s_add_u32 m0, s35, 62880
    s_add_u32 s39, s34, 0
    buffer_load_dwordx4 v3, s[20:23], s39 offen offset:0 nt lds
    v_lshlrev_b32 v152, 16, v128
    v_and_b32 v153, s33, v128
    v_mul_f32 v152, s32, v152
    v_mul_f32 v153, s32, v153
    v_lshlrev_b32 v154, 16, v129
    v_and_b32 v155, s33, v129
    v_mul_f32 v154, s32, v154
    v_mul_f32 v155, s32, v155
    v_lshlrev_b32 v156, 16, v130
    v_and_b32 v157, s33, v130
    v_mul_f32 v156, s32, v156
    v_mul_f32 v157, s32, v157
    v_lshlrev_b32 v158, 16, v131
    v_and_b32 v159, s33, v131
    v_mul_f32 v158, s32, v158
    v_mul_f32 v159, s32, v159
    v_cvt_pk_bf16_f32 v152, v152, v153
    v_cvt_pk_bf16_f32 v154, v154, v155
    v_cvt_pk_bf16_f32 v156, v156, v157
    v_cvt_pk_bf16_f32 v158, v158, v159
    v_accvgpr_write_b32 a96, v152
    v_accvgpr_write_b32 a97, v154
    v_accvgpr_write_b32 a98, v156
    v_accvgpr_write_b32 a99, v158
    s_waitcnt lgkmcnt(4)
    buffer_load_dwordx4 v3, s[20:23], s39 offen offset:1024 nt lds
    v_lshlrev_b32 v152, 16, v132
    v_and_b32 v153, s33, v132
    v_mul_f32 v152, s32, v152
    v_mul_f32 v153, s32, v153
    v_mfma_f32_16x16x32_bf16 v[32:35], v[80:83], a[96:99], -4.0
    v_lshlrev_b32 v154, 16, v133
    v_and_b32 v155, s33, v133
    v_mul_f32 v154, s32, v154
    v_mul_f32 v155, s32, v155
    v_mfma_f32_16x16x32_bf16 v[160:163], v[104:107], a[96:99], -4.0
    v_lshlrev_b32 v156, 16, v134
    v_and_b32 v157, s33, v134
    v_mul_f32 v156, s32, v156
    v_mul_f32 v157, s32, v157
    v_lshlrev_b32 v158, 16, v135
    v_and_b32 v159, s33, v135
    v_mul_f32 v158, s32, v158
    v_mul_f32 v159, s32, v159
    v_cvt_pk_bf16_f32 v152, v152, v153
    v_cvt_pk_bf16_f32 v154, v154, v155
    v_cvt_pk_bf16_f32 v156, v156, v157
    v_cvt_pk_bf16_f32 v158, v158, v159
    v_accvgpr_write_b32 a100, v152
    v_accvgpr_write_b32 a101, v154
    v_accvgpr_write_b32 a102, v156
    v_accvgpr_write_b32 a103, v158
    s_waitcnt lgkmcnt(3)
    buffer_load_dwordx4 v3, s[20:23], s39 offen offset:2048 nt lds
    v_lshlrev_b32 v152, 16, v136
    v_and_b32 v153, s33, v136
    v_mul_f32 v152, s32, v152
    v_mul_f32 v153, s32, v153
    v_mfma_f32_16x16x32_bf16 v[32:35], v[84:87], a[100:103], v[32:35]
    v_lshlrev_b32 v154, 16, v137
    v_and_b32 v155, s33, v137
    v_mul_f32 v154, s32, v154
    v_mul_f32 v155, s32, v155
    v_mfma_f32_16x16x32_bf16 v[160:163], v[108:111], a[100:103], v[160:163]
    v_lshlrev_b32 v156, 16, v138
    v_and_b32 v157, s33, v138
    v_mul_f32 v156, s32, v156
    v_mul_f32 v157, s32, v157
    v_lshlrev_b32 v158, 16, v139
    v_and_b32 v159, s33, v139
    v_mul_f32 v158, s32, v158
    v_mul_f32 v159, s32, v159
    v_cvt_pk_bf16_f32 v152, v152, v153
    v_cvt_pk_bf16_f32 v154, v154, v155
    v_cvt_pk_bf16_f32 v156, v156, v157
    v_cvt_pk_bf16_f32 v158, v158, v159
    v_accvgpr_write_b32 a104, v152
    v_accvgpr_write_b32 a105, v154
    v_accvgpr_write_b32 a106, v156
    v_accvgpr_write_b32 a107, v158
    s_waitcnt lgkmcnt(2)
    s_add_u32 m0, s35, 75456
    s_add_u32 s39, s34, 12288
    buffer_load_dwordx4 v3, s[16:19], s39 offen offset:0 nt lds
    v_lshlrev_b32 v152, 16, v140
    v_and_b32 v153, s33, v140
    v_mul_f32 v152, s32, v152
    v_mul_f32 v153, s32, v153
    v_mfma_f32_16x16x32_bf16 v[32:35], v[88:91], a[104:107], v[32:35]
    v_lshlrev_b32 v154, 16, v141
    v_and_b32 v155, s33, v141
    v_mul_f32 v154, s32, v154
    v_mul_f32 v155, s32, v155
    v_mfma_f32_16x16x32_bf16 v[160:163], v[112:115], a[104:107], v[160:163]
    v_lshlrev_b32 v156, 16, v142
    v_and_b32 v157, s33, v142
    v_mul_f32 v156, s32, v156
    v_mul_f32 v157, s32, v157
    v_lshlrev_b32 v158, 16, v143
    v_and_b32 v159, s33, v143
    v_mul_f32 v158, s32, v158
    v_mul_f32 v159, s32, v159
    v_cvt_pk_bf16_f32 v152, v152, v153
    v_cvt_pk_bf16_f32 v154, v154, v155
    v_cvt_pk_bf16_f32 v156, v156, v157
    v_cvt_pk_bf16_f32 v158, v158, v159
    v_accvgpr_write_b32 a108, v152
    v_accvgpr_write_b32 a109, v154
    v_accvgpr_write_b32 a110, v156
    v_accvgpr_write_b32 a111, v158
    s_waitcnt lgkmcnt(1)
    buffer_load_dwordx4 v3, s[16:19], s39 offen offset:1024 nt lds
    v_lshlrev_b32 v152, 16, v144
    v_and_b32 v153, s33, v144
    v_mul_f32 v152, s32, v152
    v_mul_f32 v153, s32, v153
    v_mfma_f32_16x16x32_bf16 v[32:35], v[92:95], a[108:111], v[32:35]
    v_lshlrev_b32 v154, 16, v145
    v_and_b32 v155, s33, v145
    v_mul_f32 v154, s32, v154
    v_mul_f32 v155, s32, v155
    v_mfma_f32_16x16x32_bf16 v[160:163], v[116:119], a[108:111], v[160:163]
    v_lshlrev_b32 v156, 16, v146
    v_and_b32 v157, s33, v146
    v_mul_f32 v156, s32, v156
    v_mul_f32 v157, s32, v157
    v_lshlrev_b32 v158, 16, v147
    v_and_b32 v159, s33, v147
    v_mul_f32 v158, s32, v158
    v_mul_f32 v159, s32, v159
    v_cvt_pk_bf16_f32 v152, v152, v153
    v_cvt_pk_bf16_f32 v154, v154, v155
    v_cvt_pk_bf16_f32 v156, v156, v157
    v_cvt_pk_bf16_f32 v158, v158, v159
    v_accvgpr_write_b32 a112, v152
    v_accvgpr_write_b32 a113, v154
    v_accvgpr_write_b32 a114, v156
    v_accvgpr_write_b32 a115, v158
    s_waitcnt lgkmcnt(0)
    buffer_load_dwordx4 v3, s[16:19], s39 offen offset:2048 nt lds
    v_lshlrev_b32 v152, 16, v148
    v_and_b32 v153, s33, v148
    v_mul_f32 v152, s32, v152
    v_mul_f32 v153, s32, v153
    v_mfma_f32_16x16x32_bf16 v[32:35], v[96:99], a[112:115], v[32:35]
    v_lshlrev_b32 v154, 16, v149
    v_and_b32 v155, s33, v149
    v_mul_f32 v154, s32, v154
    v_mul_f32 v155, s32, v155
    v_mfma_f32_16x16x32_bf16 v[160:163], v[120:123], a[112:115], v[160:163]
    v_lshlrev_b32 v156, 16, v150
    v_and_b32 v157, s33, v150
    v_mul_f32 v156, s32, v156
    v_mul_f32 v157, s32, v157
    v_lshlrev_b32 v158, 16, v151
    v_and_b32 v159, s33, v151
    v_mul_f32 v158, s32, v158
    v_mul_f32 v159, s32, v159
    v_cvt_pk_bf16_f32 v152, v152, v153
    v_cvt_pk_bf16_f32 v154, v154, v155
    v_cvt_pk_bf16_f32 v156, v156, v157
    v_cvt_pk_bf16_f32 v158, v158, v159
    v_accvgpr_write_b32 a116, v152
    v_accvgpr_write_b32 a117, v154
    v_accvgpr_write_b32 a118, v156
    v_accvgpr_write_b32 a119, v158
    s_nop 1
    v_mfma_f32_16x16x32_bf16 v[32:35], v[100:103], a[116:119], v[32:35]
    v_mfma_f32_16x16x32_bf16 v[160:163], v[124:127], a[116:119], v[160:163]
    s_nop 6
    v_exp_f32 v32, v32
    v_exp_f32 v33, v33
    v_exp_f32 v34, v34
    v_exp_f32 v35, v35
    v_exp_f32 v160, v160
    v_exp_f32 v161, v161
    v_exp_f32 v162, v162
    v_exp_f32 v163, v163
    v_cvt_pk_bf16_f32 v32, v32, v33
    v_cvt_pk_bf16_f32 v33, v34, v35
    v_cvt_pk_bf16_f32 v34, v160, v161
    v_cvt_pk_bf16_f32 v35, v162, v163
    s_waitcnt vmcnt(6)
    ds_read_b128 v[128:131], v0 offset:0
    ds_read_b128 v[132:135], v0 offset:64
    ds_read_b128 v[136:139], v0 offset:128
    ds_read_b128 v[140:143], v0 offset:192
    ds_read_b128 v[144:147], v0 offset:256
    ds_read_b128 v[148:151], v0 offset:320
    s_waitcnt lgkmcnt(5)
    s_add_u32 m0, s35, 88032
    s_add_u32 s39, s34, 12288
    buffer_load_dwordx4 v3, s[20:23], s39 offen offset:0 nt lds
    v_lshlrev_b32 v152, 16, v128
    v_and_b32 v153, s33, v128
    v_mul_f32 v152, s32, v152
    v_mul_f32 v153, s32, v153
    v_lshlrev_b32 v154, 16, v129
    v_and_b32 v155, s33, v129
    v_mul_f32 v154, s32, v154
    v_mul_f32 v155, s32, v155
    v_lshlrev_b32 v156, 16, v130
    v_and_b32 v157, s33, v130
    v_mul_f32 v156, s32, v156
    v_mul_f32 v157, s32, v157
    v_lshlrev_b32 v158, 16, v131
    v_and_b32 v159, s33, v131
    v_mul_f32 v158, s32, v158
    v_mul_f32 v159, s32, v159
    v_cvt_pk_bf16_f32 v152, v152, v153
    v_cvt_pk_bf16_f32 v154, v154, v155
    v_cvt_pk_bf16_f32 v156, v156, v157
    v_cvt_pk_bf16_f32 v158, v158, v159
    v_accvgpr_write_b32 a120, v152
    v_accvgpr_write_b32 a121, v154
    v_accvgpr_write_b32 a122, v156
    v_accvgpr_write_b32 a123, v158
    s_waitcnt lgkmcnt(4)
    buffer_load_dwordx4 v3, s[20:23], s39 offen offset:1024 nt lds
    v_lshlrev_b32 v152, 16, v132
    v_and_b32 v153, s33, v132
    v_mul_f32 v152, s32, v152
    v_mul_f32 v153, s32, v153
    v_mfma_f32_16x16x32_bf16 v[36:39], v[80:83], a[120:123], -4.0
    v_lshlrev_b32 v154, 16, v133
    v_and_b32 v155, s33, v133
    v_mul_f32 v154, s32, v154
    v_mul_f32 v155, s32, v155
    v_mfma_f32_16x16x32_bf16 v[160:163], v[104:107], a[120:123], -4.0
    v_lshlrev_b32 v156, 16, v134
    v_and_b32 v157, s33, v134
    v_mul_f32 v156, s32, v156
    v_mul_f32 v157, s32, v157
    v_lshlrev_b32 v158, 16, v135
    v_and_b32 v159, s33, v135
    v_mul_f32 v158, s32, v158
    v_mul_f32 v159, s32, v159
    v_cvt_pk_bf16_f32 v152, v152, v153
    v_cvt_pk_bf16_f32 v154, v154, v155
    v_cvt_pk_bf16_f32 v156, v156, v157
    v_cvt_pk_bf16_f32 v158, v158, v159
    v_accvgpr_write_b32 a124, v152
    v_accvgpr_write_b32 a125, v154
    v_accvgpr_write_b32 a126, v156
    v_accvgpr_write_b32 a127, v158
    s_waitcnt lgkmcnt(3)
    buffer_load_dwordx4 v3, s[20:23], s39 offen offset:2048 nt lds
    v_lshlrev_b32 v152, 16, v136
    v_and_b32 v153, s33, v136
    v_mul_f32 v152, s32, v152
    v_mul_f32 v153, s32, v153
    v_mfma_f32_16x16x32_bf16 v[36:39], v[84:87], a[124:127], v[36:39]
    v_lshlrev_b32 v154, 16, v137
    v_and_b32 v155, s33, v137
    v_mul_f32 v154, s32, v154
    v_mul_f32 v155, s32, v155
    v_mfma_f32_16x16x32_bf16 v[160:163], v[108:111], a[124:127], v[160:163]
    v_lshlrev_b32 v156, 16, v138
    v_and_b32 v157, s33, v138
    v_mul_f32 v156, s32, v156
    v_mul_f32 v157, s32, v157
    v_lshlrev_b32 v158, 16, v139
    v_and_b32 v159, s33, v139
    v_mul_f32 v158, s32, v158
    v_mul_f32 v159, s32, v159
    v_cvt_pk_bf16_f32 v152, v152, v153
    v_cvt_pk_bf16_f32 v154, v154, v155
    v_cvt_pk_bf16_f32 v156, v156, v157
    v_cvt_pk_bf16_f32 v158, v158, v159
    v_accvgpr_write_b32 a128, v152
    v_accvgpr_write_b32 a129, v154
    v_accvgpr_write_b32 a130, v156
    v_accvgpr_write_b32 a131, v158
    s_waitcnt lgkmcnt(2)
    v_lshlrev_b32 v152, 16, v140
    v_and_b32 v153, s33, v140
    v_mul_f32 v152, s32, v152
    v_mul_f32 v153, s32, v153
    v_mfma_f32_16x16x32_bf16 v[36:39], v[88:91], a[128:131], v[36:39]
    v_lshlrev_b32 v154, 16, v141
    v_and_b32 v155, s33, v141
    v_mul_f32 v154, s32, v154
    v_mul_f32 v155, s32, v155
    v_mfma_f32_16x16x32_bf16 v[160:163], v[112:115], a[128:131], v[160:163]
    v_lshlrev_b32 v156, 16, v142
    v_and_b32 v157, s33, v142
    v_mul_f32 v156, s32, v156
    v_mul_f32 v157, s32, v157
    v_lshlrev_b32 v158, 16, v143
    v_and_b32 v159, s33, v143
    v_mul_f32 v158, s32, v158
    v_mul_f32 v159, s32, v159
    v_cvt_pk_bf16_f32 v152, v152, v153
    v_cvt_pk_bf16_f32 v154, v154, v155
    v_cvt_pk_bf16_f32 v156, v156, v157
    v_cvt_pk_bf16_f32 v158, v158, v159
    v_accvgpr_write_b32 a132, v152
    v_accvgpr_write_b32 a133, v154
    v_accvgpr_write_b32 a134, v156
    v_accvgpr_write_b32 a135, v158
    s_waitcnt lgkmcnt(1)
    v_lshlrev_b32 v152, 16, v144
    v_and_b32 v153, s33, v144
    v_mul_f32 v152, s32, v152
    v_mul_f32 v153, s32, v153
    v_mfma_f32_16x16x32_bf16 v[36:39], v[92:95], a[132:135], v[36:39]
    v_lshlrev_b32 v154, 16, v145
    v_and_b32 v155, s33, v145
    v_mul_f32 v154, s32, v154
    v_mul_f32 v155, s32, v155
    v_mfma_f32_16x16x32_bf16 v[160:163], v[116:119], a[132:135], v[160:163]
    v_lshlrev_b32 v156, 16, v146
    v_and_b32 v157, s33, v146
    v_mul_f32 v156, s32, v156
    v_mul_f32 v157, s32, v157
    v_lshlrev_b32 v158, 16, v147
    v_and_b32 v159, s33, v147
    v_mul_f32 v158, s32, v158
    v_mul_f32 v159, s32, v159
    v_cvt_pk_bf16_f32 v152, v152, v153
    v_cvt_pk_bf16_f32 v154, v154, v155
    v_cvt_pk_bf16_f32 v156, v156, v157
    v_cvt_pk_bf16_f32 v158, v158, v159
    v_accvgpr_write_b32 a136, v152
    v_accvgpr_write_b32 a137, v154
    v_accvgpr_write_b32 a138, v156
    v_accvgpr_write_b32 a139, v158
    s_waitcnt lgkmcnt(0)
    v_lshlrev_b32 v152, 16, v148
    v_and_b32 v153, s33, v148
    v_mul_f32 v152, s32, v152
    v_mul_f32 v153, s32, v153
    v_mfma_f32_16x16x32_bf16 v[36:39], v[96:99], a[136:139], v[36:39]
    v_lshlrev_b32 v154, 16, v149
    v_and_b32 v155, s33, v149
    v_mul_f32 v154, s32, v154
    v_mul_f32 v155, s32, v155
    v_mfma_f32_16x16x32_bf16 v[160:163], v[120:123], a[136:139], v[160:163]
    v_lshlrev_b32 v156, 16, v150
    v_and_b32 v157, s33, v150
    v_mul_f32 v156, s32, v156
    v_mul_f32 v157, s32, v157
    v_lshlrev_b32 v158, 16, v151
    v_and_b32 v159, s33, v151
    v_mul_f32 v158, s32, v158
    v_mul_f32 v159, s32, v159
    v_cvt_pk_bf16_f32 v152, v152, v153
    v_cvt_pk_bf16_f32 v154, v154, v155
    v_cvt_pk_bf16_f32 v156, v156, v157
    v_cvt_pk_bf16_f32 v158, v158, v159
    v_accvgpr_write_b32 a140, v152
    v_accvgpr_write_b32 a141, v154
    v_accvgpr_write_b32 a142, v156
    v_accvgpr_write_b32 a143, v158
    s_nop 1
    v_mfma_f32_16x16x32_bf16 v[36:39], v[100:103], a[140:143], v[36:39]
    v_mfma_f32_16x16x32_bf16 v[160:163], v[124:127], a[140:143], v[160:163]
    s_nop 6
    v_exp_f32 v36, v36
    v_exp_f32 v37, v37
    v_exp_f32 v38, v38
    v_exp_f32 v39, v39
    v_exp_f32 v160, v160
    v_exp_f32 v161, v161
    v_exp_f32 v162, v162
    v_exp_f32 v163, v163
    v_cvt_pk_bf16_f32 v36, v36, v37
    v_cvt_pk_bf16_f32 v37, v38, v39
    v_cvt_pk_bf16_f32 v38, v160, v161
    v_cvt_pk_bf16_f32 v39, v162, v163
    v_mov_b32 v0, v172
    s_waitcnt vmcnt(6)
    s_barrier
    ds_read_b64_tr_b16 v[64:65], v2 offset:0
    ds_read_b64_tr_b16 v[66:67], v2 offset:1536
    ds_read_b64_tr_b16 v[68:69], v2 offset:32
    ds_read_b64_tr_b16 v[70:71], v2 offset:1568
    v_smfmac_f32_16x16x64_bf16 v[4:7], v[12:15], v[16:23], v0
    v_smfmac_f32_16x16x64_bf16 v[8:11], v[12:15], v[24:31], v0
    s_waitcnt lgkmcnt(2)
    v_mfma_f32_16x16x32_bf16 v[80:83], v[16:19], v[64:67], 0
    v_mfma_f32_16x16x32_bf16 v[128:131], v[20:23], v[64:67], 0
    v_mfma_f32_16x16x32_bf16 v[176:179], v[24:27], v[64:67], 0
    s_cmp_eq_u32 s38, 125760
    v_mfma_f32_16x16x32_bf16 a[240:243], v[28:31], v[64:67], 0
    s_cselect_b32 s37, s44, s43
    v_mfma_f32_16x16x32_bf16 a[192:195], v[32:35], v[64:67], 0
    s_waitcnt lgkmcnt(0)
    v_mfma_f32_16x16x32_bf16 a[196:199], v[32:35], v[68:71], 0
    s_add_u32 s38, s38, s37
    ds_read_b64_tr_b16 v[72:73], v2 offset:64
    v_mfma_f32_16x16x32_bf16 a[244:247], v[28:31], v[68:71], 0
    ds_read_b64_tr_b16 v[74:75], v2 offset:1600
    v_mfma_f32_16x16x32_bf16 v[180:183], v[24:27], v[68:71], 0
    ds_read_b64_tr_b16 v[52:53], v2 offset:96
    v_mfma_f32_16x16x32_bf16 v[132:135], v[20:23], v[68:71], 0
    ds_read_b64_tr_b16 v[54:55], v2 offset:1632
    v_mfma_f32_16x16x32_bf16 v[84:87], v[16:19], v[68:71], 0
    ds_read_b64_tr_b16 v[40:41], v2 offset:128
    v_mfma_f32_16x16x32_bf16 a[148:151], v[36:39], v[68:71], 0
    ds_read_b64_tr_b16 v[42:43], v2 offset:1664
    v_mfma_f32_16x16x32_bf16 a[144:147], v[36:39], v[64:67], 0
    v_smfmac_f32_16x16x64_bf16 v[76:79], v[12:15], v[32:39], v0
    s_waitcnt lgkmcnt(4)
    v_mfma_f32_16x16x32_bf16 v[88:91], v[16:19], v[72:75], 0
    s_waitcnt lgkmcnt(2)
    ds_read_b64_tr_b16 v[44:45], v2 offset:160
    v_mfma_f32_16x16x32_bf16 v[92:95], v[16:19], v[52:55], 0
    ds_read_b64_tr_b16 v[46:47], v2 offset:1696
    v_mfma_f32_16x16x32_bf16 v[140:143], v[20:23], v[52:55], 0
    ds_read_b64_tr_b16 v[48:49], v2 offset:192
    v_mfma_f32_16x16x32_bf16 v[136:139], v[20:23], v[72:75], 0
    ds_read_b64_tr_b16 v[50:51], v2 offset:1728
    v_mfma_f32_16x16x32_bf16 v[184:187], v[24:27], v[72:75], 0
    ds_read_b64_tr_b16 v[64:65], v2 offset:224
    v_mfma_f32_16x16x32_bf16 v[188:191], v[24:27], v[52:55], 0
    s_add_u32 s39, s34, 24576
    ds_read_b64_tr_b16 v[66:67], v2 offset:1760
    v_mfma_f32_16x16x32_bf16 a[252:255], v[28:31], v[52:55], 0
    s_add_u32 m0, s35, 100608
    v_mfma_f32_16x16x32_bf16 a[248:251], v[28:31], v[72:75], 0
    buffer_load_dwordx4 v3, s[16:19], s39 offen offset:0 nt lds
    v_mfma_f32_16x16x32_bf16 a[200:203], v[32:35], v[72:75], 0
    v_mfma_f32_16x16x32_bf16 a[204:207], v[32:35], v[52:55], 0
    buffer_load_dwordx4 v3, s[16:19], s39 offen offset:1024 nt lds
    v_mfma_f32_16x16x32_bf16 a[156:159], v[36:39], v[52:55], 0
    v_mfma_f32_16x16x32_bf16 a[152:155], v[36:39], v[72:75], 0
    s_waitcnt lgkmcnt(2)
    v_add_u32 v1, s37, v1
    v_mfma_f32_16x16x32_bf16 v[96:99], v[16:19], v[40:43], 0
    v_mfma_f32_16x16x32_bf16 v[100:103], v[16:19], v[44:47], 0
    ds_read_b64_tr_b16 v[56:57], v2 offset:256
    v_mfma_f32_16x16x32_bf16 v[148:151], v[20:23], v[44:47], 0
    ds_read_b64_tr_b16 v[58:59], v2 offset:1792
    v_mfma_f32_16x16x32_bf16 v[144:147], v[20:23], v[40:43], 0
    ds_read_b64_tr_b16 v[60:61], v2 offset:288
    v_mfma_f32_16x16x32_bf16 v[192:195], v[24:27], v[40:43], 0
    ds_read_b64_tr_b16 v[62:63], v2 offset:1824
    v_mfma_f32_16x16x32_bf16 v[196:199], v[24:27], v[44:47], 0
    v_mfma_f32_16x16x32_bf16 v[228:231], v[28:31], v[44:47], 0
    buffer_load_dwordx4 v3, s[16:19], s39 offen offset:2048 nt lds
    v_mfma_f32_16x16x32_bf16 v[224:227], v[28:31], v[40:43], 0
    s_add_u32 s39, s34, 24576
    v_mfma_f32_16x16x32_bf16 a[208:211], v[32:35], v[40:43], 0
    s_add_u32 m0, s35, 113184
    v_mfma_f32_16x16x32_bf16 a[212:215], v[32:35], v[44:47], 0
    buffer_load_dwordx4 v3, s[20:23], s39 offen offset:0 nt lds
    v_mfma_f32_16x16x32_bf16 a[164:167], v[36:39], v[44:47], 0
    v_mfma_f32_16x16x32_bf16 a[160:163], v[36:39], v[40:43], 0
    buffer_load_dwordx4 v3, s[20:23], s39 offen offset:1024 nt lds
    v_mfma_f32_16x16x32_bf16 v[104:107], v[16:19], v[48:51], 0
    s_waitcnt lgkmcnt(0)
    v_mfma_f32_16x16x32_bf16 v[108:111], v[16:19], v[64:67], 0
    ds_read_b64_tr_b16 v[68:69], v2 offset:320
    v_mfma_f32_16x16x32_bf16 v[156:159], v[20:23], v[64:67], 0
    ds_read_b64_tr_b16 v[70:71], v2 offset:1856
    v_mfma_f32_16x16x32_bf16 v[152:155], v[20:23], v[48:51], 0
    ds_read_b64_tr_b16 v[72:73], v2 offset:352
    v_mfma_f32_16x16x32_bf16 v[200:203], v[24:27], v[48:51], 0
    ds_read_b64_tr_b16 v[74:75], v2 offset:1888
    v_mfma_f32_16x16x32_bf16 v[204:207], v[24:27], v[64:67], 0
    v_mfma_f32_16x16x32_bf16 v[236:239], v[28:31], v[64:67], 0
    s_waitcnt vmcnt(8)
    s_barrier
    v_mfma_f32_16x16x32_bf16 v[232:235], v[28:31], v[48:51], 0
    v_mfma_f32_16x16x32_bf16 a[216:219], v[32:35], v[48:51], 0
    v_add_u32 v2, s37, v2
    v_mfma_f32_16x16x32_bf16 a[220:223], v[32:35], v[64:67], 0
    v_mfma_f32_16x16x32_bf16 a[172:175], v[36:39], v[64:67], 0
    buffer_load_dwordx4 v3, s[20:23], s39 offen offset:2048 nt lds
    v_mfma_f32_16x16x32_bf16 a[168:171], v[36:39], v[48:51], 0
    v_mfma_f32_16x16x32_bf16 v[112:115], v[16:19], v[56:59], 0
    v_mfma_f32_16x16x32_bf16 v[116:119], v[16:19], v[60:63], 0
    ds_read_b128 v[40:43], v1 offset:0
    v_mfma_f32_16x16x32_bf16 v[164:167], v[20:23], v[60:63], 0
    ds_read_b128 v[44:47], v1 offset:64
    v_mfma_f32_16x16x32_bf16 v[160:163], v[20:23], v[56:59], 0
    ds_read_b128 v[52:55], v1 offset:192
    v_mfma_f32_16x16x32_bf16 v[208:211], v[24:27], v[56:59], 0
    ds_read_b128 v[48:51], v1 offset:128
    v_mfma_f32_16x16x32_bf16 v[212:215], v[24:27], v[60:63], 0
    v_mfma_f32_16x16x32_bf16 v[244:247], v[28:31], v[60:63], 0
    v_mfma_f32_16x16x32_bf16 v[240:243], v[28:31], v[56:59], 0
    v_mfma_f32_16x16x32_bf16 a[224:227], v[32:35], v[56:59], 0
    v_mfma_f32_16x16x32_bf16 a[228:231], v[32:35], v[60:63], 0
    v_mfma_f32_16x16x32_bf16 a[180:183], v[36:39], v[60:63], 0
    v_mfma_f32_16x16x32_bf16 a[176:179], v[36:39], v[56:59], 0
    s_waitcnt lgkmcnt(1)
    v_mfma_f32_16x16x32_bf16 v[120:123], v[16:19], v[68:71], 0
    ds_read_b128 v[56:59], v1 offset:256
    v_mfma_f32_16x16x32_bf16 v[124:127], v[16:19], v[72:75], 0
    ds_read_b128 v[60:63], v1 offset:320
    v_mfma_f32_16x16x32_bf16 v[172:175], v[20:23], v[72:75], 0
    v_mfma_f32_16x16x32_bf16 v[168:171], v[20:23], v[68:71], 0
    v_mfma_f32_16x16x32_bf16 v[216:219], v[24:27], v[68:71], 0
    v_mfma_f32_16x16x32_bf16 v[220:223], v[24:27], v[72:75], 0
    v_mfma_f32_16x16x32_bf16 v[252:255], v[28:31], v[72:75], 0
    v_mfma_f32_16x16x32_bf16 v[248:251], v[28:31], v[68:71], 0
    v_mfma_f32_16x16x32_bf16 a[232:235], v[32:35], v[68:71], 0
    v_mfma_f32_16x16x32_bf16 a[236:239], v[32:35], v[72:75], 0
    v_mfma_f32_16x16x32_bf16 a[188:191], v[36:39], v[72:75], 0
    v_mfma_f32_16x16x32_bf16 a[184:187], v[36:39], v[68:71], 0
    s_waitcnt lgkmcnt(0)
    v_mfma_f32_16x16x32_bf16 v[16:19], v[40:43], a[0:3], -4.0
    ds_read_b128 v[64:67], v1 offset:1536
    v_mfma_f32_16x16x32_bf16 v[16:19], v[44:47], a[4:7], v[16:19]
    ds_read_b128 v[68:71], v1 offset:1600
    v_mfma_f32_16x16x32_bf16 v[16:19], v[48:51], a[8:11], v[16:19]
    ds_read_b128 v[72:75], v1 offset:1664
    v_mfma_f32_16x16x32_bf16 v[16:19], v[52:55], a[12:15], v[16:19]
    v_mfma_f32_16x16x32_bf16 v[16:19], v[56:59], a[16:19], v[16:19]
    v_mfma_f32_16x16x32_bf16 v[16:19], v[60:63], a[20:23], v[16:19]
    s_nop 1
    v_mfma_f32_16x16x32_bf16 v[20:23], v[40:43], a[24:27], -4.0
    s_nop 0
    v_mfma_f32_16x16x32_bf16 v[20:23], v[44:47], a[28:31], v[20:23]
    s_nop 0
    v_mfma_f32_16x16x32_bf16 v[20:23], v[48:51], a[32:35], v[20:23]
    s_nop 0
    v_exp_f32 v16, v16
    v_mfma_f32_16x16x32_bf16 v[20:23], v[52:55], a[36:39], v[20:23]
    v_exp_f32 v17, v17
    v_mfma_f32_16x16x32_bf16 v[20:23], v[56:59], a[40:43], v[20:23]
    v_exp_f32 v18, v18
    v_mfma_f32_16x16x32_bf16 v[20:23], v[60:63], a[44:47], v[20:23]
    s_nop 0
    v_exp_f32 v19, v19
    v_mfma_f32_16x16x32_bf16 v[24:27], v[40:43], a[48:51], -4.0
    s_nop 0
    v_cvt_pk_bf16_f32 v16, v16, v17
    v_cvt_pk_bf16_f32 v17, v18, v19
    v_mfma_f32_16x16x32_bf16 v[24:27], v[44:47], a[52:55], v[24:27]
    v_mfma_f32_16x16x32_bf16 v[24:27], v[48:51], a[56:59], v[24:27]
    v_exp_f32 v20, v20
    v_mfma_f32_16x16x32_bf16 v[24:27], v[52:55], a[60:63], v[24:27]
    v_exp_f32 v21, v21
    v_mfma_f32_16x16x32_bf16 v[24:27], v[56:59], a[64:67], v[24:27]
    v_exp_f32 v22, v22
    v_mfma_f32_16x16x32_bf16 v[24:27], v[60:63], a[68:71], v[24:27]
    s_nop 0
    v_exp_f32 v23, v23
    v_mfma_f32_16x16x32_bf16 v[28:31], v[40:43], a[72:75], -4.0
    s_nop 0
    v_cvt_pk_bf16_f32 v20, v20, v21
    v_cvt_pk_bf16_f32 v21, v22, v23
    v_mfma_f32_16x16x32_bf16 v[28:31], v[44:47], a[76:79], v[28:31]
    v_mfma_f32_16x16x32_bf16 v[28:31], v[48:51], a[80:83], v[28:31]
    v_exp_f32 v24, v24
    v_mfma_f32_16x16x32_bf16 v[28:31], v[52:55], a[84:87], v[28:31]
    v_exp_f32 v25, v25
    v_mfma_f32_16x16x32_bf16 v[28:31], v[56:59], a[88:91], v[28:31]
    v_exp_f32 v26, v26
    v_mfma_f32_16x16x32_bf16 v[28:31], v[60:63], a[92:95], v[28:31]
    s_nop 0
    v_exp_f32 v27, v27
    v_mfma_f32_16x16x32_bf16 v[32:35], v[40:43], a[96:99], -4.0
    s_nop 0
    v_cvt_pk_bf16_f32 v24, v24, v25
    v_cvt_pk_bf16_f32 v25, v26, v27
    v_mfma_f32_16x16x32_bf16 v[32:35], v[44:47], a[100:103], v[32:35]
    v_mfma_f32_16x16x32_bf16 v[32:35], v[48:51], a[104:107], v[32:35]
    v_exp_f32 v28, v28
    v_mfma_f32_16x16x32_bf16 v[32:35], v[52:55], a[108:111], v[32:35]
    v_exp_f32 v29, v29
    v_mfma_f32_16x16x32_bf16 v[32:35], v[56:59], a[112:115], v[32:35]
    v_exp_f32 v30, v30
    v_mfma_f32_16x16x32_bf16 v[32:35], v[60:63], a[116:119], v[32:35]
    v_exp_f32 v31, v31
    v_mfma_f32_16x16x32_bf16 v[36:39], v[40:43], a[120:123], -4.0
    v_cvt_pk_bf16_f32 v28, v28, v29
    v_cvt_pk_bf16_f32 v29, v30, v31
    v_mfma_f32_16x16x32_bf16 v[36:39], v[44:47], a[124:127], v[36:39]
    ds_read_b128 v[40:43], v1 offset:1728
    ds_read_b128 v[44:47], v1 offset:1792
    v_mfma_f32_16x16x32_bf16 v[36:39], v[48:51], a[128:131], v[36:39]
    ds_read_b128 v[48:51], v1 offset:1856
    v_mfma_f32_16x16x32_bf16 v[36:39], v[52:55], a[132:135], v[36:39]
    v_exp_f32 v32, v32
    v_mfma_f32_16x16x32_bf16 v[36:39], v[56:59], a[136:139], v[36:39]
    v_exp_f32 v33, v33
    v_mfma_f32_16x16x32_bf16 v[36:39], v[60:63], a[140:143], v[36:39]
    s_waitcnt lgkmcnt(3)
    v_exp_f32 v34, v34
    v_mfma_f32_16x16x32_bf16 v[52:55], v[64:67], a[0:3], -4.0
    v_exp_f32 v35, v35
    v_mfma_f32_16x16x32_bf16 v[52:55], v[68:71], a[4:7], v[52:55]
    v_cvt_pk_bf16_f32 v32, v32, v33
    v_cvt_pk_bf16_f32 v33, v34, v35
    v_mfma_f32_16x16x32_bf16 v[52:55], v[72:75], a[8:11], v[52:55]
    s_waitcnt lgkmcnt(2)
    v_exp_f32 v36, v36
    v_mfma_f32_16x16x32_bf16 v[52:55], v[40:43], a[12:15], v[52:55]
    s_waitcnt lgkmcnt(1)
    v_exp_f32 v37, v37
    v_mfma_f32_16x16x32_bf16 v[52:55], v[44:47], a[16:19], v[52:55]
    s_waitcnt lgkmcnt(0)
    v_exp_f32 v38, v38
    v_mfma_f32_16x16x32_bf16 v[52:55], v[48:51], a[20:23], v[52:55]
    s_cmp_eq_u32 s38, 125760
    v_exp_f32 v39, v39
    v_mfma_f32_16x16x32_bf16 v[56:59], v[64:67], a[24:27], -4.0
    s_cselect_b32 s37, s44, s43
    v_cvt_pk_bf16_f32 v36, v36, v37
    v_cvt_pk_bf16_f32 v37, v38, v39
    v_mfma_f32_16x16x32_bf16 v[56:59], v[68:71], a[28:31], v[56:59]
    s_add_u32 s38, s38, s37
    v_mfma_f32_16x16x32_bf16 v[56:59], v[72:75], a[32:35], v[56:59]
    v_exp_f32 v52, v52
    v_mfma_f32_16x16x32_bf16 v[56:59], v[40:43], a[36:39], v[56:59]
    v_exp_f32 v53, v53
    v_mfma_f32_16x16x32_bf16 v[56:59], v[44:47], a[40:43], v[56:59]
    v_exp_f32 v54, v54
    v_mfma_f32_16x16x32_bf16 v[56:59], v[48:51], a[44:47], v[56:59]
    s_nop 0
    v_exp_f32 v55, v55
    v_mfma_f32_16x16x32_bf16 v[60:63], v[64:67], a[48:51], -4.0
    v_cvt_pk_bf16_f32 v18, v52, v53
    v_cvt_pk_bf16_f32 v19, v54, v55
    v_mfma_f32_16x16x32_bf16 v[60:63], v[68:71], a[52:55], v[60:63]
    v_add_u32 v1, s37, v1
    v_mfma_f32_16x16x32_bf16 v[60:63], v[72:75], a[56:59], v[60:63]
    v_exp_f32 v56, v56
    v_mfma_f32_16x16x32_bf16 v[60:63], v[40:43], a[60:63], v[60:63]
    v_exp_f32 v57, v57
    v_mfma_f32_16x16x32_bf16 v[60:63], v[44:47], a[64:67], v[60:63]
    v_exp_f32 v58, v58
    v_mfma_f32_16x16x32_bf16 v[60:63], v[48:51], a[68:71], v[60:63]
    v_exp_f32 v59, v59
    v_mfma_f32_16x16x32_bf16 v[52:55], v[64:67], a[72:75], -4.0
    v_cvt_pk_bf16_f32 v22, v56, v57
    v_cvt_pk_bf16_f32 v23, v58, v59
    v_mfma_f32_16x16x32_bf16 v[52:55], v[68:71], a[76:79], v[52:55]
    s_waitcnt vmcnt(3)
    s_barrier
    v_mfma_f32_16x16x32_bf16 v[52:55], v[72:75], a[80:83], v[52:55]
    v_exp_f32 v60, v60
    v_mfma_f32_16x16x32_bf16 v[52:55], v[40:43], a[84:87], v[52:55]
    v_exp_f32 v61, v61
    v_mfma_f32_16x16x32_bf16 v[52:55], v[44:47], a[88:91], v[52:55]
    v_exp_f32 v62, v62
    v_mfma_f32_16x16x32_bf16 v[52:55], v[48:51], a[92:95], v[52:55]
    s_nop 0
    v_exp_f32 v63, v63
    v_mfma_f32_16x16x32_bf16 v[56:59], v[64:67], a[96:99], -4.0
    s_nop 0
    v_cvt_pk_bf16_f32 v26, v60, v61
    v_cvt_pk_bf16_f32 v27, v62, v63
    v_mfma_f32_16x16x32_bf16 v[56:59], v[68:71], a[100:103], v[56:59]
    v_mfma_f32_16x16x32_bf16 v[56:59], v[72:75], a[104:107], v[56:59]
    v_exp_f32 v52, v52
    v_mfma_f32_16x16x32_bf16 v[56:59], v[40:43], a[108:111], v[56:59]
    v_exp_f32 v53, v53
    v_mfma_f32_16x16x32_bf16 v[56:59], v[44:47], a[112:115], v[56:59]
    v_exp_f32 v54, v54
    v_mfma_f32_16x16x32_bf16 v[56:59], v[48:51], a[116:119], v[56:59]
    v_exp_f32 v55, v55
    v_mfma_f32_16x16x32_bf16 v[60:63], v[64:67], a[120:123], -4.0
    v_cvt_pk_bf16_f32 v30, v52, v53
    v_cvt_pk_bf16_f32 v31, v54, v55
    v_mfma_f32_16x16x32_bf16 v[60:63], v[68:71], a[124:127], v[60:63]
    ds_read_b64_tr_b16 v[64:65], v2 offset:0
    ds_read_b64_tr_b16 v[66:67], v2 offset:1536
    v_mfma_f32_16x16x32_bf16 v[60:63], v[72:75], a[128:131], v[60:63]
    v_exp_f32 v56, v56
    v_mfma_f32_16x16x32_bf16 v[60:63], v[40:43], a[132:135], v[60:63]
    v_exp_f32 v57, v57
    v_mfma_f32_16x16x32_bf16 v[60:63], v[44:47], a[136:139], v[60:63]
    v_exp_f32 v58, v58
    v_mfma_f32_16x16x32_bf16 v[60:63], v[48:51], a[140:143], v[60:63]
    v_exp_f32 v59, v59
    v_smfmac_f32_16x16x64_bf16 v[4:7], v[12:15], v[16:23], v0
    v_cvt_pk_bf16_f32 v34, v56, v57
    v_cvt_pk_bf16_f32 v35, v58, v59
    v_smfmac_f32_16x16x64_bf16 v[8:11], v[12:15], v[24:31], v0
    s_waitcnt lgkmcnt(0)
    ds_read_b64_tr_b16 v[68:69], v2 offset:32
    ds_read_b64_tr_b16 v[70:71], v2 offset:1568
    v_mfma_f32_16x16x32_bf16 v[80:83], v[16:19], v[64:67], v[80:83]
    v_exp_f32 v60, v60
    v_mfma_f32_16x16x32_bf16 v[128:131], v[20:23], v[64:67], v[128:131]
    v_exp_f32 v61, v61
    v_mfma_f32_16x16x32_bf16 v[176:179], v[24:27], v[64:67], v[176:179]
    v_exp_f32 v62, v62
    v_mfma_f32_16x16x32_bf16 a[240:243], v[28:31], v[64:67], a[240:243]
    v_exp_f32 v63, v63
    v_mfma_f32_16x16x32_bf16 a[192:195], v[32:35], v[64:67], a[192:195]
    s_waitcnt lgkmcnt(0)
    v_cvt_pk_bf16_f32 v38, v60, v61
    v_cvt_pk_bf16_f32 v39, v62, v63
    v_mfma_f32_16x16x32_bf16 a[196:199], v[32:35], v[68:71], a[196:199]
    ds_read_b64_tr_b16 v[72:73], v2 offset:64
    v_mfma_f32_16x16x32_bf16 a[244:247], v[28:31], v[68:71], a[244:247]
    ds_read_b64_tr_b16 v[74:75], v2 offset:1600
    v_mfma_f32_16x16x32_bf16 v[180:183], v[24:27], v[68:71], v[180:183]
    ds_read_b64_tr_b16 v[52:53], v2 offset:96
    v_mfma_f32_16x16x32_bf16 v[132:135], v[20:23], v[68:71], v[132:135]
    ds_read_b64_tr_b16 v[54:55], v2 offset:1632
    v_mfma_f32_16x16x32_bf16 v[84:87], v[16:19], v[68:71], v[84:87]
    s_add_u32 s39, s34, 36864
    ds_read_b64_tr_b16 v[40:41], v2 offset:128
    v_mfma_f32_16x16x32_bf16 a[148:151], v[36:39], v[68:71], a[148:151]
    s_add_u32 m0, s35, 125760
    ds_read_b64_tr_b16 v[42:43], v2 offset:1664
    v_mfma_f32_16x16x32_bf16 a[144:147], v[36:39], v[64:67], a[144:147]
    buffer_load_dwordx4 v3, s[16:19], s39 offen offset:0 nt lds
    v_smfmac_f32_16x16x64_bf16 v[76:79], v[12:15], v[32:39], v0
    s_waitcnt lgkmcnt(4)
    v_mfma_f32_16x16x32_bf16 v[88:91], v[16:19], v[72:75], v[88:91]
    s_waitcnt lgkmcnt(2)
    ds_read_b64_tr_b16 v[44:45], v2 offset:160
    v_mfma_f32_16x16x32_bf16 v[92:95], v[16:19], v[52:55], v[92:95]
    ds_read_b64_tr_b16 v[46:47], v2 offset:1696
    v_mfma_f32_16x16x32_bf16 v[140:143], v[20:23], v[52:55], v[140:143]
    ds_read_b64_tr_b16 v[48:49], v2 offset:192
    v_mfma_f32_16x16x32_bf16 v[136:139], v[20:23], v[72:75], v[136:139]
    ds_read_b64_tr_b16 v[50:51], v2 offset:1728
    v_mfma_f32_16x16x32_bf16 v[184:187], v[24:27], v[72:75], v[184:187]
    ds_read_b64_tr_b16 v[64:65], v2 offset:224
    v_mfma_f32_16x16x32_bf16 v[188:191], v[24:27], v[52:55], v[188:191]
    ds_read_b64_tr_b16 v[66:67], v2 offset:1760
    v_mfma_f32_16x16x32_bf16 a[252:255], v[28:31], v[52:55], a[252:255]
    buffer_load_dwordx4 v3, s[16:19], s39 offen offset:1024 nt lds
    v_mfma_f32_16x16x32_bf16 a[248:251], v[28:31], v[72:75], a[248:251]
    v_mfma_f32_16x16x32_bf16 a[200:203], v[32:35], v[72:75], a[200:203]
    buffer_load_dwordx4 v3, s[16:19], s39 offen offset:2048 nt lds
    v_mfma_f32_16x16x32_bf16 a[204:207], v[32:35], v[52:55], a[204:207]
    s_add_u32 s39, s34, 36864
    v_mfma_f32_16x16x32_bf16 a[156:159], v[36:39], v[52:55], a[156:159]
    s_add_u32 m0, s35, 138336
    v_mfma_f32_16x16x32_bf16 a[152:155], v[36:39], v[72:75], a[152:155]
    s_waitcnt lgkmcnt(2)
    v_mfma_f32_16x16x32_bf16 v[96:99], v[16:19], v[40:43], v[96:99]
    buffer_load_dwordx4 v3, s[20:23], s39 offen offset:0 nt lds
    v_mfma_f32_16x16x32_bf16 v[100:103], v[16:19], v[44:47], v[100:103]
    ds_read_b64_tr_b16 v[56:57], v2 offset:256
    v_mfma_f32_16x16x32_bf16 v[148:151], v[20:23], v[44:47], v[148:151]
    ds_read_b64_tr_b16 v[58:59], v2 offset:1792
    v_mfma_f32_16x16x32_bf16 v[144:147], v[20:23], v[40:43], v[144:147]
    ds_read_b64_tr_b16 v[60:61], v2 offset:288
    v_mfma_f32_16x16x32_bf16 v[192:195], v[24:27], v[40:43], v[192:195]
    ds_read_b64_tr_b16 v[62:63], v2 offset:1824
    v_mfma_f32_16x16x32_bf16 v[196:199], v[24:27], v[44:47], v[196:199]
    v_mfma_f32_16x16x32_bf16 v[228:231], v[28:31], v[44:47], v[228:231]
    buffer_load_dwordx4 v3, s[20:23], s39 offen offset:1024 nt lds
    v_mfma_f32_16x16x32_bf16 v[224:227], v[28:31], v[40:43], v[224:227]
    v_mfma_f32_16x16x32_bf16 a[208:211], v[32:35], v[40:43], a[208:211]
    buffer_load_dwordx4 v3, s[20:23], s39 offen offset:2048 nt lds
    v_mfma_f32_16x16x32_bf16 a[212:215], v[32:35], v[44:47], a[212:215]
    v_mfma_f32_16x16x32_bf16 a[164:167], v[36:39], v[44:47], a[164:167]
    s_add_u32 s39, s34, 49152
    v_mfma_f32_16x16x32_bf16 a[160:163], v[36:39], v[40:43], a[160:163]
    s_add_u32 m0, s35, 0
    v_mfma_f32_16x16x32_bf16 v[104:107], v[16:19], v[48:51], v[104:107]
    s_waitcnt lgkmcnt(0)
    buffer_load_dwordx4 v3, s[16:19], s39 offen offset:0 nt lds
    v_mfma_f32_16x16x32_bf16 v[108:111], v[16:19], v[64:67], v[108:111]
    ds_read_b64_tr_b16 v[68:69], v2 offset:320
    v_mfma_f32_16x16x32_bf16 v[156:159], v[20:23], v[64:67], v[156:159]
    ds_read_b64_tr_b16 v[70:71], v2 offset:1856
    v_mfma_f32_16x16x32_bf16 v[152:155], v[20:23], v[48:51], v[152:155]
    ds_read_b64_tr_b16 v[72:73], v2 offset:352
    v_mfma_f32_16x16x32_bf16 v[200:203], v[24:27], v[48:51], v[200:203]
    ds_read_b64_tr_b16 v[74:75], v2 offset:1888
    v_mfma_f32_16x16x32_bf16 v[204:207], v[24:27], v[64:67], v[204:207]
    v_mfma_f32_16x16x32_bf16 v[236:239], v[28:31], v[64:67], v[236:239]
    v_mfma_f32_16x16x32_bf16 v[232:235], v[28:31], v[48:51], v[232:235]
    buffer_load_dwordx4 v3, s[16:19], s39 offen offset:1024 nt lds
    v_mfma_f32_16x16x32_bf16 a[216:219], v[32:35], v[48:51], a[216:219]
    v_add_u32 v2, s37, v2
    v_mfma_f32_16x16x32_bf16 a[220:223], v[32:35], v[64:67], a[220:223]
    v_mfma_f32_16x16x32_bf16 a[172:175], v[36:39], v[64:67], a[172:175]
    buffer_load_dwordx4 v3, s[16:19], s39 offen offset:2048 nt lds
    v_mfma_f32_16x16x32_bf16 a[168:171], v[36:39], v[48:51], a[168:171]
    v_mfma_f32_16x16x32_bf16 v[112:115], v[16:19], v[56:59], v[112:115]
    v_mfma_f32_16x16x32_bf16 v[116:119], v[16:19], v[60:63], v[116:119]
    ds_read_b128 v[40:43], v1 offset:0
    v_mfma_f32_16x16x32_bf16 v[164:167], v[20:23], v[60:63], v[164:167]
    ds_read_b128 v[44:47], v1 offset:64
    v_mfma_f32_16x16x32_bf16 v[160:163], v[20:23], v[56:59], v[160:163]
    ds_read_b128 v[52:55], v1 offset:192
    v_mfma_f32_16x16x32_bf16 v[208:211], v[24:27], v[56:59], v[208:211]
    ds_read_b128 v[48:51], v1 offset:128
    v_mfma_f32_16x16x32_bf16 v[212:215], v[24:27], v[60:63], v[212:215]
    v_mfma_f32_16x16x32_bf16 v[244:247], v[28:31], v[60:63], v[244:247]
    v_mfma_f32_16x16x32_bf16 v[240:243], v[28:31], v[56:59], v[240:243]
    v_mfma_f32_16x16x32_bf16 a[224:227], v[32:35], v[56:59], a[224:227]
    v_mfma_f32_16x16x32_bf16 a[228:231], v[32:35], v[60:63], a[228:231]
    v_mfma_f32_16x16x32_bf16 a[180:183], v[36:39], v[60:63], a[180:183]
    v_mfma_f32_16x16x32_bf16 a[176:179], v[36:39], v[56:59], a[176:179]
    s_waitcnt lgkmcnt(1)
    v_mfma_f32_16x16x32_bf16 v[120:123], v[16:19], v[68:71], v[120:123]
    ds_read_b128 v[56:59], v1 offset:256
    v_mfma_f32_16x16x32_bf16 v[124:127], v[16:19], v[72:75], v[124:127]
    ds_read_b128 v[60:63], v1 offset:320
    v_mfma_f32_16x16x32_bf16 v[172:175], v[20:23], v[72:75], v[172:175]
    v_mfma_f32_16x16x32_bf16 v[168:171], v[20:23], v[68:71], v[168:171]
    v_mfma_f32_16x16x32_bf16 v[216:219], v[24:27], v[68:71], v[216:219]
    v_mfma_f32_16x16x32_bf16 v[220:223], v[24:27], v[72:75], v[220:223]
    v_mfma_f32_16x16x32_bf16 v[252:255], v[28:31], v[72:75], v[252:255]
    v_mfma_f32_16x16x32_bf16 v[248:251], v[28:31], v[68:71], v[248:251]
    v_mfma_f32_16x16x32_bf16 a[232:235], v[32:35], v[68:71], a[232:235]
    v_mfma_f32_16x16x32_bf16 a[236:239], v[32:35], v[72:75], a[236:239]
    v_mfma_f32_16x16x32_bf16 a[188:191], v[36:39], v[72:75], a[188:191]
    v_mfma_f32_16x16x32_bf16 a[184:187], v[36:39], v[68:71], a[184:187]
    s_waitcnt lgkmcnt(0)
    v_mfma_f32_16x16x32_bf16 v[16:19], v[40:43], a[0:3], -4.0
    ds_read_b128 v[64:67], v1 offset:1536
    v_mfma_f32_16x16x32_bf16 v[16:19], v[44:47], a[4:7], v[16:19]
    ds_read_b128 v[68:71], v1 offset:1600
    v_mfma_f32_16x16x32_bf16 v[16:19], v[48:51], a[8:11], v[16:19]
    ds_read_b128 v[72:75], v1 offset:1664
    v_mfma_f32_16x16x32_bf16 v[16:19], v[52:55], a[12:15], v[16:19]
    v_mfma_f32_16x16x32_bf16 v[16:19], v[56:59], a[16:19], v[16:19]
    v_mfma_f32_16x16x32_bf16 v[16:19], v[60:63], a[20:23], v[16:19]
    s_nop 1
    v_mfma_f32_16x16x32_bf16 v[20:23], v[40:43], a[24:27], -4.0
    s_nop 0
    v_mfma_f32_16x16x32_bf16 v[20:23], v[44:47], a[28:31], v[20:23]
    s_nop 0
    v_mfma_f32_16x16x32_bf16 v[20:23], v[48:51], a[32:35], v[20:23]
    s_nop 0
    v_exp_f32 v16, v16
    v_mfma_f32_16x16x32_bf16 v[20:23], v[52:55], a[36:39], v[20:23]
    v_exp_f32 v17, v17
    v_mfma_f32_16x16x32_bf16 v[20:23], v[56:59], a[40:43], v[20:23]
    v_exp_f32 v18, v18
    v_mfma_f32_16x16x32_bf16 v[20:23], v[60:63], a[44:47], v[20:23]
    s_nop 0
    v_exp_f32 v19, v19
    v_mfma_f32_16x16x32_bf16 v[24:27], v[40:43], a[48:51], -4.0
    s_nop 0
    v_cvt_pk_bf16_f32 v16, v16, v17
    v_cvt_pk_bf16_f32 v17, v18, v19
    v_mfma_f32_16x16x32_bf16 v[24:27], v[44:47], a[52:55], v[24:27]
    v_mfma_f32_16x16x32_bf16 v[24:27], v[48:51], a[56:59], v[24:27]
    v_exp_f32 v20, v20
    v_mfma_f32_16x16x32_bf16 v[24:27], v[52:55], a[60:63], v[24:27]
    v_exp_f32 v21, v21
    v_mfma_f32_16x16x32_bf16 v[24:27], v[56:59], a[64:67], v[24:27]
    v_exp_f32 v22, v22
    v_mfma_f32_16x16x32_bf16 v[24:27], v[60:63], a[68:71], v[24:27]
    s_nop 0
    v_exp_f32 v23, v23
    v_mfma_f32_16x16x32_bf16 v[28:31], v[40:43], a[72:75], -4.0
    s_nop 0
    v_cvt_pk_bf16_f32 v20, v20, v21
    v_cvt_pk_bf16_f32 v21, v22, v23
    v_mfma_f32_16x16x32_bf16 v[28:31], v[44:47], a[76:79], v[28:31]
    v_mfma_f32_16x16x32_bf16 v[28:31], v[48:51], a[80:83], v[28:31]
    v_exp_f32 v24, v24
    v_mfma_f32_16x16x32_bf16 v[28:31], v[52:55], a[84:87], v[28:31]
    v_exp_f32 v25, v25
    v_mfma_f32_16x16x32_bf16 v[28:31], v[56:59], a[88:91], v[28:31]
    v_exp_f32 v26, v26
    v_mfma_f32_16x16x32_bf16 v[28:31], v[60:63], a[92:95], v[28:31]
    s_nop 0
    v_exp_f32 v27, v27
    v_mfma_f32_16x16x32_bf16 v[32:35], v[40:43], a[96:99], -4.0
    s_nop 0
    v_cvt_pk_bf16_f32 v24, v24, v25
    v_cvt_pk_bf16_f32 v25, v26, v27
    v_mfma_f32_16x16x32_bf16 v[32:35], v[44:47], a[100:103], v[32:35]
    v_mfma_f32_16x16x32_bf16 v[32:35], v[48:51], a[104:107], v[32:35]
    v_exp_f32 v28, v28
    v_mfma_f32_16x16x32_bf16 v[32:35], v[52:55], a[108:111], v[32:35]
    v_exp_f32 v29, v29
    v_mfma_f32_16x16x32_bf16 v[32:35], v[56:59], a[112:115], v[32:35]
    v_exp_f32 v30, v30
    v_mfma_f32_16x16x32_bf16 v[32:35], v[60:63], a[116:119], v[32:35]
    v_exp_f32 v31, v31
    v_mfma_f32_16x16x32_bf16 v[36:39], v[40:43], a[120:123], -4.0
    v_cvt_pk_bf16_f32 v28, v28, v29
    v_cvt_pk_bf16_f32 v29, v30, v31
    v_mfma_f32_16x16x32_bf16 v[36:39], v[44:47], a[124:127], v[36:39]
    ds_read_b128 v[40:43], v1 offset:1728
    ds_read_b128 v[44:47], v1 offset:1792
    v_mfma_f32_16x16x32_bf16 v[36:39], v[48:51], a[128:131], v[36:39]
    ds_read_b128 v[48:51], v1 offset:1856
    v_mfma_f32_16x16x32_bf16 v[36:39], v[52:55], a[132:135], v[36:39]
    v_exp_f32 v32, v32
    v_mfma_f32_16x16x32_bf16 v[36:39], v[56:59], a[136:139], v[36:39]
    v_exp_f32 v33, v33
    v_mfma_f32_16x16x32_bf16 v[36:39], v[60:63], a[140:143], v[36:39]
    s_waitcnt lgkmcnt(3)
    v_exp_f32 v34, v34
    v_mfma_f32_16x16x32_bf16 v[52:55], v[64:67], a[0:3], -4.0
    v_exp_f32 v35, v35
    v_mfma_f32_16x16x32_bf16 v[52:55], v[68:71], a[4:7], v[52:55]
    v_cvt_pk_bf16_f32 v32, v32, v33
    v_cvt_pk_bf16_f32 v33, v34, v35
    v_mfma_f32_16x16x32_bf16 v[52:55], v[72:75], a[8:11], v[52:55]
    s_waitcnt lgkmcnt(2)
    v_exp_f32 v36, v36
    v_mfma_f32_16x16x32_bf16 v[52:55], v[40:43], a[12:15], v[52:55]
    s_waitcnt lgkmcnt(1)
    v_exp_f32 v37, v37
    v_mfma_f32_16x16x32_bf16 v[52:55], v[44:47], a[16:19], v[52:55]
    s_waitcnt lgkmcnt(0)
    v_exp_f32 v38, v38
    v_mfma_f32_16x16x32_bf16 v[52:55], v[48:51], a[20:23], v[52:55]
    s_cmp_eq_u32 s38, 125760
    v_exp_f32 v39, v39
    v_mfma_f32_16x16x32_bf16 v[56:59], v[64:67], a[24:27], -4.0
    s_cselect_b32 s37, s44, s43
    v_cvt_pk_bf16_f32 v36, v36, v37
    v_cvt_pk_bf16_f32 v37, v38, v39
    v_mfma_f32_16x16x32_bf16 v[56:59], v[68:71], a[28:31], v[56:59]
    s_add_u32 s38, s38, s37
    v_mfma_f32_16x16x32_bf16 v[56:59], v[72:75], a[32:35], v[56:59]
    v_exp_f32 v52, v52
    v_mfma_f32_16x16x32_bf16 v[56:59], v[40:43], a[36:39], v[56:59]
    v_exp_f32 v53, v53
    v_mfma_f32_16x16x32_bf16 v[56:59], v[44:47], a[40:43], v[56:59]
    v_exp_f32 v54, v54
    v_mfma_f32_16x16x32_bf16 v[56:59], v[48:51], a[44:47], v[56:59]
    s_nop 0
    v_exp_f32 v55, v55
    v_mfma_f32_16x16x32_bf16 v[60:63], v[64:67], a[48:51], -4.0
    v_cvt_pk_bf16_f32 v18, v52, v53
    v_cvt_pk_bf16_f32 v19, v54, v55
    v_mfma_f32_16x16x32_bf16 v[60:63], v[68:71], a[52:55], v[60:63]
    v_add_u32 v1, s37, v1
    v_mfma_f32_16x16x32_bf16 v[60:63], v[72:75], a[56:59], v[60:63]
    v_exp_f32 v56, v56
    v_mfma_f32_16x16x32_bf16 v[60:63], v[40:43], a[60:63], v[60:63]
    v_exp_f32 v57, v57
    v_mfma_f32_16x16x32_bf16 v[60:63], v[44:47], a[64:67], v[60:63]
    v_exp_f32 v58, v58
    v_mfma_f32_16x16x32_bf16 v[60:63], v[48:51], a[68:71], v[60:63]
    v_exp_f32 v59, v59
    v_mfma_f32_16x16x32_bf16 v[52:55], v[64:67], a[72:75], -4.0
    v_cvt_pk_bf16_f32 v22, v56, v57
    v_cvt_pk_bf16_f32 v23, v58, v59
    v_mfma_f32_16x16x32_bf16 v[52:55], v[68:71], a[76:79], v[52:55]
    s_waitcnt vmcnt(6)
    s_barrier
    v_mfma_f32_16x16x32_bf16 v[52:55], v[72:75], a[80:83], v[52:55]
    v_exp_f32 v60, v60
    v_mfma_f32_16x16x32_bf16 v[52:55], v[40:43], a[84:87], v[52:55]
    v_exp_f32 v61, v61
    v_mfma_f32_16x16x32_bf16 v[52:55], v[44:47], a[88:91], v[52:55]
    v_exp_f32 v62, v62
    v_mfma_f32_16x16x32_bf16 v[52:55], v[48:51], a[92:95], v[52:55]
    s_nop 0
    v_exp_f32 v63, v63
    v_mfma_f32_16x16x32_bf16 v[56:59], v[64:67], a[96:99], -4.0
    s_nop 0
    v_cvt_pk_bf16_f32 v26, v60, v61
    v_cvt_pk_bf16_f32 v27, v62, v63
    v_mfma_f32_16x16x32_bf16 v[56:59], v[68:71], a[100:103], v[56:59]
    v_mfma_f32_16x16x32_bf16 v[56:59], v[72:75], a[104:107], v[56:59]
    v_exp_f32 v52, v52
    v_mfma_f32_16x16x32_bf16 v[56:59], v[40:43], a[108:111], v[56:59]
    v_exp_f32 v53, v53
    v_mfma_f32_16x16x32_bf16 v[56:59], v[44:47], a[112:115], v[56:59]
    v_exp_f32 v54, v54
    v_mfma_f32_16x16x32_bf16 v[56:59], v[48:51], a[116:119], v[56:59]
    v_exp_f32 v55, v55
    v_mfma_f32_16x16x32_bf16 v[60:63], v[64:67], a[120:123], -4.0
    v_cvt_pk_bf16_f32 v30, v52, v53
    v_cvt_pk_bf16_f32 v31, v54, v55
    v_mfma_f32_16x16x32_bf16 v[60:63], v[68:71], a[124:127], v[60:63]
    ds_read_b64_tr_b16 v[64:65], v2 offset:0
    ds_read_b64_tr_b16 v[66:67], v2 offset:1536
    v_mfma_f32_16x16x32_bf16 v[60:63], v[72:75], a[128:131], v[60:63]
    v_exp_f32 v56, v56
    v_mfma_f32_16x16x32_bf16 v[60:63], v[40:43], a[132:135], v[60:63]
    v_exp_f32 v57, v57
    v_mfma_f32_16x16x32_bf16 v[60:63], v[44:47], a[136:139], v[60:63]
    v_exp_f32 v58, v58
    v_mfma_f32_16x16x32_bf16 v[60:63], v[48:51], a[140:143], v[60:63]
    v_exp_f32 v59, v59
    v_smfmac_f32_16x16x64_bf16 v[4:7], v[12:15], v[16:23], v0
    v_cvt_pk_bf16_f32 v34, v56, v57
    v_cvt_pk_bf16_f32 v35, v58, v59
    v_smfmac_f32_16x16x64_bf16 v[8:11], v[12:15], v[24:31], v0
    s_waitcnt lgkmcnt(0)
    ds_read_b64_tr_b16 v[68:69], v2 offset:32
    ds_read_b64_tr_b16 v[70:71], v2 offset:1568
    v_mfma_f32_16x16x32_bf16 v[80:83], v[16:19], v[64:67], v[80:83]
    v_exp_f32 v60, v60
    v_mfma_f32_16x16x32_bf16 v[128:131], v[20:23], v[64:67], v[128:131]
    v_exp_f32 v61, v61
    v_mfma_f32_16x16x32_bf16 v[176:179], v[24:27], v[64:67], v[176:179]
    v_exp_f32 v62, v62
    v_mfma_f32_16x16x32_bf16 a[240:243], v[28:31], v[64:67], a[240:243]
    v_exp_f32 v63, v63
    v_mfma_f32_16x16x32_bf16 a[192:195], v[32:35], v[64:67], a[192:195]
    s_waitcnt lgkmcnt(0)
    v_cvt_pk_bf16_f32 v38, v60, v61
    v_cvt_pk_bf16_f32 v39, v62, v63
    v_mfma_f32_16x16x32_bf16 a[196:199], v[32:35], v[68:71], a[196:199]
    ds_read_b64_tr_b16 v[72:73], v2 offset:64
    v_mfma_f32_16x16x32_bf16 a[244:247], v[28:31], v[68:71], a[244:247]
    ds_read_b64_tr_b16 v[74:75], v2 offset:1600
    v_mfma_f32_16x16x32_bf16 v[180:183], v[24:27], v[68:71], v[180:183]
    ds_read_b64_tr_b16 v[52:53], v2 offset:96
    v_mfma_f32_16x16x32_bf16 v[132:135], v[20:23], v[68:71], v[132:135]
    ds_read_b64_tr_b16 v[54:55], v2 offset:1632
    v_mfma_f32_16x16x32_bf16 v[84:87], v[16:19], v[68:71], v[84:87]
    s_add_u32 s39, s34, 49152
    ds_read_b64_tr_b16 v[40:41], v2 offset:128
    v_mfma_f32_16x16x32_bf16 a[148:151], v[36:39], v[68:71], a[148:151]
    s_add_u32 m0, s35, 12576
    ds_read_b64_tr_b16 v[42:43], v2 offset:1664
    v_mfma_f32_16x16x32_bf16 a[144:147], v[36:39], v[64:67], a[144:147]
    buffer_load_dwordx4 v3, s[20:23], s39 offen offset:0 nt lds
    v_smfmac_f32_16x16x64_bf16 v[76:79], v[12:15], v[32:39], v0
    s_waitcnt lgkmcnt(4)
    v_mfma_f32_16x16x32_bf16 v[88:91], v[16:19], v[72:75], v[88:91]
    s_waitcnt lgkmcnt(2)
    ds_read_b64_tr_b16 v[44:45], v2 offset:160
    v_mfma_f32_16x16x32_bf16 v[92:95], v[16:19], v[52:55], v[92:95]
    ds_read_b64_tr_b16 v[46:47], v2 offset:1696
    v_mfma_f32_16x16x32_bf16 v[140:143], v[20:23], v[52:55], v[140:143]
    ds_read_b64_tr_b16 v[48:49], v2 offset:192
    v_mfma_f32_16x16x32_bf16 v[136:139], v[20:23], v[72:75], v[136:139]
    ds_read_b64_tr_b16 v[50:51], v2 offset:1728
    v_mfma_f32_16x16x32_bf16 v[184:187], v[24:27], v[72:75], v[184:187]
    ds_read_b64_tr_b16 v[64:65], v2 offset:224
    v_mfma_f32_16x16x32_bf16 v[188:191], v[24:27], v[52:55], v[188:191]
    ds_read_b64_tr_b16 v[66:67], v2 offset:1760
    v_mfma_f32_16x16x32_bf16 a[252:255], v[28:31], v[52:55], a[252:255]
    buffer_load_dwordx4 v3, s[20:23], s39 offen offset:1024 nt lds
    v_mfma_f32_16x16x32_bf16 a[248:251], v[28:31], v[72:75], a[248:251]
    v_mfma_f32_16x16x32_bf16 a[200:203], v[32:35], v[72:75], a[200:203]
    buffer_load_dwordx4 v3, s[20:23], s39 offen offset:2048 nt lds
    v_mfma_f32_16x16x32_bf16 a[204:207], v[32:35], v[52:55], a[204:207]
    s_add_u32 s39, s34, 61440
    v_mfma_f32_16x16x32_bf16 a[156:159], v[36:39], v[52:55], a[156:159]
    s_add_u32 m0, s35, 25152
    v_mfma_f32_16x16x32_bf16 a[152:155], v[36:39], v[72:75], a[152:155]
    s_waitcnt lgkmcnt(2)
    v_mfma_f32_16x16x32_bf16 v[96:99], v[16:19], v[40:43], v[96:99]
    buffer_load_dwordx4 v3, s[16:19], s39 offen offset:0 nt lds
    v_mfma_f32_16x16x32_bf16 v[100:103], v[16:19], v[44:47], v[100:103]
    ds_read_b64_tr_b16 v[56:57], v2 offset:256
    v_mfma_f32_16x16x32_bf16 v[148:151], v[20:23], v[44:47], v[148:151]
    ds_read_b64_tr_b16 v[58:59], v2 offset:1792
    v_mfma_f32_16x16x32_bf16 v[144:147], v[20:23], v[40:43], v[144:147]
    ds_read_b64_tr_b16 v[60:61], v2 offset:288
    v_mfma_f32_16x16x32_bf16 v[192:195], v[24:27], v[40:43], v[192:195]
    ds_read_b64_tr_b16 v[62:63], v2 offset:1824
    v_mfma_f32_16x16x32_bf16 v[196:199], v[24:27], v[44:47], v[196:199]
    v_mfma_f32_16x16x32_bf16 v[228:231], v[28:31], v[44:47], v[228:231]
    buffer_load_dwordx4 v3, s[16:19], s39 offen offset:1024 nt lds
    v_mfma_f32_16x16x32_bf16 v[224:227], v[28:31], v[40:43], v[224:227]
    v_mfma_f32_16x16x32_bf16 a[208:211], v[32:35], v[40:43], a[208:211]
    buffer_load_dwordx4 v3, s[16:19], s39 offen offset:2048 nt lds
    v_mfma_f32_16x16x32_bf16 a[212:215], v[32:35], v[44:47], a[212:215]
    v_mfma_f32_16x16x32_bf16 a[164:167], v[36:39], v[44:47], a[164:167]
    s_add_u32 s39, s34, 61440
    v_mfma_f32_16x16x32_bf16 a[160:163], v[36:39], v[40:43], a[160:163]
    s_add_u32 m0, s35, 37728
    v_mfma_f32_16x16x32_bf16 v[104:107], v[16:19], v[48:51], v[104:107]
    s_waitcnt lgkmcnt(0)
    buffer_load_dwordx4 v3, s[20:23], s39 offen offset:0 nt lds
    v_mfma_f32_16x16x32_bf16 v[108:111], v[16:19], v[64:67], v[108:111]
    ds_read_b64_tr_b16 v[68:69], v2 offset:320
    v_mfma_f32_16x16x32_bf16 v[156:159], v[20:23], v[64:67], v[156:159]
    ds_read_b64_tr_b16 v[70:71], v2 offset:1856
    v_mfma_f32_16x16x32_bf16 v[152:155], v[20:23], v[48:51], v[152:155]
    ds_read_b64_tr_b16 v[72:73], v2 offset:352
    v_mfma_f32_16x16x32_bf16 v[200:203], v[24:27], v[48:51], v[200:203]
    ds_read_b64_tr_b16 v[74:75], v2 offset:1888
    v_mfma_f32_16x16x32_bf16 v[204:207], v[24:27], v[64:67], v[204:207]
    v_mfma_f32_16x16x32_bf16 v[236:239], v[28:31], v[64:67], v[236:239]
    v_mfma_f32_16x16x32_bf16 v[232:235], v[28:31], v[48:51], v[232:235]
    buffer_load_dwordx4 v3, s[20:23], s39 offen offset:1024 nt lds
    v_mfma_f32_16x16x32_bf16 a[216:219], v[32:35], v[48:51], a[216:219]
    v_add_u32 v2, s37, v2
    v_mfma_f32_16x16x32_bf16 a[220:223], v[32:35], v[64:67], a[220:223]
    v_mfma_f32_16x16x32_bf16 a[172:175], v[36:39], v[64:67], a[172:175]
    buffer_load_dwordx4 v3, s[20:23], s39 offen offset:2048 nt lds
    v_mfma_f32_16x16x32_bf16 a[168:171], v[36:39], v[48:51], a[168:171]
    v_mfma_f32_16x16x32_bf16 v[112:115], v[16:19], v[56:59], v[112:115]
    v_mfma_f32_16x16x32_bf16 v[116:119], v[16:19], v[60:63], v[116:119]
    ds_read_b128 v[40:43], v1 offset:0
    v_mfma_f32_16x16x32_bf16 v[164:167], v[20:23], v[60:63], v[164:167]
    ds_read_b128 v[44:47], v1 offset:64
    v_mfma_f32_16x16x32_bf16 v[160:163], v[20:23], v[56:59], v[160:163]
    ds_read_b128 v[52:55], v1 offset:192
    v_mfma_f32_16x16x32_bf16 v[208:211], v[24:27], v[56:59], v[208:211]
    ds_read_b128 v[48:51], v1 offset:128
    v_mfma_f32_16x16x32_bf16 v[212:215], v[24:27], v[60:63], v[212:215]
    v_mfma_f32_16x16x32_bf16 v[244:247], v[28:31], v[60:63], v[244:247]
    v_mfma_f32_16x16x32_bf16 v[240:243], v[28:31], v[56:59], v[240:243]
    v_mfma_f32_16x16x32_bf16 a[224:227], v[32:35], v[56:59], a[224:227]
    v_mfma_f32_16x16x32_bf16 a[228:231], v[32:35], v[60:63], a[228:231]
    v_mfma_f32_16x16x32_bf16 a[180:183], v[36:39], v[60:63], a[180:183]
    v_mfma_f32_16x16x32_bf16 a[176:179], v[36:39], v[56:59], a[176:179]
    s_waitcnt lgkmcnt(1)
    v_mfma_f32_16x16x32_bf16 v[120:123], v[16:19], v[68:71], v[120:123]
    ds_read_b128 v[56:59], v1 offset:256
    v_mfma_f32_16x16x32_bf16 v[124:127], v[16:19], v[72:75], v[124:127]
    ds_read_b128 v[60:63], v1 offset:320
    v_mfma_f32_16x16x32_bf16 v[172:175], v[20:23], v[72:75], v[172:175]
    v_mfma_f32_16x16x32_bf16 v[168:171], v[20:23], v[68:71], v[168:171]
    v_mfma_f32_16x16x32_bf16 v[216:219], v[24:27], v[68:71], v[216:219]
    v_mfma_f32_16x16x32_bf16 v[220:223], v[24:27], v[72:75], v[220:223]
    v_mfma_f32_16x16x32_bf16 v[252:255], v[28:31], v[72:75], v[252:255]
    v_mfma_f32_16x16x32_bf16 v[248:251], v[28:31], v[68:71], v[248:251]
    v_mfma_f32_16x16x32_bf16 a[232:235], v[32:35], v[68:71], a[232:235]
    v_mfma_f32_16x16x32_bf16 a[236:239], v[32:35], v[72:75], a[236:239]
    v_mfma_f32_16x16x32_bf16 a[188:191], v[36:39], v[72:75], a[188:191]
    v_mfma_f32_16x16x32_bf16 a[184:187], v[36:39], v[68:71], a[184:187]
    s_waitcnt lgkmcnt(0)
    .p2align 6
L_loop:
    v_mfma_f32_16x16x32_bf16 v[16:19], v[40:43], a[0:3], -4.0
    ds_read_b128 v[64:67], v1 offset:1536
    v_mfma_f32_16x16x32_bf16 v[16:19], v[44:47], a[4:7], v[16:19]
    ds_read_b128 v[68:71], v1 offset:1600
    v_mfma_f32_16x16x32_bf16 v[16:19], v[48:51], a[8:11], v[16:19]
    ds_read_b128 v[72:75], v1 offset:1664
    v_mfma_f32_16x16x32_bf16 v[16:19], v[52:55], a[12:15], v[16:19]
    v_mfma_f32_16x16x32_bf16 v[16:19], v[56:59], a[16:19], v[16:19]
    v_mfma_f32_16x16x32_bf16 v[16:19], v[60:63], a[20:23], v[16:19]
    s_nop 1
    v_mfma_f32_16x16x32_bf16 v[20:23], v[40:43], a[24:27], -4.0
    s_nop 0
    v_mfma_f32_16x16x32_bf16 v[20:23], v[44:47], a[28:31], v[20:23]
    s_nop 0
    v_mfma_f32_16x16x32_bf16 v[20:23], v[48:51], a[32:35], v[20:23]
    s_nop 0
    v_exp_f32 v16, v16
    v_mfma_f32_16x16x32_bf16 v[20:23], v[52:55], a[36:39], v[20:23]
    v_exp_f32 v17, v17
    v_mfma_f32_16x16x32_bf16 v[20:23], v[56:59], a[40:43], v[20:23]
    v_exp_f32 v18, v18
    v_mfma_f32_16x16x32_bf16 v[20:23], v[60:63], a[44:47], v[20:23]
    s_nop 0
    v_exp_f32 v19, v19
    v_mfma_f32_16x16x32_bf16 v[24:27], v[40:43], a[48:51], -4.0
    s_nop 0
    v_cvt_pk_bf16_f32 v16, v16, v17
    v_cvt_pk_bf16_f32 v17, v18, v19
    v_mfma_f32_16x16x32_bf16 v[24:27], v[44:47], a[52:55], v[24:27]
    v_mfma_f32_16x16x32_bf16 v[24:27], v[48:51], a[56:59], v[24:27]
    v_exp_f32 v20, v20
    v_mfma_f32_16x16x32_bf16 v[24:27], v[52:55], a[60:63], v[24:27]
    v_exp_f32 v21, v21
    v_mfma_f32_16x16x32_bf16 v[24:27], v[56:59], a[64:67], v[24:27]
    v_exp_f32 v22, v22
    v_mfma_f32_16x16x32_bf16 v[24:27], v[60:63], a[68:71], v[24:27]
    s_nop 0
    v_exp_f32 v23, v23
    v_mfma_f32_16x16x32_bf16 v[28:31], v[40:43], a[72:75], -4.0
    s_nop 0
    v_cvt_pk_bf16_f32 v20, v20, v21
    v_cvt_pk_bf16_f32 v21, v22, v23
    v_mfma_f32_16x16x32_bf16 v[28:31], v[44:47], a[76:79], v[28:31]
    v_mfma_f32_16x16x32_bf16 v[28:31], v[48:51], a[80:83], v[28:31]
    v_exp_f32 v24, v24
    v_mfma_f32_16x16x32_bf16 v[28:31], v[52:55], a[84:87], v[28:31]
    v_exp_f32 v25, v25
    v_mfma_f32_16x16x32_bf16 v[28:31], v[56:59], a[88:91], v[28:31]
    v_exp_f32 v26, v26
    v_mfma_f32_16x16x32_bf16 v[28:31], v[60:63], a[92:95], v[28:31]
    s_nop 0
    v_exp_f32 v27, v27
    v_mfma_f32_16x16x32_bf16 v[32:35], v[40:43], a[96:99], -4.0
    s_nop 0
    v_cvt_pk_bf16_f32 v24, v24, v25
    v_cvt_pk_bf16_f32 v25, v26, v27
    v_mfma_f32_16x16x32_bf16 v[32:35], v[44:47], a[100:103], v[32:35]
    v_mfma_f32_16x16x32_bf16 v[32:35], v[48:51], a[104:107], v[32:35]
    v_exp_f32 v28, v28
    v_mfma_f32_16x16x32_bf16 v[32:35], v[52:55], a[108:111], v[32:35]
    v_exp_f32 v29, v29
    v_mfma_f32_16x16x32_bf16 v[32:35], v[56:59], a[112:115], v[32:35]
    v_exp_f32 v30, v30
    v_mfma_f32_16x16x32_bf16 v[32:35], v[60:63], a[116:119], v[32:35]
    v_exp_f32 v31, v31
    v_mfma_f32_16x16x32_bf16 v[36:39], v[40:43], a[120:123], -4.0
    v_cvt_pk_bf16_f32 v28, v28, v29
    v_cvt_pk_bf16_f32 v29, v30, v31
    v_mfma_f32_16x16x32_bf16 v[36:39], v[44:47], a[124:127], v[36:39]
    ds_read_b128 v[40:43], v1 offset:1728
    ds_read_b128 v[44:47], v1 offset:1792
    v_mfma_f32_16x16x32_bf16 v[36:39], v[48:51], a[128:131], v[36:39]
    ds_read_b128 v[48:51], v1 offset:1856
    v_mfma_f32_16x16x32_bf16 v[36:39], v[52:55], a[132:135], v[36:39]
    v_exp_f32 v32, v32
    v_mfma_f32_16x16x32_bf16 v[36:39], v[56:59], a[136:139], v[36:39]
    v_exp_f32 v33, v33
    v_mfma_f32_16x16x32_bf16 v[36:39], v[60:63], a[140:143], v[36:39]
    s_waitcnt lgkmcnt(3)
    v_exp_f32 v34, v34
    v_mfma_f32_16x16x32_bf16 v[52:55], v[64:67], a[0:3], -4.0
    v_exp_f32 v35, v35
    v_mfma_f32_16x16x32_bf16 v[52:55], v[68:71], a[4:7], v[52:55]
    v_cvt_pk_bf16_f32 v32, v32, v33
    v_cvt_pk_bf16_f32 v33, v34, v35
    v_mfma_f32_16x16x32_bf16 v[52:55], v[72:75], a[8:11], v[52:55]
    s_waitcnt lgkmcnt(2)
    v_exp_f32 v36, v36
    v_mfma_f32_16x16x32_bf16 v[52:55], v[40:43], a[12:15], v[52:55]
    s_waitcnt lgkmcnt(1)
    v_exp_f32 v37, v37
    v_mfma_f32_16x16x32_bf16 v[52:55], v[44:47], a[16:19], v[52:55]
    s_waitcnt lgkmcnt(0)
    v_exp_f32 v38, v38
    v_mfma_f32_16x16x32_bf16 v[52:55], v[48:51], a[20:23], v[52:55]
    s_cmp_eq_u32 s38, 125760
    v_exp_f32 v39, v39
    v_mfma_f32_16x16x32_bf16 v[56:59], v[64:67], a[24:27], -4.0
    s_cselect_b32 s37, s44, s43
    v_cvt_pk_bf16_f32 v36, v36, v37
    v_cvt_pk_bf16_f32 v37, v38, v39
    v_mfma_f32_16x16x32_bf16 v[56:59], v[68:71], a[28:31], v[56:59]
    s_add_u32 s38, s38, s37
    v_mfma_f32_16x16x32_bf16 v[56:59], v[72:75], a[32:35], v[56:59]
    v_exp_f32 v52, v52
    v_mfma_f32_16x16x32_bf16 v[56:59], v[40:43], a[36:39], v[56:59]
    v_exp_f32 v53, v53
    v_mfma_f32_16x16x32_bf16 v[56:59], v[44:47], a[40:43], v[56:59]
    v_exp_f32 v54, v54
    v_mfma_f32_16x16x32_bf16 v[56:59], v[48:51], a[44:47], v[56:59]
    s_nop 0
    v_exp_f32 v55, v55
    v_mfma_f32_16x16x32_bf16 v[60:63], v[64:67], a[48:51], -4.0
    v_cvt_pk_bf16_f32 v18, v52, v53
    v_cvt_pk_bf16_f32 v19, v54, v55
    v_mfma_f32_16x16x32_bf16 v[60:63], v[68:71], a[52:55], v[60:63]
    v_add_u32 v1, s37, v1
    v_mfma_f32_16x16x32_bf16 v[60:63], v[72:75], a[56:59], v[60:63]
    v_exp_f32 v56, v56
    v_mfma_f32_16x16x32_bf16 v[60:63], v[40:43], a[60:63], v[60:63]
    v_exp_f32 v57, v57
    v_mfma_f32_16x16x32_bf16 v[60:63], v[44:47], a[64:67], v[60:63]
    v_exp_f32 v58, v58
    v_mfma_f32_16x16x32_bf16 v[60:63], v[48:51], a[68:71], v[60:63]
    v_exp_f32 v59, v59
    v_mfma_f32_16x16x32_bf16 v[52:55], v[64:67], a[72:75], -4.0
    v_cvt_pk_bf16_f32 v22, v56, v57
    v_cvt_pk_bf16_f32 v23, v58, v59
    v_mfma_f32_16x16x32_bf16 v[52:55], v[68:71], a[76:79], v[52:55]
    s_waitcnt vmcnt(9)
    s_barrier
    v_mfma_f32_16x16x32_bf16 v[52:55], v[72:75], a[80:83], v[52:55]
    v_exp_f32 v60, v60
    v_mfma_f32_16x16x32_bf16 v[52:55], v[40:43], a[84:87], v[52:55]
    v_exp_f32 v61, v61
    v_mfma_f32_16x16x32_bf16 v[52:55], v[44:47], a[88:91], v[52:55]
    v_exp_f32 v62, v62
    v_mfma_f32_16x16x32_bf16 v[52:55], v[48:51], a[92:95], v[52:55]
    s_nop 0
    v_exp_f32 v63, v63
    v_mfma_f32_16x16x32_bf16 v[56:59], v[64:67], a[96:99], -4.0
    s_nop 0
    v_cvt_pk_bf16_f32 v26, v60, v61
    v_cvt_pk_bf16_f32 v27, v62, v63
    v_mfma_f32_16x16x32_bf16 v[56:59], v[68:71], a[100:103], v[56:59]
    v_mfma_f32_16x16x32_bf16 v[56:59], v[72:75], a[104:107], v[56:59]
    v_exp_f32 v52, v52
    v_mfma_f32_16x16x32_bf16 v[56:59], v[40:43], a[108:111], v[56:59]
    v_exp_f32 v53, v53
    v_mfma_f32_16x16x32_bf16 v[56:59], v[44:47], a[112:115], v[56:59]
    v_exp_f32 v54, v54
    v_mfma_f32_16x16x32_bf16 v[56:59], v[48:51], a[116:119], v[56:59]
    v_exp_f32 v55, v55
    v_mfma_f32_16x16x32_bf16 v[60:63], v[64:67], a[120:123], -4.0
    v_cvt_pk_bf16_f32 v30, v52, v53
    v_cvt_pk_bf16_f32 v31, v54, v55
    v_mfma_f32_16x16x32_bf16 v[60:63], v[68:71], a[124:127], v[60:63]
    ds_read_b64_tr_b16 v[64:65], v2 offset:0
    ds_read_b64_tr_b16 v[66:67], v2 offset:1536
    v_mfma_f32_16x16x32_bf16 v[60:63], v[72:75], a[128:131], v[60:63]
    v_exp_f32 v56, v56
    v_mfma_f32_16x16x32_bf16 v[60:63], v[40:43], a[132:135], v[60:63]
    v_exp_f32 v57, v57
    v_mfma_f32_16x16x32_bf16 v[60:63], v[44:47], a[136:139], v[60:63]
    v_exp_f32 v58, v58
    v_mfma_f32_16x16x32_bf16 v[60:63], v[48:51], a[140:143], v[60:63]
    v_exp_f32 v59, v59
    v_smfmac_f32_16x16x64_bf16 v[4:7], v[12:15], v[16:23], v0
    v_cvt_pk_bf16_f32 v34, v56, v57
    v_cvt_pk_bf16_f32 v35, v58, v59
    v_smfmac_f32_16x16x64_bf16 v[8:11], v[12:15], v[24:31], v0
    s_waitcnt lgkmcnt(0)
    ds_read_b64_tr_b16 v[68:69], v2 offset:32
    ds_read_b64_tr_b16 v[70:71], v2 offset:1568
    v_mfma_f32_16x16x32_bf16 v[80:83], v[16:19], v[64:67], v[80:83]
    v_exp_f32 v60, v60
    v_mfma_f32_16x16x32_bf16 v[128:131], v[20:23], v[64:67], v[128:131]
    v_exp_f32 v61, v61
    v_mfma_f32_16x16x32_bf16 v[176:179], v[24:27], v[64:67], v[176:179]
    v_exp_f32 v62, v62
    v_mfma_f32_16x16x32_bf16 a[240:243], v[28:31], v[64:67], a[240:243]
    v_exp_f32 v63, v63
    v_mfma_f32_16x16x32_bf16 a[192:195], v[32:35], v[64:67], a[192:195]
    s_waitcnt lgkmcnt(0)
    v_cvt_pk_bf16_f32 v38, v60, v61
    v_cvt_pk_bf16_f32 v39, v62, v63
    v_mfma_f32_16x16x32_bf16 a[196:199], v[32:35], v[68:71], a[196:199]
    ds_read_b64_tr_b16 v[72:73], v2 offset:64
    v_mfma_f32_16x16x32_bf16 a[244:247], v[28:31], v[68:71], a[244:247]
    ds_read_b64_tr_b16 v[74:75], v2 offset:1600
    v_mfma_f32_16x16x32_bf16 v[180:183], v[24:27], v[68:71], v[180:183]
    ds_read_b64_tr_b16 v[52:53], v2 offset:96
    v_mfma_f32_16x16x32_bf16 v[132:135], v[20:23], v[68:71], v[132:135]
    ds_read_b64_tr_b16 v[54:55], v2 offset:1632
    v_mfma_f32_16x16x32_bf16 v[84:87], v[16:19], v[68:71], v[84:87]
    ds_read_b64_tr_b16 v[40:41], v2 offset:128
    v_mfma_f32_16x16x32_bf16 a[148:151], v[36:39], v[68:71], a[148:151]
    ds_read_b64_tr_b16 v[42:43], v2 offset:1664
    v_mfma_f32_16x16x32_bf16 a[144:147], v[36:39], v[64:67], a[144:147]
    v_smfmac_f32_16x16x64_bf16 v[76:79], v[12:15], v[32:39], v0
    s_waitcnt lgkmcnt(4)
    v_mfma_f32_16x16x32_bf16 v[88:91], v[16:19], v[72:75], v[88:91]
    s_waitcnt lgkmcnt(2)
    ds_read_b64_tr_b16 v[44:45], v2 offset:160
    v_mfma_f32_16x16x32_bf16 v[92:95], v[16:19], v[52:55], v[92:95]
    ds_read_b64_tr_b16 v[46:47], v2 offset:1696
    v_mfma_f32_16x16x32_bf16 v[140:143], v[20:23], v[52:55], v[140:143]
    ds_read_b64_tr_b16 v[48:49], v2 offset:192
    v_mfma_f32_16x16x32_bf16 v[136:139], v[20:23], v[72:75], v[136:139]
    ds_read_b64_tr_b16 v[50:51], v2 offset:1728
    v_mfma_f32_16x16x32_bf16 v[184:187], v[24:27], v[72:75], v[184:187]
    ds_read_b64_tr_b16 v[64:65], v2 offset:224
    v_mfma_f32_16x16x32_bf16 v[188:191], v[24:27], v[52:55], v[188:191]
    ds_read_b64_tr_b16 v[66:67], v2 offset:1760
    v_mfma_f32_16x16x32_bf16 a[252:255], v[28:31], v[52:55], a[252:255]
    s_mov_b32 m0, s52
    v_mfma_f32_16x16x32_bf16 a[248:251], v[28:31], v[72:75], a[248:251]
    buffer_load_dwordx4 v3, s[16:19], s47 offen offset:0 nt lds
    v_mfma_f32_16x16x32_bf16 a[200:203], v[32:35], v[72:75], a[200:203]
    v_mfma_f32_16x16x32_bf16 a[204:207], v[32:35], v[52:55], a[204:207]
    buffer_load_dwordx4 v3, s[16:19], s47 offen offset:1024 nt lds
    v_mfma_f32_16x16x32_bf16 a[156:159], v[36:39], v[52:55], a[156:159]
    v_mfma_f32_16x16x32_bf16 a[152:155], v[36:39], v[72:75], a[152:155]
    s_waitcnt lgkmcnt(2)
    v_mfma_f32_16x16x32_bf16 v[96:99], v[16:19], v[40:43], v[96:99]
    v_mfma_f32_16x16x32_bf16 v[100:103], v[16:19], v[44:47], v[100:103]
    ds_read_b64_tr_b16 v[56:57], v2 offset:256
    v_mfma_f32_16x16x32_bf16 v[148:151], v[20:23], v[44:47], v[148:151]
    ds_read_b64_tr_b16 v[58:59], v2 offset:1792
    v_mfma_f32_16x16x32_bf16 v[144:147], v[20:23], v[40:43], v[144:147]
    ds_read_b64_tr_b16 v[60:61], v2 offset:288
    v_mfma_f32_16x16x32_bf16 v[192:195], v[24:27], v[40:43], v[192:195]
    ds_read_b64_tr_b16 v[62:63], v2 offset:1824
    v_mfma_f32_16x16x32_bf16 v[196:199], v[24:27], v[44:47], v[196:199]
    v_mfma_f32_16x16x32_bf16 v[228:231], v[28:31], v[44:47], v[228:231]
    buffer_load_dwordx4 v3, s[16:19], s47 offen offset:2048 nt lds
    v_mfma_f32_16x16x32_bf16 v[224:227], v[28:31], v[40:43], v[224:227]
    v_mfma_f32_16x16x32_bf16 a[208:211], v[32:35], v[40:43], a[208:211]
    s_add_u32 m0, s52, 12576
    v_mfma_f32_16x16x32_bf16 a[212:215], v[32:35], v[44:47], a[212:215]
    buffer_load_dwordx4 v3, s[20:23], s47 offen offset:0 nt lds
    v_mfma_f32_16x16x32_bf16 a[164:167], v[36:39], v[44:47], a[164:167]
    v_mfma_f32_16x16x32_bf16 a[160:163], v[36:39], v[40:43], a[160:163]
    buffer_load_dwordx4 v3, s[20:23], s47 offen offset:1024 nt lds
    v_mfma_f32_16x16x32_bf16 v[104:107], v[16:19], v[48:51], v[104:107]
    s_waitcnt lgkmcnt(0)
    v_mfma_f32_16x16x32_bf16 v[108:111], v[16:19], v[64:67], v[108:111]
    ds_read_b64_tr_b16 v[68:69], v2 offset:320
    v_mfma_f32_16x16x32_bf16 v[156:159], v[20:23], v[64:67], v[156:159]
    ds_read_b64_tr_b16 v[70:71], v2 offset:1856
    v_mfma_f32_16x16x32_bf16 v[152:155], v[20:23], v[48:51], v[152:155]
    ds_read_b64_tr_b16 v[72:73], v2 offset:352
    v_mfma_f32_16x16x32_bf16 v[200:203], v[24:27], v[48:51], v[200:203]
    ds_read_b64_tr_b16 v[74:75], v2 offset:1888
    v_mfma_f32_16x16x32_bf16 v[204:207], v[24:27], v[64:67], v[204:207]
    v_mfma_f32_16x16x32_bf16 v[236:239], v[28:31], v[64:67], v[236:239]
    v_mfma_f32_16x16x32_bf16 v[232:235], v[28:31], v[48:51], v[232:235]
    v_mfma_f32_16x16x32_bf16 a[216:219], v[32:35], v[48:51], a[216:219]
    v_add_u32 v2, s37, v2
    v_mfma_f32_16x16x32_bf16 a[220:223], v[32:35], v[64:67], a[220:223]
    v_mfma_f32_16x16x32_bf16 a[172:175], v[36:39], v[64:67], a[172:175]
    buffer_load_dwordx4 v3, s[20:23], s47 offen offset:2048 nt lds
    v_mfma_f32_16x16x32_bf16 a[168:171], v[36:39], v[48:51], a[168:171]
    s_add_u32 s47, s47, 12288
    v_mfma_f32_16x16x32_bf16 v[112:115], v[16:19], v[56:59], v[112:115]
    s_cmp_eq_u32 s52, s45
    v_mfma_f32_16x16x32_bf16 v[116:119], v[16:19], v[60:63], v[116:119]
    s_cselect_b32 s39, s44, s43
    ds_read_b128 v[40:43], v1 offset:0
    v_mfma_f32_16x16x32_bf16 v[164:167], v[20:23], v[60:63], v[164:167]
    s_add_u32 s52, s52, s39
    ds_read_b128 v[44:47], v1 offset:64
    v_mfma_f32_16x16x32_bf16 v[160:163], v[20:23], v[56:59], v[160:163]
    ds_read_b128 v[52:55], v1 offset:192
    v_mfma_f32_16x16x32_bf16 v[208:211], v[24:27], v[56:59], v[208:211]
    ds_read_b128 v[48:51], v1 offset:128
    v_mfma_f32_16x16x32_bf16 v[212:215], v[24:27], v[60:63], v[212:215]
    v_mfma_f32_16x16x32_bf16 v[244:247], v[28:31], v[60:63], v[244:247]
    v_mfma_f32_16x16x32_bf16 v[240:243], v[28:31], v[56:59], v[240:243]
    v_mfma_f32_16x16x32_bf16 a[224:227], v[32:35], v[56:59], a[224:227]
    v_mfma_f32_16x16x32_bf16 a[228:231], v[32:35], v[60:63], a[228:231]
    v_mfma_f32_16x16x32_bf16 a[180:183], v[36:39], v[60:63], a[180:183]
    v_mfma_f32_16x16x32_bf16 a[176:179], v[36:39], v[56:59], a[176:179]
    s_waitcnt lgkmcnt(1)
    v_mfma_f32_16x16x32_bf16 v[120:123], v[16:19], v[68:71], v[120:123]
    ds_read_b128 v[56:59], v1 offset:256
    v_mfma_f32_16x16x32_bf16 v[124:127], v[16:19], v[72:75], v[124:127]
    ds_read_b128 v[60:63], v1 offset:320
    v_mfma_f32_16x16x32_bf16 v[172:175], v[20:23], v[72:75], v[172:175]
    v_mfma_f32_16x16x32_bf16 v[168:171], v[20:23], v[68:71], v[168:171]
    s_add_u32 s36, s36, 1
    v_mfma_f32_16x16x32_bf16 v[216:219], v[24:27], v[68:71], v[216:219]
    s_cmp_lt_u32 s36, 28
    v_mfma_f32_16x16x32_bf16 v[220:223], v[24:27], v[72:75], v[220:223]
    v_mfma_f32_16x16x32_bf16 v[252:255], v[28:31], v[72:75], v[252:255]
    v_mfma_f32_16x16x32_bf16 v[248:251], v[28:31], v[68:71], v[248:251]
    v_mfma_f32_16x16x32_bf16 a[232:235], v[32:35], v[68:71], a[232:235]
    v_mfma_f32_16x16x32_bf16 a[236:239], v[32:35], v[72:75], a[236:239]
    v_mfma_f32_16x16x32_bf16 a[188:191], v[36:39], v[72:75], a[188:191]
    v_mfma_f32_16x16x32_bf16 a[184:187], v[36:39], v[68:71], a[184:187]
    s_waitcnt lgkmcnt(0)
    s_cbranch_scc1 L_loop
    v_mfma_f32_16x16x32_bf16 v[16:19], v[40:43], a[0:3], -4.0
    v_add_f32 v4, v4, v5
    v_add_f32 v5, v6, v7
    v_mfma_f32_16x16x32_bf16 v[16:19], v[44:47], a[4:7], v[16:19]
    v_add_f32 v6, v8, v9
    v_add_f32 v7, v10, v11
    v_mfma_f32_16x16x32_bf16 v[16:19], v[48:51], a[8:11], v[16:19]
    v_add_f32 v8, v76, v77
    v_add_f32 v9, v78, v79
    v_mfma_f32_16x16x32_bf16 v[16:19], v[52:55], a[12:15], v[16:19]
    ds_read_b128 v[64:67], v1 offset:1536
    ds_read_b128 v[68:71], v1 offset:1600
    v_mfma_f32_16x16x32_bf16 v[16:19], v[56:59], a[16:19], v[16:19]
    s_waitcnt vmcnt(9)
    s_barrier
    v_mfma_f32_16x16x32_bf16 v[16:19], v[60:63], a[20:23], v[16:19]
    v_mov_b32 v12, 0x3f803f80
    v_mov_b32 v13, 0x3f803f80
    v_mfma_f32_16x16x32_bf16 v[20:23], v[40:43], a[24:27], -4.0
    v_mov_b32 v14, 0x3f803f80
    v_mov_b32 v15, 0x3f803f80
    v_mfma_f32_16x16x32_bf16 v[20:23], v[44:47], a[28:31], v[20:23]
    ds_read_b128 v[72:75], v1 offset:1664
    ds_read_b128 v[76:79], v1 offset:1728
    v_mfma_f32_16x16x32_bf16 v[20:23], v[48:51], a[32:35], v[20:23]
    v_exp_f32 v16, v16
    v_mfma_f32_16x16x32_bf16 v[20:23], v[52:55], a[36:39], v[20:23]
    v_exp_f32 v17, v17
    v_mfma_f32_16x16x32_bf16 v[20:23], v[56:59], a[40:43], v[20:23]
    v_exp_f32 v18, v18
    v_mfma_f32_16x16x32_bf16 v[20:23], v[60:63], a[44:47], v[20:23]
    v_exp_f32 v19, v19
    v_mfma_f32_16x16x32_bf16 v[24:27], v[40:43], a[48:51], -4.0
    v_cvt_pk_bf16_f32 v16, v16, v17
    v_cvt_pk_bf16_f32 v17, v18, v19
    v_mfma_f32_16x16x32_bf16 v[24:27], v[44:47], a[52:55], v[24:27]
    ds_read_b128 v[40:43], v1 offset:1792
    ds_read_b128 v[44:47], v1 offset:1856
    v_mfma_f32_16x16x32_bf16 v[24:27], v[48:51], a[56:59], v[24:27]
    v_exp_f32 v20, v20
    v_mfma_f32_16x16x32_bf16 v[24:27], v[52:55], a[60:63], v[24:27]
    v_exp_f32 v21, v21
    v_mfma_f32_16x16x32_bf16 v[24:27], v[56:59], a[64:67], v[24:27]
    v_exp_f32 v22, v22
    v_mfma_f32_16x16x32_bf16 v[24:27], v[60:63], a[68:71], v[24:27]
    s_waitcnt lgkmcnt(2)
    v_exp_f32 v23, v23
    v_mfma_f32_16x16x32_bf16 v[48:51], v[64:67], a[0:3], -4.0
    v_cvt_pk_bf16_f32 v20, v20, v21
    v_cvt_pk_bf16_f32 v21, v22, v23
    v_mfma_f32_16x16x32_bf16 v[48:51], v[68:71], a[4:7], v[48:51]
    ds_read_b64_tr_b16 v[28:29], v2 offset:0
    ds_read_b64_tr_b16 v[30:31], v2 offset:1536
    v_mfma_f32_16x16x32_bf16 v[48:51], v[72:75], a[8:11], v[48:51]
    v_exp_f32 v24, v24
    v_mfma_f32_16x16x32_bf16 v[48:51], v[76:79], a[12:15], v[48:51]
    s_waitcnt lgkmcnt(2)
    v_exp_f32 v25, v25
    v_mfma_f32_16x16x32_bf16 v[48:51], v[40:43], a[16:19], v[48:51]
    v_exp_f32 v26, v26
    v_mfma_f32_16x16x32_bf16 v[48:51], v[44:47], a[20:23], v[48:51]
    v_exp_f32 v27, v27
    v_mfma_f32_16x16x32_bf16 v[52:55], v[64:67], a[24:27], -4.0
    v_cvt_pk_bf16_f32 v24, v24, v25
    v_cvt_pk_bf16_f32 v25, v26, v27
    v_mfma_f32_16x16x32_bf16 v[52:55], v[68:71], a[28:31], v[52:55]
    ds_read_b64_tr_b16 v[32:33], v2 offset:32
    ds_read_b64_tr_b16 v[34:35], v2 offset:1568
    v_mfma_f32_16x16x32_bf16 v[52:55], v[72:75], a[32:35], v[52:55]
    v_exp_f32 v48, v48
    v_mfma_f32_16x16x32_bf16 v[52:55], v[76:79], a[36:39], v[52:55]
    v_exp_f32 v49, v49
    v_mfma_f32_16x16x32_bf16 v[52:55], v[40:43], a[40:43], v[52:55]
    v_exp_f32 v50, v50
    v_mfma_f32_16x16x32_bf16 v[52:55], v[44:47], a[44:47], v[52:55]
    v_exp_f32 v51, v51
    v_mfma_f32_16x16x32_bf16 v[56:59], v[64:67], a[48:51], -4.0
    v_cvt_pk_bf16_f32 v18, v48, v49
    v_cvt_pk_bf16_f32 v19, v50, v51
    v_mfma_f32_16x16x32_bf16 v[56:59], v[68:71], a[52:55], v[56:59]
    ds_read_b64_tr_b16 v[36:37], v2 offset:64
    ds_read_b64_tr_b16 v[38:39], v2 offset:1600
    v_mfma_f32_16x16x32_bf16 v[56:59], v[72:75], a[56:59], v[56:59]
    v_exp_f32 v52, v52
    v_mfma_f32_16x16x32_bf16 v[56:59], v[76:79], a[60:63], v[56:59]
    v_exp_f32 v53, v53
    v_mfma_f32_16x16x32_bf16 v[56:59], v[40:43], a[64:67], v[56:59]
    v_exp_f32 v54, v54
    v_mfma_f32_16x16x32_bf16 v[56:59], v[44:47], a[68:71], v[56:59]
    v_exp_f32 v55, v55
    v_mfma_f32_16x16x32_bf16 v[48:51], v[12:15], v[16:19], 0
    s_waitcnt lgkmcnt(2)
    v_cvt_pk_bf16_f32 v22, v52, v53
    v_cvt_pk_bf16_f32 v23, v54, v55
    v_mfma_f32_16x16x32_bf16 v[80:83], v[16:19], v[28:31], v[80:83]
    ds_read_b64_tr_b16 v[60:61], v2 offset:96
    ds_read_b64_tr_b16 v[62:63], v2 offset:1632
    v_mfma_f32_16x16x32_bf16 v[84:87], v[16:19], v[32:35], v[84:87]
    s_waitcnt lgkmcnt(2)
    v_exp_f32 v56, v56
    v_mfma_f32_16x16x32_bf16 v[88:91], v[16:19], v[36:39], v[88:91]
    v_exp_f32 v57, v57
    v_mfma_f32_16x16x32_bf16 v[52:55], v[12:15], v[20:23], 0
    v_exp_f32 v58, v58
    v_mfma_f32_16x16x32_bf16 v[136:139], v[20:23], v[36:39], v[136:139]
    v_exp_f32 v59, v59
    v_mfma_f32_16x16x32_bf16 v[132:135], v[20:23], v[32:35], v[132:135]
    v_cvt_pk_bf16_f32 v26, v56, v57
    v_cvt_pk_bf16_f32 v27, v58, v59
    v_mfma_f32_16x16x32_bf16 v[128:131], v[20:23], v[28:31], v[128:131]
    s_nop 0
    ds_read_b64_tr_b16 v[64:65], v2 offset:128
    ds_read_b64_tr_b16 v[66:67], v2 offset:1664
    v_mfma_f32_16x16x32_bf16 v[176:179], v[24:27], v[28:31], v[176:179]
    ds_read_b64_tr_b16 v[68:69], v2 offset:160
    ds_read_b64_tr_b16 v[70:71], v2 offset:1696
    v_mfma_f32_16x16x32_bf16 v[180:183], v[24:27], v[32:35], v[180:183]
    s_add_u32 s39, s34, 380928
    v_add_f32 v4, v4, v48
    v_add_f32 v5, v5, v52
    v_mfma_f32_16x16x32_bf16 v[184:187], v[24:27], v[36:39], v[184:187]
    s_add_u32 m0, s35, 75456
    ds_read_b64_tr_b16 v[72:73], v2 offset:192
    ds_read_b64_tr_b16 v[74:75], v2 offset:1728
    v_mfma_f32_16x16x32_bf16 v[56:59], v[12:15], v[24:27], 0
    s_waitcnt lgkmcnt(6)
    ds_read_b64_tr_b16 v[76:77], v2 offset:224
    ds_read_b64_tr_b16 v[78:79], v2 offset:1760
    v_mfma_f32_16x16x32_bf16 v[92:95], v[16:19], v[60:63], v[92:95]
    s_waitcnt lgkmcnt(6)
    ds_read_b64_tr_b16 v[28:29], v2 offset:256
    ds_read_b64_tr_b16 v[30:31], v2 offset:1792
    v_mfma_f32_16x16x32_bf16 v[96:99], v[16:19], v[64:67], v[96:99]
    s_waitcnt lgkmcnt(6)
    buffer_load_dwordx4 v3, s[16:19], s39 offen offset:0 nt lds
    v_mfma_f32_16x16x32_bf16 v[100:103], v[16:19], v[68:71], v[100:103]
    ds_read_b64_tr_b16 v[32:33], v2 offset:288
    ds_read_b64_tr_b16 v[34:35], v2 offset:1824
    v_mfma_f32_16x16x32_bf16 v[148:151], v[20:23], v[68:71], v[148:151]
    v_mfma_f32_16x16x32_bf16 v[144:147], v[20:23], v[64:67], v[144:147]
    ds_read_b64_tr_b16 v[36:37], v2 offset:320
    ds_read_b64_tr_b16 v[38:39], v2 offset:1856
    v_mfma_f32_16x16x32_bf16 v[140:143], v[20:23], v[60:63], v[140:143]
    v_add_f32 v6, v6, v56
    v_add_u32 v1, 0x6240, v1
    v_mfma_f32_16x16x32_bf16 v[188:191], v[24:27], v[60:63], v[188:191]
    buffer_load_dwordx4 v3, s[16:19], s39 offen offset:1024 nt lds
    v_mfma_f32_16x16x32_bf16 v[192:195], v[24:27], v[64:67], v[192:195]
    v_mfma_f32_16x16x32_bf16 v[196:199], v[24:27], v[68:71], v[196:199]
    s_waitcnt lgkmcnt(4)
    buffer_load_dwordx4 v3, s[16:19], s39 offen offset:2048 nt lds
    v_mfma_f32_16x16x32_bf16 v[104:107], v[16:19], v[72:75], v[104:107]
    ds_read_b64_tr_b16 v[64:65], v2 offset:352
    ds_read_b64_tr_b16 v[66:67], v2 offset:1888
    v_mfma_f32_16x16x32_bf16 v[108:111], v[16:19], v[76:79], v[108:111]
    v_mfma_f32_16x16x32_bf16 v[112:115], v[16:19], v[28:31], v[112:115]
    ds_read_b128 v[40:43], v1 offset:0
    ds_read_b128 v[44:47], v1 offset:64
    v_mfma_f32_16x16x32_bf16 v[160:163], v[20:23], v[28:31], v[160:163]
    v_add_u32 v2, 0x6240, v2
    v_mfma_f32_16x16x32_bf16 v[156:159], v[20:23], v[76:79], v[156:159]
    ds_read_b128 v[48:51], v1 offset:128
    ds_read_b128 v[52:55], v1 offset:192
    v_mfma_f32_16x16x32_bf16 v[152:155], v[20:23], v[72:75], v[152:155]
    s_add_u32 s39, s34, 380928
    v_mfma_f32_16x16x32_bf16 v[200:203], v[24:27], v[72:75], v[200:203]
    s_add_u32 m0, s35, 88032
    ds_read_b128 v[56:59], v1 offset:256
    ds_read_b128 v[60:63], v1 offset:320
    v_mfma_f32_16x16x32_bf16 v[204:207], v[24:27], v[76:79], v[204:207]
    buffer_load_dwordx4 v3, s[20:23], s39 offen offset:0 nt lds
    v_mfma_f32_16x16x32_bf16 v[208:211], v[24:27], v[28:31], v[208:211]
    s_waitcnt lgkmcnt(6)
    v_mfma_f32_16x16x32_bf16 v[116:119], v[16:19], v[32:35], v[116:119]
    v_mfma_f32_16x16x32_bf16 v[120:123], v[16:19], v[36:39], v[120:123]
    buffer_load_dwordx4 v3, s[20:23], s39 offen offset:1024 nt lds
    v_mfma_f32_16x16x32_bf16 v[124:127], v[16:19], v[64:67], v[124:127]
    v_mfma_f32_16x16x32_bf16 v[172:175], v[20:23], v[64:67], v[172:175]
    v_mfma_f32_16x16x32_bf16 v[168:171], v[20:23], v[36:39], v[168:171]
    buffer_load_dwordx4 v3, s[20:23], s39 offen offset:2048 nt lds
    v_mfma_f32_16x16x32_bf16 v[164:167], v[20:23], v[32:35], v[164:167]
    v_mfma_f32_16x16x32_bf16 v[212:215], v[24:27], v[32:35], v[212:215]
    v_mfma_f32_16x16x32_bf16 v[216:219], v[24:27], v[36:39], v[216:219]
    v_mfma_f32_16x16x32_bf16 v[220:223], v[24:27], v[64:67], v[220:223]
    s_waitcnt lgkmcnt(0)
    v_mfma_f32_16x16x32_bf16 v[16:19], v[40:43], a[0:3], -4.0
    ds_read_b128 v[64:67], v1 offset:1536
    ds_read_b128 v[68:71], v1 offset:1600
    v_mfma_f32_16x16x32_bf16 v[16:19], v[44:47], a[4:7], v[16:19]
    ds_read_b128 v[72:75], v1 offset:1664
    ds_read_b128 v[76:79], v1 offset:1728
    v_mfma_f32_16x16x32_bf16 v[16:19], v[48:51], a[8:11], v[16:19]
    v_mfma_f32_16x16x32_bf16 v[16:19], v[52:55], a[12:15], v[16:19]
    v_mfma_f32_16x16x32_bf16 v[16:19], v[56:59], a[16:19], v[16:19]
    s_waitcnt vmcnt(9)
    s_barrier
    v_mfma_f32_16x16x32_bf16 v[16:19], v[60:63], a[20:23], v[16:19]
    s_nop 0
    v_mfma_f32_16x16x32_bf16 v[20:23], v[40:43], a[24:27], -4.0
    s_nop 0
    v_mfma_f32_16x16x32_bf16 v[20:23], v[44:47], a[28:31], v[20:23]
    s_nop 0
    ds_read_b64_tr_b16 v[28:29], v2 offset:0
    ds_read_b64_tr_b16 v[30:31], v2 offset:1536
    v_mfma_f32_16x16x32_bf16 v[20:23], v[48:51], a[32:35], v[20:23]
    v_exp_f32 v16, v16
    v_mfma_f32_16x16x32_bf16 v[20:23], v[52:55], a[36:39], v[20:23]
    v_exp_f32 v17, v17
    v_mfma_f32_16x16x32_bf16 v[20:23], v[56:59], a[40:43], v[20:23]
    v_exp_f32 v18, v18
    v_mfma_f32_16x16x32_bf16 v[20:23], v[60:63], a[44:47], v[20:23]
    v_exp_f32 v19, v19
    v_mfma_f32_16x16x32_bf16 v[24:27], v[40:43], a[48:51], -4.0
    v_cvt_pk_bf16_f32 v16, v16, v17
    v_cvt_pk_bf16_f32 v17, v18, v19
    v_mfma_f32_16x16x32_bf16 v[24:27], v[44:47], a[52:55], v[24:27]
    ds_read_b128 v[40:43], v1 offset:1792
    ds_read_b128 v[44:47], v1 offset:1856
    v_mfma_f32_16x16x32_bf16 v[24:27], v[48:51], a[56:59], v[24:27]
    v_exp_f32 v20, v20
    v_mfma_f32_16x16x32_bf16 v[24:27], v[52:55], a[60:63], v[24:27]
    v_exp_f32 v21, v21
    v_mfma_f32_16x16x32_bf16 v[24:27], v[56:59], a[64:67], v[24:27]
    v_exp_f32 v22, v22
    v_mfma_f32_16x16x32_bf16 v[24:27], v[60:63], a[68:71], v[24:27]
    s_waitcnt lgkmcnt(2)
    v_exp_f32 v23, v23
    v_mfma_f32_16x16x32_bf16 v[48:51], v[64:67], a[0:3], -4.0
    v_cvt_pk_bf16_f32 v20, v20, v21
    v_cvt_pk_bf16_f32 v21, v22, v23
    v_mfma_f32_16x16x32_bf16 v[48:51], v[68:71], a[4:7], v[48:51]
    ds_read_b64_tr_b16 v[32:33], v2 offset:32
    ds_read_b64_tr_b16 v[34:35], v2 offset:1568
    v_mfma_f32_16x16x32_bf16 v[48:51], v[72:75], a[8:11], v[48:51]
    v_exp_f32 v24, v24
    v_mfma_f32_16x16x32_bf16 v[48:51], v[76:79], a[12:15], v[48:51]
    s_waitcnt lgkmcnt(2)
    v_exp_f32 v25, v25
    v_mfma_f32_16x16x32_bf16 v[48:51], v[40:43], a[16:19], v[48:51]
    v_exp_f32 v26, v26
    v_mfma_f32_16x16x32_bf16 v[48:51], v[44:47], a[20:23], v[48:51]
    v_exp_f32 v27, v27
    v_mfma_f32_16x16x32_bf16 v[52:55], v[64:67], a[24:27], -4.0
    v_cvt_pk_bf16_f32 v24, v24, v25
    v_cvt_pk_bf16_f32 v25, v26, v27
    v_mfma_f32_16x16x32_bf16 v[52:55], v[68:71], a[28:31], v[52:55]
    ds_read_b64_tr_b16 v[36:37], v2 offset:64
    ds_read_b64_tr_b16 v[38:39], v2 offset:1600
    v_mfma_f32_16x16x32_bf16 v[52:55], v[72:75], a[32:35], v[52:55]
    v_exp_f32 v48, v48
    v_mfma_f32_16x16x32_bf16 v[52:55], v[76:79], a[36:39], v[52:55]
    v_exp_f32 v49, v49
    v_mfma_f32_16x16x32_bf16 v[52:55], v[40:43], a[40:43], v[52:55]
    v_exp_f32 v50, v50
    v_mfma_f32_16x16x32_bf16 v[52:55], v[44:47], a[44:47], v[52:55]
    v_exp_f32 v51, v51
    v_mfma_f32_16x16x32_bf16 v[56:59], v[64:67], a[48:51], -4.0
    v_cvt_pk_bf16_f32 v18, v48, v49
    v_cvt_pk_bf16_f32 v19, v50, v51
    v_mfma_f32_16x16x32_bf16 v[56:59], v[68:71], a[52:55], v[56:59]
    ds_read_b64_tr_b16 v[60:61], v2 offset:96
    ds_read_b64_tr_b16 v[62:63], v2 offset:1632
    v_mfma_f32_16x16x32_bf16 v[56:59], v[72:75], a[56:59], v[56:59]
    v_exp_f32 v52, v52
    v_mfma_f32_16x16x32_bf16 v[56:59], v[76:79], a[60:63], v[56:59]
    v_exp_f32 v53, v53
    v_mfma_f32_16x16x32_bf16 v[56:59], v[40:43], a[64:67], v[56:59]
    v_exp_f32 v54, v54
    v_mfma_f32_16x16x32_bf16 v[56:59], v[44:47], a[68:71], v[56:59]
    v_exp_f32 v55, v55
    v_mfma_f32_16x16x32_bf16 v[48:51], v[12:15], v[16:19], 0
    v_cvt_pk_bf16_f32 v22, v52, v53
    v_cvt_pk_bf16_f32 v23, v54, v55
    v_mfma_f32_16x16x32_bf16 v[80:83], v[16:19], v[28:31], v[80:83]
    s_waitcnt lgkmcnt(2)
    ds_read_b64_tr_b16 v[64:65], v2 offset:128
    ds_read_b64_tr_b16 v[66:67], v2 offset:1664
    v_mfma_f32_16x16x32_bf16 v[84:87], v[16:19], v[32:35], v[84:87]
    v_exp_f32 v56, v56
    v_mfma_f32_16x16x32_bf16 v[88:91], v[16:19], v[36:39], v[88:91]
    v_exp_f32 v57, v57
    v_mfma_f32_16x16x32_bf16 v[52:55], v[12:15], v[20:23], 0
    v_exp_f32 v58, v58
    v_mfma_f32_16x16x32_bf16 v[136:139], v[20:23], v[36:39], v[136:139]
    v_exp_f32 v59, v59
    v_mfma_f32_16x16x32_bf16 v[132:135], v[20:23], v[32:35], v[132:135]
    v_cvt_pk_bf16_f32 v26, v56, v57
    v_cvt_pk_bf16_f32 v27, v58, v59
    v_mfma_f32_16x16x32_bf16 v[128:131], v[20:23], v[28:31], v[128:131]
    s_nop 0
    ds_read_b64_tr_b16 v[68:69], v2 offset:160
    ds_read_b64_tr_b16 v[70:71], v2 offset:1696
    v_mfma_f32_16x16x32_bf16 v[176:179], v[24:27], v[28:31], v[176:179]
    ds_read_b64_tr_b16 v[72:73], v2 offset:192
    ds_read_b64_tr_b16 v[74:75], v2 offset:1728
    v_mfma_f32_16x16x32_bf16 v[180:183], v[24:27], v[32:35], v[180:183]
    v_add_f32 v4, v4, v48
    v_add_f32 v5, v5, v52
    v_mfma_f32_16x16x32_bf16 v[184:187], v[24:27], v[36:39], v[184:187]
    ds_read_b64_tr_b16 v[76:77], v2 offset:224
    ds_read_b64_tr_b16 v[78:79], v2 offset:1760
    v_mfma_f32_16x16x32_bf16 v[56:59], v[12:15], v[24:27], 0
    s_waitcnt lgkmcnt(6)
    v_mfma_f32_16x16x32_bf16 v[92:95], v[16:19], v[60:63], v[92:95]
    ds_read_b64_tr_b16 v[28:29], v2 offset:256
    ds_read_b64_tr_b16 v[30:31], v2 offset:1792
    v_mfma_f32_16x16x32_bf16 v[96:99], v[16:19], v[64:67], v[96:99]
    s_waitcnt lgkmcnt(6)
    v_mfma_f32_16x16x32_bf16 v[100:103], v[16:19], v[68:71], v[100:103]
    ds_read_b64_tr_b16 v[32:33], v2 offset:288
    ds_read_b64_tr_b16 v[34:35], v2 offset:1824
    v_mfma_f32_16x16x32_bf16 v[148:151], v[20:23], v[68:71], v[148:151]
    v_mfma_f32_16x16x32_bf16 v[144:147], v[20:23], v[64:67], v[144:147]
    ds_read_b64_tr_b16 v[36:37], v2 offset:320
    ds_read_b64_tr_b16 v[38:39], v2 offset:1856
    v_mfma_f32_16x16x32_bf16 v[140:143], v[20:23], v[60:63], v[140:143]
    v_add_f32 v6, v6, v56
    v_add_u32 v1, 0x6240, v1
    v_mfma_f32_16x16x32_bf16 v[188:191], v[24:27], v[60:63], v[188:191]
    v_mfma_f32_16x16x32_bf16 v[192:195], v[24:27], v[64:67], v[192:195]
    v_mfma_f32_16x16x32_bf16 v[196:199], v[24:27], v[68:71], v[196:199]
    s_waitcnt lgkmcnt(4)
    v_mfma_f32_16x16x32_bf16 v[104:107], v[16:19], v[72:75], v[104:107]
    ds_read_b64_tr_b16 v[64:65], v2 offset:352
    ds_read_b64_tr_b16 v[66:67], v2 offset:1888
    v_mfma_f32_16x16x32_bf16 v[108:111], v[16:19], v[76:79], v[108:111]
    v_mfma_f32_16x16x32_bf16 v[112:115], v[16:19], v[28:31], v[112:115]
    ds_read_b128 v[40:43], v1 offset:0
    ds_read_b128 v[44:47], v1 offset:64
    v_mfma_f32_16x16x32_bf16 v[160:163], v[20:23], v[28:31], v[160:163]
    v_add_u32 v2, 0x6240, v2
    v_mfma_f32_16x16x32_bf16 v[156:159], v[20:23], v[76:79], v[156:159]
    ds_read_b128 v[48:51], v1 offset:128
    ds_read_b128 v[52:55], v1 offset:192
    v_mfma_f32_16x16x32_bf16 v[152:155], v[20:23], v[72:75], v[152:155]
    v_mfma_f32_16x16x32_bf16 v[200:203], v[24:27], v[72:75], v[200:203]
    ds_read_b128 v[56:59], v1 offset:256
    ds_read_b128 v[60:63], v1 offset:320
    v_mfma_f32_16x16x32_bf16 v[204:207], v[24:27], v[76:79], v[204:207]
    v_mfma_f32_16x16x32_bf16 v[208:211], v[24:27], v[28:31], v[208:211]
    s_waitcnt lgkmcnt(6)
    v_mfma_f32_16x16x32_bf16 v[116:119], v[16:19], v[32:35], v[116:119]
    v_mfma_f32_16x16x32_bf16 v[120:123], v[16:19], v[36:39], v[120:123]
    v_mfma_f32_16x16x32_bf16 v[124:127], v[16:19], v[64:67], v[124:127]
    v_mfma_f32_16x16x32_bf16 v[172:175], v[20:23], v[64:67], v[172:175]
    v_mfma_f32_16x16x32_bf16 v[168:171], v[20:23], v[36:39], v[168:171]
    v_mfma_f32_16x16x32_bf16 v[164:167], v[20:23], v[32:35], v[164:167]
    v_mfma_f32_16x16x32_bf16 v[212:215], v[24:27], v[32:35], v[212:215]
    v_mfma_f32_16x16x32_bf16 v[216:219], v[24:27], v[36:39], v[216:219]
    v_mfma_f32_16x16x32_bf16 v[220:223], v[24:27], v[64:67], v[220:223]
    s_waitcnt lgkmcnt(0)
    v_mfma_f32_16x16x32_bf16 v[16:19], v[40:43], a[0:3], -4.0
    ds_read_b128 v[64:67], v1 offset:1536
    ds_read_b128 v[68:71], v1 offset:1600
    v_mfma_f32_16x16x32_bf16 v[16:19], v[44:47], a[4:7], v[16:19]
    ds_read_b128 v[72:75], v1 offset:1664
    ds_read_b128 v[76:79], v1 offset:1728
    v_mfma_f32_16x16x32_bf16 v[16:19], v[48:51], a[8:11], v[16:19]
    v_mfma_f32_16x16x32_bf16 v[16:19], v[52:55], a[12:15], v[16:19]
    v_mfma_f32_16x16x32_bf16 v[16:19], v[56:59], a[16:19], v[16:19]
    s_waitcnt vmcnt(3)
    s_barrier
    v_mfma_f32_16x16x32_bf16 v[16:19], v[60:63], a[20:23], v[16:19]
    s_nop 0
    v_mfma_f32_16x16x32_bf16 v[20:23], v[40:43], a[24:27], -4.0
    s_nop 0
    v_mfma_f32_16x16x32_bf16 v[20:23], v[44:47], a[28:31], v[20:23]
    s_nop 0
    ds_read_b64_tr_b16 v[28:29], v2 offset:0
    ds_read_b64_tr_b16 v[30:31], v2 offset:1536
    v_mfma_f32_16x16x32_bf16 v[20:23], v[48:51], a[32:35], v[20:23]
    v_exp_f32 v16, v16
    v_mfma_f32_16x16x32_bf16 v[20:23], v[52:55], a[36:39], v[20:23]
    v_exp_f32 v17, v17
    v_mfma_f32_16x16x32_bf16 v[20:23], v[56:59], a[40:43], v[20:23]
    v_exp_f32 v18, v18
    v_mfma_f32_16x16x32_bf16 v[20:23], v[60:63], a[44:47], v[20:23]
    v_exp_f32 v19, v19
    v_mfma_f32_16x16x32_bf16 v[24:27], v[40:43], a[48:51], -4.0
    v_cvt_pk_bf16_f32 v16, v16, v17
    v_cvt_pk_bf16_f32 v17, v18, v19
    v_mfma_f32_16x16x32_bf16 v[24:27], v[44:47], a[52:55], v[24:27]
    ds_read_b128 v[40:43], v1 offset:1792
    ds_read_b128 v[44:47], v1 offset:1856
    v_mfma_f32_16x16x32_bf16 v[24:27], v[48:51], a[56:59], v[24:27]
    v_exp_f32 v20, v20
    v_mfma_f32_16x16x32_bf16 v[24:27], v[52:55], a[60:63], v[24:27]
    v_exp_f32 v21, v21
    v_mfma_f32_16x16x32_bf16 v[24:27], v[56:59], a[64:67], v[24:27]
    v_exp_f32 v22, v22
    v_mfma_f32_16x16x32_bf16 v[24:27], v[60:63], a[68:71], v[24:27]
    s_waitcnt lgkmcnt(2)
    v_exp_f32 v23, v23
    v_mfma_f32_16x16x32_bf16 v[48:51], v[64:67], a[0:3], -4.0
    v_cvt_pk_bf16_f32 v20, v20, v21
    v_cvt_pk_bf16_f32 v21, v22, v23
    v_mfma_f32_16x16x32_bf16 v[48:51], v[68:71], a[4:7], v[48:51]
    ds_read_b64_tr_b16 v[32:33], v2 offset:32
    ds_read_b64_tr_b16 v[34:35], v2 offset:1568
    v_mfma_f32_16x16x32_bf16 v[48:51], v[72:75], a[8:11], v[48:51]
    v_exp_f32 v24, v24
    v_mfma_f32_16x16x32_bf16 v[48:51], v[76:79], a[12:15], v[48:51]
    s_waitcnt lgkmcnt(2)
    v_exp_f32 v25, v25
    v_mfma_f32_16x16x32_bf16 v[48:51], v[40:43], a[16:19], v[48:51]
    v_exp_f32 v26, v26
    v_mfma_f32_16x16x32_bf16 v[48:51], v[44:47], a[20:23], v[48:51]
    v_exp_f32 v27, v27
    v_mfma_f32_16x16x32_bf16 v[52:55], v[64:67], a[24:27], -4.0
    v_cvt_pk_bf16_f32 v24, v24, v25
    v_cvt_pk_bf16_f32 v25, v26, v27
    v_mfma_f32_16x16x32_bf16 v[52:55], v[68:71], a[28:31], v[52:55]
    ds_read_b64_tr_b16 v[36:37], v2 offset:64
    ds_read_b64_tr_b16 v[38:39], v2 offset:1600
    v_mfma_f32_16x16x32_bf16 v[52:55], v[72:75], a[32:35], v[52:55]
    v_exp_f32 v48, v48
    v_mfma_f32_16x16x32_bf16 v[52:55], v[76:79], a[36:39], v[52:55]
    v_exp_f32 v49, v49
    v_mfma_f32_16x16x32_bf16 v[52:55], v[40:43], a[40:43], v[52:55]
    v_exp_f32 v50, v50
    v_mfma_f32_16x16x32_bf16 v[52:55], v[44:47], a[44:47], v[52:55]
    v_exp_f32 v51, v51
    v_mfma_f32_16x16x32_bf16 v[56:59], v[64:67], a[48:51], -4.0
    v_cvt_pk_bf16_f32 v18, v48, v49
    v_cvt_pk_bf16_f32 v19, v50, v51
    v_mfma_f32_16x16x32_bf16 v[56:59], v[68:71], a[52:55], v[56:59]
    ds_read_b64_tr_b16 v[60:61], v2 offset:96
    ds_read_b64_tr_b16 v[62:63], v2 offset:1632
    v_mfma_f32_16x16x32_bf16 v[56:59], v[72:75], a[56:59], v[56:59]
    v_exp_f32 v52, v52
    v_mfma_f32_16x16x32_bf16 v[56:59], v[76:79], a[60:63], v[56:59]
    v_exp_f32 v53, v53
    v_mfma_f32_16x16x32_bf16 v[56:59], v[40:43], a[64:67], v[56:59]
    v_exp_f32 v54, v54
    v_mfma_f32_16x16x32_bf16 v[56:59], v[44:47], a[68:71], v[56:59]
    v_exp_f32 v55, v55
    v_mfma_f32_16x16x32_bf16 v[48:51], v[12:15], v[16:19], 0
    v_cvt_pk_bf16_f32 v22, v52, v53
    v_cvt_pk_bf16_f32 v23, v54, v55
    v_mfma_f32_16x16x32_bf16 v[80:83], v[16:19], v[28:31], v[80:83]
    s_waitcnt lgkmcnt(2)
    ds_read_b64_tr_b16 v[64:65], v2 offset:128
    ds_read_b64_tr_b16 v[66:67], v2 offset:1664
    v_mfma_f32_16x16x32_bf16 v[84:87], v[16:19], v[32:35], v[84:87]
    v_exp_f32 v56, v56
    v_mfma_f32_16x16x32_bf16 v[88:91], v[16:19], v[36:39], v[88:91]
    v_exp_f32 v57, v57
    v_mfma_f32_16x16x32_bf16 v[52:55], v[12:15], v[20:23], 0
    v_exp_f32 v58, v58
    v_mfma_f32_16x16x32_bf16 v[136:139], v[20:23], v[36:39], v[136:139]
    v_exp_f32 v59, v59
    v_mfma_f32_16x16x32_bf16 v[132:135], v[20:23], v[32:35], v[132:135]
    v_cvt_pk_bf16_f32 v26, v56, v57
    v_cvt_pk_bf16_f32 v27, v58, v59
    v_mfma_f32_16x16x32_bf16 v[128:131], v[20:23], v[28:31], v[128:131]
    s_nop 0
    ds_read_b64_tr_b16 v[68:69], v2 offset:160
    ds_read_b64_tr_b16 v[70:71], v2 offset:1696
    v_mfma_f32_16x16x32_bf16 v[176:179], v[24:27], v[28:31], v[176:179]
    ds_read_b64_tr_b16 v[72:73], v2 offset:192
    ds_read_b64_tr_b16 v[74:75], v2 offset:1728
    v_mfma_f32_16x16x32_bf16 v[180:183], v[24:27], v[32:35], v[180:183]
    v_add_f32 v4, v4, v48
    v_add_f32 v5, v5, v52
    v_mfma_f32_16x16x32_bf16 v[184:187], v[24:27], v[36:39], v[184:187]
    ds_read_b64_tr_b16 v[76:77], v2 offset:224
    ds_read_b64_tr_b16 v[78:79], v2 offset:1760
    v_mfma_f32_16x16x32_bf16 v[56:59], v[12:15], v[24:27], 0
    s_waitcnt lgkmcnt(6)
    v_mfma_f32_16x16x32_bf16 v[92:95], v[16:19], v[60:63], v[92:95]
    ds_read_b64_tr_b16 v[28:29], v2 offset:256
    ds_read_b64_tr_b16 v[30:31], v2 offset:1792
    v_mfma_f32_16x16x32_bf16 v[96:99], v[16:19], v[64:67], v[96:99]
    s_waitcnt lgkmcnt(6)
    v_mfma_f32_16x16x32_bf16 v[100:103], v[16:19], v[68:71], v[100:103]
    ds_read_b64_tr_b16 v[32:33], v2 offset:288
    ds_read_b64_tr_b16 v[34:35], v2 offset:1824
    v_mfma_f32_16x16x32_bf16 v[148:151], v[20:23], v[68:71], v[148:151]
    v_mfma_f32_16x16x32_bf16 v[144:147], v[20:23], v[64:67], v[144:147]
    ds_read_b64_tr_b16 v[36:37], v2 offset:320
    ds_read_b64_tr_b16 v[38:39], v2 offset:1856
    v_mfma_f32_16x16x32_bf16 v[140:143], v[20:23], v[60:63], v[140:143]
    v_add_f32 v6, v6, v56
    v_add_u32 v1, 0x6240, v1
    v_mfma_f32_16x16x32_bf16 v[188:191], v[24:27], v[60:63], v[188:191]
    v_mfma_f32_16x16x32_bf16 v[192:195], v[24:27], v[64:67], v[192:195]
    v_mfma_f32_16x16x32_bf16 v[196:199], v[24:27], v[68:71], v[196:199]
    s_waitcnt lgkmcnt(4)
    v_mfma_f32_16x16x32_bf16 v[104:107], v[16:19], v[72:75], v[104:107]
    ds_read_b64_tr_b16 v[64:65], v2 offset:352
    ds_read_b64_tr_b16 v[66:67], v2 offset:1888
    v_mfma_f32_16x16x32_bf16 v[108:111], v[16:19], v[76:79], v[108:111]
    v_mfma_f32_16x16x32_bf16 v[112:115], v[16:19], v[28:31], v[112:115]
    ds_read_b128 v[40:43], v1 offset:0
    ds_read_b128 v[44:47], v1 offset:64
    v_mfma_f32_16x16x32_bf16 v[160:163], v[20:23], v[28:31], v[160:163]
    v_add_u32 v2, 0x6240, v2
    v_mfma_f32_16x16x32_bf16 v[156:159], v[20:23], v[76:79], v[156:159]
    ds_read_b128 v[48:51], v1 offset:128
    ds_read_b128 v[52:55], v1 offset:192
    v_mfma_f32_16x16x32_bf16 v[152:155], v[20:23], v[72:75], v[152:155]
    v_mfma_f32_16x16x32_bf16 v[200:203], v[24:27], v[72:75], v[200:203]
    ds_read_b128 v[56:59], v1 offset:256
    ds_read_b128 v[60:63], v1 offset:320
    v_mfma_f32_16x16x32_bf16 v[204:207], v[24:27], v[76:79], v[204:207]
    v_mfma_f32_16x16x32_bf16 v[208:211], v[24:27], v[28:31], v[208:211]
    s_waitcnt lgkmcnt(6)
    v_mfma_f32_16x16x32_bf16 v[116:119], v[16:19], v[32:35], v[116:119]
    v_mfma_f32_16x16x32_bf16 v[120:123], v[16:19], v[36:39], v[120:123]
    v_mfma_f32_16x16x32_bf16 v[124:127], v[16:19], v[64:67], v[124:127]
    v_mfma_f32_16x16x32_bf16 v[172:175], v[20:23], v[64:67], v[172:175]
    v_mfma_f32_16x16x32_bf16 v[168:171], v[20:23], v[36:39], v[168:171]
    v_mfma_f32_16x16x32_bf16 v[164:167], v[20:23], v[32:35], v[164:167]
    v_mfma_f32_16x16x32_bf16 v[212:215], v[24:27], v[32:35], v[212:215]
    v_mfma_f32_16x16x32_bf16 v[216:219], v[24:27], v[36:39], v[216:219]
    v_mfma_f32_16x16x32_bf16 v[220:223], v[24:27], v[64:67], v[220:223]
    s_waitcnt lgkmcnt(0)
    v_mfma_f32_16x16x32_bf16 v[16:19], v[40:43], a[0:3], -4.0
    ds_read_b128 v[64:67], v1 offset:1536
    ds_read_b128 v[68:71], v1 offset:1600
    v_mfma_f32_16x16x32_bf16 v[16:19], v[44:47], a[4:7], v[16:19]
    ds_read_b128 v[72:75], v1 offset:1664
    ds_read_b128 v[76:79], v1 offset:1728
    v_mfma_f32_16x16x32_bf16 v[16:19], v[48:51], a[8:11], v[16:19]
    v_mbcnt_lo_u32_b32 v10, -1, 0
    v_mbcnt_hi_u32_b32 v10, -1, v10
    v_mfma_f32_16x16x32_bf16 v[16:19], v[52:55], a[12:15], v[16:19]
    v_and_b32 v0, 15, v10
    v_lshlrev_b32 v0, 3, v0
    v_mfma_f32_16x16x32_bf16 v[16:19], v[56:59], a[16:19], v[16:19]
    s_waitcnt vmcnt(0)
    s_barrier
    v_mfma_f32_16x16x32_bf16 v[16:19], v[60:63], a[20:23], v[16:19]
    v_and_b32 v10, 48, v10
    v_mad_u32_u24 v0, v10, 40, v0
    v_mfma_f32_16x16x32_bf16 v[20:23], v[40:43], a[24:27], -4.0
    v_add_u32 v0, s46, v0
    v_mfma_f32_16x16x32_bf16 v[20:23], v[44:47], a[28:31], v[20:23]
    ds_read_b64_tr_b16 v[28:29], v2 offset:0
    ds_read_b64_tr_b16 v[30:31], v2 offset:1536
    v_mfma_f32_16x16x32_bf16 v[20:23], v[48:51], a[32:35], v[20:23]
    v_exp_f32 v16, v16
    v_mfma_f32_16x16x32_bf16 v[20:23], v[52:55], a[36:39], v[20:23]
    v_exp_f32 v17, v17
    v_mfma_f32_16x16x32_bf16 v[20:23], v[56:59], a[40:43], v[20:23]
    v_exp_f32 v18, v18
    v_mfma_f32_16x16x32_bf16 v[20:23], v[60:63], a[44:47], v[20:23]
    v_exp_f32 v19, v19
    v_mfma_f32_16x16x32_bf16 v[24:27], v[40:43], a[48:51], -4.0
    v_cvt_pk_bf16_f32 v16, v16, v17
    v_cvt_pk_bf16_f32 v17, v18, v19
    v_mfma_f32_16x16x32_bf16 v[24:27], v[44:47], a[52:55], v[24:27]
    ds_read_b128 v[40:43], v1 offset:1792
    ds_read_b128 v[44:47], v1 offset:1856
    v_mfma_f32_16x16x32_bf16 v[24:27], v[48:51], a[56:59], v[24:27]
    v_exp_f32 v20, v20
    v_mfma_f32_16x16x32_bf16 v[24:27], v[52:55], a[60:63], v[24:27]
    v_exp_f32 v21, v21
    v_mfma_f32_16x16x32_bf16 v[24:27], v[56:59], a[64:67], v[24:27]
    v_exp_f32 v22, v22
    v_mfma_f32_16x16x32_bf16 v[24:27], v[60:63], a[68:71], v[24:27]
    s_waitcnt lgkmcnt(2)
    v_exp_f32 v23, v23
    v_mfma_f32_16x16x32_bf16 v[48:51], v[64:67], a[0:3], -4.0
    v_cvt_pk_bf16_f32 v20, v20, v21
    v_cvt_pk_bf16_f32 v21, v22, v23
    v_mfma_f32_16x16x32_bf16 v[48:51], v[68:71], a[4:7], v[48:51]
    ds_read_b64_tr_b16 v[32:33], v2 offset:32
    ds_read_b64_tr_b16 v[34:35], v2 offset:1568
    v_mfma_f32_16x16x32_bf16 v[48:51], v[72:75], a[8:11], v[48:51]
    v_exp_f32 v24, v24
    v_mfma_f32_16x16x32_bf16 v[48:51], v[76:79], a[12:15], v[48:51]
    s_waitcnt lgkmcnt(2)
    v_exp_f32 v25, v25
    v_mfma_f32_16x16x32_bf16 v[48:51], v[40:43], a[16:19], v[48:51]
    v_exp_f32 v26, v26
    v_mfma_f32_16x16x32_bf16 v[48:51], v[44:47], a[20:23], v[48:51]
    v_exp_f32 v27, v27
    v_mfma_f32_16x16x32_bf16 v[52:55], v[64:67], a[24:27], -4.0
    v_cvt_pk_bf16_f32 v24, v24, v25
    v_cvt_pk_bf16_f32 v25, v26, v27
    v_mfma_f32_16x16x32_bf16 v[52:55], v[68:71], a[28:31], v[52:55]
    ds_read_b64_tr_b16 v[36:37], v2 offset:64
    ds_read_b64_tr_b16 v[38:39], v2 offset:1600
    v_mfma_f32_16x16x32_bf16 v[52:55], v[72:75], a[32:35], v[52:55]
    v_exp_f32 v48, v48
    v_mfma_f32_16x16x32_bf16 v[52:55], v[76:79], a[36:39], v[52:55]
    v_exp_f32 v49, v49
    v_mfma_f32_16x16x32_bf16 v[52:55], v[40:43], a[40:43], v[52:55]
    v_exp_f32 v50, v50
    v_mfma_f32_16x16x32_bf16 v[52:55], v[44:47], a[44:47], v[52:55]
    v_exp_f32 v51, v51
    v_mfma_f32_16x16x32_bf16 v[56:59], v[64:67], a[48:51], -4.0
    v_cvt_pk_bf16_f32 v18, v48, v49
    v_cvt_pk_bf16_f32 v19, v50, v51
    v_mfma_f32_16x16x32_bf16 v[56:59], v[68:71], a[52:55], v[56:59]
    ds_read_b64_tr_b16 v[60:61], v2 offset:96
    ds_read_b64_tr_b16 v[62:63], v2 offset:1632
    v_mfma_f32_16x16x32_bf16 v[56:59], v[72:75], a[56:59], v[56:59]
    v_exp_f32 v52, v52
    v_mfma_f32_16x16x32_bf16 v[56:59], v[76:79], a[60:63], v[56:59]
    v_exp_f32 v53, v53
    v_mfma_f32_16x16x32_bf16 v[56:59], v[40:43], a[64:67], v[56:59]
    v_exp_f32 v54, v54
    v_mfma_f32_16x16x32_bf16 v[56:59], v[44:47], a[68:71], v[56:59]
    v_exp_f32 v55, v55
    v_mfma_f32_16x16x32_bf16 v[48:51], v[12:15], v[16:19], 0
    v_cvt_pk_bf16_f32 v22, v52, v53
    v_cvt_pk_bf16_f32 v23, v54, v55
    v_mfma_f32_16x16x32_bf16 v[80:83], v[16:19], v[28:31], v[80:83]
    s_waitcnt lgkmcnt(2)
    ds_read_b64_tr_b16 v[64:65], v2 offset:128
    ds_read_b64_tr_b16 v[66:67], v2 offset:1664
    v_mfma_f32_16x16x32_bf16 v[84:87], v[16:19], v[32:35], v[84:87]
    v_exp_f32 v56, v56
    v_mfma_f32_16x16x32_bf16 v[88:91], v[16:19], v[36:39], v[88:91]
    v_exp_f32 v57, v57
    v_mfma_f32_16x16x32_bf16 v[52:55], v[12:15], v[20:23], 0
    v_exp_f32 v58, v58
    v_mfma_f32_16x16x32_bf16 v[136:139], v[20:23], v[36:39], v[136:139]
    v_exp_f32 v59, v59
    v_mfma_f32_16x16x32_bf16 v[132:135], v[20:23], v[32:35], v[132:135]
    v_cvt_pk_bf16_f32 v26, v56, v57
    v_cvt_pk_bf16_f32 v27, v58, v59
    v_mfma_f32_16x16x32_bf16 v[128:131], v[20:23], v[28:31], v[128:131]
    s_nop 0
    ds_read_b64_tr_b16 v[68:69], v2 offset:160
    ds_read_b64_tr_b16 v[70:71], v2 offset:1696
    v_mfma_f32_16x16x32_bf16 v[176:179], v[24:27], v[28:31], v[176:179]
    ds_read_b64_tr_b16 v[72:73], v2 offset:192
    ds_read_b64_tr_b16 v[74:75], v2 offset:1728
    v_mfma_f32_16x16x32_bf16 v[180:183], v[24:27], v[32:35], v[180:183]
    v_add_f32 v4, v4, v48
    v_add_f32 v5, v5, v52
    v_mfma_f32_16x16x32_bf16 v[184:187], v[24:27], v[36:39], v[184:187]
    ds_read_b64_tr_b16 v[76:77], v2 offset:224
    ds_read_b64_tr_b16 v[78:79], v2 offset:1760
    v_mfma_f32_16x16x32_bf16 v[56:59], v[12:15], v[24:27], 0
    s_waitcnt lgkmcnt(6)
    v_mfma_f32_16x16x32_bf16 v[92:95], v[16:19], v[60:63], v[92:95]
    ds_read_b64_tr_b16 v[28:29], v2 offset:256
    ds_read_b64_tr_b16 v[30:31], v2 offset:1792
    v_mfma_f32_16x16x32_bf16 v[96:99], v[16:19], v[64:67], v[96:99]
    s_waitcnt lgkmcnt(6)
    v_mfma_f32_16x16x32_bf16 v[100:103], v[16:19], v[68:71], v[100:103]
    ds_read_b64_tr_b16 v[32:33], v2 offset:288
    ds_read_b64_tr_b16 v[34:35], v2 offset:1824
    v_mfma_f32_16x16x32_bf16 v[148:151], v[20:23], v[68:71], v[148:151]
    v_mfma_f32_16x16x32_bf16 v[144:147], v[20:23], v[64:67], v[144:147]
    ds_read_b64_tr_b16 v[36:37], v2 offset:320
    ds_read_b64_tr_b16 v[38:39], v2 offset:1856
    v_mfma_f32_16x16x32_bf16 v[140:143], v[20:23], v[60:63], v[140:143]
    v_add_f32 v6, v6, v56
    v_add_u32 v1, 0xfffed940, v1
    v_mfma_f32_16x16x32_bf16 v[188:191], v[24:27], v[60:63], v[188:191]
    v_mfma_f32_16x16x32_bf16 v[192:195], v[24:27], v[64:67], v[192:195]
    v_add_f32 v57, v4, v5
    v_min3_f32 v58, v4, v5, v6
    v_mfma_f32_16x16x32_bf16 v[196:199], v[24:27], v[68:71], v[196:199]
    s_waitcnt lgkmcnt(4)
    v_add_f32 v57, v57, v6
    v_cmp_gt_f32 s[50:51], s42, v58
    v_mfma_f32_16x16x32_bf16 v[104:107], v[16:19], v[72:75], v[104:107]
    ds_read_b64_tr_b16 v[64:65], v2 offset:352
    ds_read_b64_tr_b16 v[66:67], v2 offset:1888
    v_mfma_f32_16x16x32_bf16 v[108:111], v[16:19], v[76:79], v[108:111]
    v_cmp_nge_f32 s[48:49], s41, v57
    v_mfma_f32_16x16x32_bf16 v[112:115], v[16:19], v[28:31], v[112:115]
    ds_read_b128 v[40:43], v1 offset:0
    ds_read_b128 v[44:47], v1 offset:64
    v_mfma_f32_16x16x32_bf16 v[160:163], v[20:23], v[28:31], v[160:163]
    v_add_u32 v2, 0xfffed940, v2
    v_mfma_f32_16x16x32_bf16 v[156:159], v[20:23], v[76:79], v[156:159]
    ds_read_b128 v[48:51], v1 offset:128
    ds_read_b128 v[52:55], v1 offset:192
    v_mfma_f32_16x16x32_bf16 v[152:155], v[20:23], v[72:75], v[152:155]
    v_rcp_f32 v4, v4
    v_mfma_f32_16x16x32_bf16 v[200:203], v[24:27], v[72:75], v[200:203]
    ds_read_b128 v[56:59], v1 offset:256
    ds_read_b128 v[60:63], v1 offset:320
    v_mfma_f32_16x16x32_bf16 v[204:207], v[24:27], v[76:79], v[204:207]
    v_rcp_f32 v5, v5
    v_mfma_f32_16x16x32_bf16 v[208:211], v[24:27], v[28:31], v[208:211]
    s_waitcnt lgkmcnt(6)
    v_rcp_f32 v6, v6
    v_mfma_f32_16x16x32_bf16 v[116:119], v[16:19], v[32:35], v[116:119]
    ds_bpermute_b32 v11, v10, v4 offset:0
    ds_bpermute_b32 v3, v10, v4 offset:4
    v_mfma_f32_16x16x32_bf16 v[120:123], v[16:19], v[36:39], v[120:123]
    v_mfma_f32_16x16x32_bf16 v[124:127], v[16:19], v[64:67], v[124:127]
    s_or_b64 s[48:49], s[48:49], s[50:51]
    v_mfma_f32_16x16x32_bf16 v[172:175], v[20:23], v[64:67], v[172:175]
    v_mfma_f32_16x16x32_bf16 v[168:171], v[20:23], v[36:39], v[168:171]
    v_mfma_f32_16x16x32_bf16 v[164:167], v[20:23], v[32:35], v[164:167]
    v_mfma_f32_16x16x32_bf16 v[212:215], v[24:27], v[32:35], v[212:215]
    s_waitcnt lgkmcnt(0)
    v_mul_f32 v80, v11, v80
    v_mul_f32 v81, v3, v81
    v_mfma_f32_16x16x32_bf16 v[216:219], v[24:27], v[36:39], v[216:219]
    v_mul_f32 v84, v11, v84
    v_mul_f32 v85, v3, v85
    v_mfma_f32_16x16x32_bf16 v[220:223], v[24:27], v[64:67], v[220:223]
    v_mul_f32 v88, v11, v88
    v_mul_f32 v89, v3, v89
    v_mfma_f32_16x16x32_bf16 v[28:31], v[40:43], a[72:75], -4.0
    ds_read_b128 v[64:67], v1 offset:1536
    ds_read_b128 v[68:71], v1 offset:1600
    v_mul_f32 v92, v11, v92
    v_mul_f32 v93, v3, v93
    v_mfma_f32_16x16x32_bf16 v[28:31], v[44:47], a[76:79], v[28:31]
    ds_read_b128 v[72:75], v1 offset:1664
    ds_read_b128 v[76:79], v1 offset:1728
    v_cvt_pk_bf16_f32 v80, v80, v84
    v_cvt_pk_bf16_f32 v84, v81, v85
    v_mfma_f32_16x16x32_bf16 v[28:31], v[48:51], a[80:83], v[28:31]
    v_cvt_pk_bf16_f32 v81, v88, v92
    v_cvt_pk_bf16_f32 v85, v89, v93
    v_mfma_f32_16x16x32_bf16 v[28:31], v[52:55], a[84:87], v[28:31]
    ds_write_b64 v0, v[80:81] offset:0
    ds_write_b64 v0, v[84:85] offset:160
    v_mul_f32 v96, v11, v96
    v_mul_f32 v97, v3, v97
    v_mfma_f32_16x16x32_bf16 v[28:31], v[56:59], a[88:91], v[28:31]
    v_mul_f32 v100, v11, v100
    v_mul_f32 v101, v3, v101
    v_mul_f32 v104, v11, v104
    v_mul_f32 v105, v3, v105
    v_mfma_f32_16x16x32_bf16 v[28:31], v[60:63], a[92:95], v[28:31]
    v_mul_f32 v108, v11, v108
    v_mul_f32 v109, v3, v109
    v_cvt_pk_bf16_f32 v96, v96, v100
    v_cvt_pk_bf16_f32 v100, v97, v101
    v_mfma_f32_16x16x32_bf16 v[32:35], v[40:43], a[96:99], -4.0
    v_cvt_pk_bf16_f32 v97, v104, v108
    v_cvt_pk_bf16_f32 v101, v105, v109
    v_mfma_f32_16x16x32_bf16 v[32:35], v[44:47], a[100:103], v[32:35]
    ds_read_b64_tr_b16 v[16:17], v2 offset:0
    ds_read_b64_tr_b16 v[18:19], v2 offset:1536
    ds_write_b64 v0, v[96:97] offset:2560
    ds_write_b64 v0, v[100:101] offset:2720
    v_mfma_f32_16x16x32_bf16 v[32:35], v[48:51], a[104:107], v[32:35]
    v_exp_f32 v28, v28
    v_mul_f32 v112, v11, v112
    v_mul_f32 v113, v3, v113
    v_mfma_f32_16x16x32_bf16 v[32:35], v[52:55], a[108:111], v[32:35]
    v_exp_f32 v29, v29
    v_mul_f32 v116, v11, v116
    v_mul_f32 v117, v3, v117
    v_mfma_f32_16x16x32_bf16 v[32:35], v[56:59], a[112:115], v[32:35]
    v_exp_f32 v30, v30
    v_mul_f32 v120, v11, v120
    v_mul_f32 v121, v3, v121
    v_mfma_f32_16x16x32_bf16 v[32:35], v[60:63], a[116:119], v[32:35]
    v_exp_f32 v31, v31
    v_mul_f32 v124, v11, v124
    v_mul_f32 v125, v3, v125
    v_mfma_f32_16x16x32_bf16 v[36:39], v[40:43], a[120:123], -4.0
    v_cvt_pk_bf16_f32 v28, v28, v29
    v_cvt_pk_bf16_f32 v29, v30, v31
    v_cvt_pk_bf16_f32 v112, v112, v116
    v_cvt_pk_bf16_f32 v116, v113, v117
    v_mfma_f32_16x16x32_bf16 v[36:39], v[44:47], a[124:127], v[36:39]
    ds_read_b128 v[40:43], v1 offset:1792
    ds_read_b128 v[44:47], v1 offset:1856
    v_cvt_pk_bf16_f32 v113, v120, v124
    v_cvt_pk_bf16_f32 v117, v121, v125
    v_mfma_f32_16x16x32_bf16 v[36:39], v[48:51], a[128:131], v[36:39]
    ds_write_b64 v0, v[112:113] offset:5120
    ds_write_b64 v0, v[116:117] offset:5280
    v_exp_f32 v32, v32
    v_mfma_f32_16x16x32_bf16 v[36:39], v[52:55], a[132:135], v[36:39]
    s_waitcnt lgkmcnt(13)
    ds_bpermute_b32 v120, v10, v4 offset:8
    ds_bpermute_b32 v121, v10, v4 offset:12
    v_exp_f32 v33, v33
    v_mfma_f32_16x16x32_bf16 v[36:39], v[56:59], a[136:139], v[36:39]
    v_exp_f32 v34, v34
    v_mbcnt_lo_u32_b32 v92, -1, 0
    v_mbcnt_hi_u32_b32 v92, -1, v92
    v_mfma_f32_16x16x32_bf16 v[36:39], v[60:63], a[140:143], v[36:39]
    v_exp_f32 v35, v35
    v_bfe_u32 v88, v92, 4, 1
    v_lshrrev_b32 v93, 5, v92
    v_mfma_f32_16x16x32_bf16 v[48:51], v[64:67], a[72:75], -4.0
    s_waitcnt lgkmcnt(6)
    v_cvt_pk_bf16_f32 v32, v32, v33
    v_cvt_pk_bf16_f32 v33, v34, v35
    v_lshl_add_u32 v88, v88, 1, v93
    v_bfe_u32 v93, v92, 3, 1
    v_mfma_f32_16x16x32_bf16 v[48:51], v[68:71], a[76:79], v[48:51]
    ds_read_b64_tr_b16 v[20:21], v2 offset:32
    ds_read_b64_tr_b16 v[22:23], v2 offset:1568
    v_lshl_add_u32 v93, v88, 1, v93
    v_mul_u32_u24 v89, 384, v93
    v_mfma_f32_16x16x32_bf16 v[48:51], v[72:75], a[80:83], v[48:51]
    v_exp_f32 v36, v36
    v_and_b32 v93, 3, v92
    v_lshl_add_u32 v89, v93, 5, v89
    v_mfma_f32_16x16x32_bf16 v[48:51], v[76:79], a[84:87], v[48:51]
    s_waitcnt lgkmcnt(6)
    v_exp_f32 v37, v37
    v_bfe_u32 v93, v92, 2, 1
    v_lshl_add_u32 v89, v93, 4, v89
    v_mfma_f32_16x16x32_bf16 v[48:51], v[40:43], a[88:91], v[48:51]
    v_exp_f32 v38, v38
    v_bfe_u32 v93, v92, 1, 1
    v_lshl_add_u32 v88, v88, 1, v93
    v_mfma_f32_16x16x32_bf16 v[48:51], v[44:47], a[92:95], v[48:51]
    v_exp_f32 v39, v39
    v_mul_u32_u24 v88, 160, v88
    v_and_b32 v93, 1, v92
    v_mfma_f32_16x16x32_bf16 v[52:55], v[64:67], a[96:99], -4.0
    v_cvt_pk_bf16_f32 v36, v36, v37
    v_cvt_pk_bf16_f32 v37, v38, v39
    v_lshl_add_u32 v88, v93, 6, v88
    v_bfe_u32 v93, v92, 2, 2
    v_mfma_f32_16x16x32_bf16 v[52:55], v[68:71], a[100:103], v[52:55]
    ds_read_b64_tr_b16 v[24:25], v2 offset:64
    ds_read_b64_tr_b16 v[26:27], v2 offset:1600
    v_lshl_add_u32 v88, v93, 3, v88
    v_add_u32 v88, s46, v88
    v_mfma_f32_16x16x32_bf16 v[52:55], v[72:75], a[104:107], v[52:55]
    s_waitcnt lgkmcnt(4)
    v_exp_f32 v48, v48
    v_mul_f32 v82, v120, v82
    v_mul_f32 v83, v121, v83
    v_mfma_f32_16x16x32_bf16 v[52:55], v[76:79], a[108:111], v[52:55]
    v_exp_f32 v49, v49
    v_mul_f32 v86, v120, v86
    v_mul_f32 v87, v121, v87
    v_mfma_f32_16x16x32_bf16 v[52:55], v[40:43], a[112:115], v[52:55]
    v_exp_f32 v50, v50
    v_mul_f32 v90, v120, v90
    v_mul_f32 v91, v121, v91
    v_mfma_f32_16x16x32_bf16 v[52:55], v[44:47], a[116:119], v[52:55]
    v_exp_f32 v51, v51
    v_mul_f32 v94, v120, v94
    v_mul_f32 v95, v121, v95
    v_mfma_f32_16x16x32_bf16 v[56:59], v[64:67], a[120:123], -4.0
    v_cvt_pk_bf16_f32 v30, v48, v49
    v_cvt_pk_bf16_f32 v31, v50, v51
    v_cvt_pk_bf16_f32 v82, v82, v86
    v_cvt_pk_bf16_f32 v86, v83, v87
    v_mfma_f32_16x16x32_bf16 v[56:59], v[68:71], a[124:127], v[56:59]
    ds_read_b64_tr_b16 v[60:61], v2 offset:96
    ds_read_b64_tr_b16 v[62:63], v2 offset:1632
    v_cvt_pk_bf16_f32 v83, v90, v94
    v_cvt_pk_bf16_f32 v87, v91, v95
    v_mfma_f32_16x16x32_bf16 v[56:59], v[72:75], a[128:131], v[56:59]
    ds_write_b64 v0, v[82:83] offset:320
    ds_write_b64 v0, v[86:87] offset:480
    v_exp_f32 v52, v52
    v_mfma_f32_16x16x32_bf16 v[56:59], v[76:79], a[132:135], v[56:59]
    ds_read_b64_tr_b16 v[80:81], v88 offset:0
    ds_read_b64_tr_b16 v[82:83], v88 offset:32
    v_exp_f32 v53, v53
    v_mfma_f32_16x16x32_bf16 v[56:59], v[40:43], a[136:139], v[56:59]
    ds_read_b64_tr_b16 v[84:85], v88 offset:1280
    ds_read_b64_tr_b16 v[86:87], v88 offset:1312
    v_exp_f32 v54, v54
    v_mfma_f32_16x16x32_bf16 v[56:59], v[44:47], a[140:143], v[56:59]
    v_exp_f32 v55, v55
    v_mul_f32 v98, v120, v98
    v_mul_f32 v99, v121, v99
    v_mfma_f32_16x16x32_bf16 v[48:51], v[12:15], v[28:31], 0
    v_cvt_pk_bf16_f32 v34, v52, v53
    v_cvt_pk_bf16_f32 v35, v54, v55
    v_mul_f32 v102, v120, v102
    v_mul_f32 v103, v121, v103
    v_mfma_f32_16x16x32_bf16 a[240:243], v[28:31], v[16:19], a[240:243]
    s_waitcnt lgkmcnt(8)
    ds_read_b64_tr_b16 v[64:65], v2 offset:128
    ds_read_b64_tr_b16 v[66:67], v2 offset:1664
    v_mul_f32 v106, v120, v106
    v_mul_f32 v107, v121, v107
    v_mfma_f32_16x16x32_bf16 a[244:247], v[28:31], v[20:23], a[244:247]
    v_exp_f32 v56, v56
    v_mul_f32 v110, v120, v110
    v_mul_f32 v111, v121, v111
    v_mfma_f32_16x16x32_bf16 a[248:251], v[28:31], v[24:27], a[248:251]
    s_waitcnt lgkmcnt(4)
    buffer_store_dwordx4 v[80:83], v89, s[24:27], s72 offen offset:0 sc0 sc1
    v_exp_f32 v57, v57
    v_mfma_f32_16x16x32_bf16 v[52:55], v[12:15], v[32:35], 0
    v_exp_f32 v58, v58
    v_cvt_pk_bf16_f32 v98, v98, v102
    v_cvt_pk_bf16_f32 v102, v99, v103
    v_mfma_f32_16x16x32_bf16 a[200:203], v[32:35], v[24:27], a[200:203]
    v_exp_f32 v59, v59
    v_cvt_pk_bf16_f32 v99, v106, v110
    v_cvt_pk_bf16_f32 v103, v107, v111
    v_mfma_f32_16x16x32_bf16 a[196:199], v[32:35], v[20:23], a[196:199]
    ds_write_b64 v0, v[98:99] offset:2880
    ds_write_b64 v0, v[102:103] offset:3040
    v_cvt_pk_bf16_f32 v38, v56, v57
    v_cvt_pk_bf16_f32 v39, v58, v59
    v_mfma_f32_16x16x32_bf16 a[192:195], v[32:35], v[16:19], a[192:195]
    s_nop 0
    ds_read_b64_tr_b16 v[68:69], v2 offset:160
    ds_read_b64_tr_b16 v[70:71], v2 offset:1696
    ds_read_b64_tr_b16 v[96:97], v88 offset:2560
    ds_read_b64_tr_b16 v[98:99], v88 offset:2592
    v_mfma_f32_16x16x32_bf16 a[144:147], v[36:39], v[16:19], a[144:147]
    s_waitcnt lgkmcnt(8)
    buffer_store_dwordx4 v[84:87], v89, s[24:27], s72 offen offset:3072 sc0 sc1
    ds_read_b64_tr_b16 v[72:73], v2 offset:192
    ds_read_b64_tr_b16 v[74:75], v2 offset:1728
    v_mfma_f32_16x16x32_bf16 a[148:151], v[36:39], v[20:23], a[148:151]
    ds_read_b64_tr_b16 v[100:101], v88 offset:3840
    ds_read_b64_tr_b16 v[102:103], v88 offset:3872
    v_add_f32 v7, v7, v48
    v_add_f32 v8, v8, v52
    v_mfma_f32_16x16x32_bf16 a[152:155], v[36:39], v[24:27], a[152:155]
    ds_read_b64_tr_b16 v[76:77], v2 offset:224
    ds_read_b64_tr_b16 v[78:79], v2 offset:1760
    v_mul_f32 v114, v120, v114
    v_mul_f32 v115, v121, v115
    v_mfma_f32_16x16x32_bf16 v[56:59], v[12:15], v[36:39], 0
    v_mul_f32 v118, v120, v118
    v_mul_f32 v119, v121, v119
    v_mul_f32 v122, v120, v122
    v_mul_f32 v123, v121, v123
    v_mfma_f32_16x16x32_bf16 a[252:255], v[28:31], v[60:63], a[252:255]
    s_waitcnt lgkmcnt(12)
    ds_read_b64_tr_b16 v[16:17], v2 offset:256
    ds_read_b64_tr_b16 v[18:19], v2 offset:1792
    v_mul_f32 v126, v120, v126
    v_mul_f32 v127, v121, v127
    v_mfma_f32_16x16x32_bf16 v[224:227], v[28:31], v[64:67], v[224:227]
    s_waitcnt lgkmcnt(8)
    buffer_store_dwordx4 v[96:99], v89, s[24:27], s72 offen offset:128 sc0 sc1
    v_mfma_f32_16x16x32_bf16 v[228:231], v[28:31], v[68:71], v[228:231]
    ds_read_b64_tr_b16 v[20:21], v2 offset:288
    ds_read_b64_tr_b16 v[22:23], v2 offset:1824
    ds_bpermute_b32 v104, v10, v5 offset:0
    ds_bpermute_b32 v105, v10, v5 offset:4
    v_mfma_f32_16x16x32_bf16 a[212:215], v[32:35], v[68:71], a[212:215]
    ds_bpermute_b32 v106, v10, v5 offset:8
    ds_bpermute_b32 v107, v10, v5 offset:12
    v_cvt_pk_bf16_f32 v114, v114, v118
    v_cvt_pk_bf16_f32 v118, v115, v119
    v_mfma_f32_16x16x32_bf16 a[208:211], v[32:35], v[64:67], a[208:211]
    s_waitcnt lgkmcnt(13)
    ds_read_b64_tr_b16 v[24:25], v2 offset:320
    ds_read_b64_tr_b16 v[26:27], v2 offset:1856
    v_cvt_pk_bf16_f32 v115, v122, v126
    v_cvt_pk_bf16_f32 v119, v123, v127
    v_mfma_f32_16x16x32_bf16 a[204:207], v[32:35], v[60:63], a[204:207]
    s_waitcnt lgkmcnt(13)
    ds_write_b64 v0, v[114:115] offset:5440
    ds_write_b64 v0, v[118:119] offset:5600
    v_add_f32 v9, v9, v56
    v_add_u32 v1, 0x6240, v1
    v_mfma_f32_16x16x32_bf16 a[156:159], v[36:39], v[60:63], a[156:159]
    s_waitcnt lgkmcnt(14)
    buffer_store_dwordx4 v[100:103], v89, s[24:27], s72 offen offset:3200 sc0 sc1
    v_mfma_f32_16x16x32_bf16 a[160:163], v[36:39], v[64:67], a[160:163]
    s_waitcnt lgkmcnt(11)
    ds_read_b64_tr_b16 v[112:113], v88 offset:5120
    ds_read_b64_tr_b16 v[114:115], v88 offset:5152
    ds_read_b64_tr_b16 v[116:117], v88 offset:6400
    ds_read_b64_tr_b16 v[118:119], v88 offset:6432
    v_mfma_f32_16x16x32_bf16 a[164:167], v[36:39], v[68:71], a[164:167]
    s_waitcnt lgkmcnt(10)
    v_mul_f32 v128, v104, v128
    v_mul_f32 v129, v105, v129
    v_mul_f32 v132, v104, v132
    v_mul_f32 v133, v105, v133
    v_mfma_f32_16x16x32_bf16 v[232:235], v[28:31], v[72:75], v[232:235]
    ds_read_b64_tr_b16 v[64:65], v2 offset:352
    ds_read_b64_tr_b16 v[66:67], v2 offset:1888
    v_mul_f32 v136, v104, v136
    v_mul_f32 v137, v105, v137
    v_mfma_f32_16x16x32_bf16 v[236:239], v[28:31], v[76:79], v[236:239]
    v_mul_f32 v140, v104, v140
    v_mul_f32 v141, v105, v141
    v_cvt_pk_bf16_f32 v128, v128, v132
    v_cvt_pk_bf16_f32 v132, v129, v133
    v_mfma_f32_16x16x32_bf16 v[240:243], v[28:31], v[16:19], v[240:243]
    ds_read_b128 v[40:43], v1 offset:0
    ds_read_b128 v[44:47], v1 offset:64
    v_cvt_pk_bf16_f32 v129, v136, v140
    v_cvt_pk_bf16_f32 v133, v137, v141
    v_mfma_f32_16x16x32_bf16 a[224:227], v[32:35], v[16:19], a[224:227]
    s_waitcnt lgkmcnt(13)
    ds_write_b64 v0, v[128:129] offset:7680
    ds_write_b64 v0, v[132:133] offset:7840
    v_add_u32 v2, 0x6240, v2
    v_mul_f32 v130, v106, v130
    v_mfma_f32_16x16x32_bf16 a[220:223], v[32:35], v[76:79], a[220:223]
    s_waitcnt lgkmcnt(8)
    buffer_store_dwordx4 v[112:115], v89, s[24:27], s72 offen offset:256 sc0 sc1
    ds_read_b128 v[48:51], v1 offset:128
    ds_read_b128 v[52:55], v1 offset:192
    v_mfma_f32_16x16x32_bf16 a[216:219], v[32:35], v[72:75], a[216:219]
    v_mul_f32 v131, v107, v131
    v_mul_f32 v134, v106, v134
    v_mul_f32 v135, v107, v135
    v_mul_f32 v138, v106, v138
    v_mfma_f32_16x16x32_bf16 a[168:171], v[36:39], v[72:75], a[168:171]
    ds_read_b128 v[56:59], v1 offset:256
    ds_read_b128 v[60:63], v1 offset:320
    v_mul_f32 v139, v107, v139
    v_mul_f32 v142, v106, v142
    v_mfma_f32_16x16x32_bf16 a[172:175], v[36:39], v[76:79], a[172:175]
    v_mul_f32 v143, v107, v143
    v_cvt_pk_bf16_f32 v130, v130, v134
    v_cvt_pk_bf16_f32 v134, v131, v135
    v_cvt_pk_bf16_f32 v131, v138, v142
    v_mfma_f32_16x16x32_bf16 a[176:179], v[36:39], v[16:19], a[176:179]
    v_cvt_pk_bf16_f32 v135, v139, v143
    v_mfma_f32_16x16x32_bf16 v[244:247], v[28:31], v[20:23], v[244:247]
    s_waitcnt lgkmcnt(10)
    buffer_store_dwordx4 v[116:119], v89, s[24:27], s72 offen offset:3328 sc0 sc1
    v_mfma_f32_16x16x32_bf16 v[248:251], v[28:31], v[24:27], v[248:251]
    s_waitcnt lgkmcnt(6)
    ds_write_b64 v0, v[130:131] offset:8000
    ds_write_b64 v0, v[134:135] offset:8160
    ds_read_b64_tr_b16 v[128:129], v88 offset:7680
    ds_read_b64_tr_b16 v[130:131], v88 offset:7712
    v_mfma_f32_16x16x32_bf16 v[252:255], v[28:31], v[64:67], v[252:255]
    ds_read_b64_tr_b16 v[132:133], v88 offset:8960
    ds_read_b64_tr_b16 v[134:135], v88 offset:8992
    v_mul_f32 v144, v104, v144
    v_mul_f32 v145, v105, v145
    v_mfma_f32_16x16x32_bf16 a[236:239], v[32:35], v[64:67], a[236:239]
    v_mul_f32 v148, v104, v148
    v_mul_f32 v149, v105, v149
    v_mul_f32 v152, v104, v152
    v_mul_f32 v153, v105, v153
    v_mfma_f32_16x16x32_bf16 a[232:235], v[32:35], v[24:27], a[232:235]
    v_mul_f32 v156, v104, v156
    v_mul_f32 v157, v105, v157
    v_cvt_pk_bf16_f32 v144, v144, v148
    v_cvt_pk_bf16_f32 v148, v145, v149
    v_mfma_f32_16x16x32_bf16 a[228:231], v[32:35], v[20:23], a[228:231]
    v_cvt_pk_bf16_f32 v145, v152, v156
    v_cvt_pk_bf16_f32 v149, v153, v157
    v_mfma_f32_16x16x32_bf16 a[180:183], v[36:39], v[20:23], a[180:183]
    ds_write_b64 v0, v[144:145] offset:10240
    ds_write_b64 v0, v[148:149] offset:10400
    v_mul_f32 v146, v106, v146
    v_mul_f32 v147, v107, v147
    v_mfma_f32_16x16x32_bf16 a[184:187], v[36:39], v[24:27], a[184:187]
    s_waitcnt lgkmcnt(4)
    buffer_store_dwordx4 v[128:131], v89, s[24:27], s73 offen offset:0 sc0 sc1
    v_mfma_f32_16x16x32_bf16 a[188:191], v[36:39], v[64:67], a[188:191]
    v_mul_f32 v150, v106, v150
    v_mul_f32 v151, v107, v151
    v_mul_f32 v154, v106, v154
    v_mul_f32 v155, v107, v155
    v_mfma_f32_16x16x32_bf16 v[28:31], v[40:43], a[72:75], -4.0
    ds_read_b128 v[64:67], v1 offset:1536
    ds_read_b128 v[68:71], v1 offset:1600
    v_mul_f32 v158, v106, v158
    v_mfma_f32_16x16x32_bf16 v[28:31], v[44:47], a[76:79], v[28:31]
    ds_read_b128 v[72:75], v1 offset:1664
    ds_read_b128 v[76:79], v1 offset:1728
    v_mul_f32 v159, v107, v159
    v_mfma_f32_16x16x32_bf16 v[28:31], v[48:51], a[80:83], v[28:31]
    v_cvt_pk_bf16_f32 v146, v146, v150
    v_cvt_pk_bf16_f32 v150, v147, v151
    v_cvt_pk_bf16_f32 v147, v154, v158
    v_mfma_f32_16x16x32_bf16 v[28:31], v[52:55], a[84:87], v[28:31]
    s_waitcnt lgkmcnt(6)
    buffer_store_dwordx4 v[132:135], v89, s[24:27], s73 offen offset:3072 sc0 sc1
    v_mfma_f32_16x16x32_bf16 v[28:31], v[56:59], a[88:91], v[28:31]
    v_cvt_pk_bf16_f32 v151, v155, v159
    v_mfma_f32_16x16x32_bf16 v[28:31], v[60:63], a[92:95], v[28:31]
    ds_write_b64 v0, v[146:147] offset:10560
    ds_write_b64 v0, v[150:151] offset:10720
    ds_read_b64_tr_b16 v[144:145], v88 offset:10240
    v_mfma_f32_16x16x32_bf16 v[32:35], v[40:43], a[96:99], -4.0
    ds_read_b64_tr_b16 v[146:147], v88 offset:10272
    ds_read_b64_tr_b16 v[148:149], v88 offset:11520
    ds_read_b64_tr_b16 v[150:151], v88 offset:11552
    v_mfma_f32_16x16x32_bf16 v[32:35], v[44:47], a[100:103], v[32:35]
    ds_read_b64_tr_b16 v[16:17], v2 offset:0
    ds_read_b64_tr_b16 v[18:19], v2 offset:1536
    v_mul_f32 v160, v104, v160
    v_mfma_f32_16x16x32_bf16 v[32:35], v[48:51], a[104:107], v[32:35]
    v_exp_f32 v28, v28
    v_mul_f32 v161, v105, v161
    v_mfma_f32_16x16x32_bf16 v[32:35], v[52:55], a[108:111], v[32:35]
    v_exp_f32 v29, v29
    v_mul_f32 v164, v104, v164
    v_mfma_f32_16x16x32_bf16 v[32:35], v[56:59], a[112:115], v[32:35]
    v_exp_f32 v30, v30
    v_mul_f32 v165, v105, v165
    v_mfma_f32_16x16x32_bf16 v[32:35], v[60:63], a[116:119], v[32:35]
    v_exp_f32 v31, v31
    v_mul_f32 v168, v104, v168
    v_mfma_f32_16x16x32_bf16 v[36:39], v[40:43], a[120:123], -4.0
    v_cvt_pk_bf16_f32 v28, v28, v29
    v_cvt_pk_bf16_f32 v29, v30, v31
    v_mul_f32 v169, v105, v169
    v_mfma_f32_16x16x32_bf16 v[36:39], v[44:47], a[124:127], v[36:39]
    s_waitcnt lgkmcnt(13)
    ds_read_b128 v[40:43], v1 offset:1792
    ds_read_b128 v[44:47], v1 offset:1856
    v_mul_f32 v172, v104, v172
    v_mfma_f32_16x16x32_bf16 v[36:39], v[48:51], a[128:131], v[36:39]
    v_exp_f32 v32, v32
    v_mul_f32 v173, v105, v173
    v_mfma_f32_16x16x32_bf16 v[36:39], v[52:55], a[132:135], v[36:39]
    s_waitcnt lgkmcnt(6)
    buffer_store_dwordx4 v[144:147], v89, s[24:27], s73 offen offset:128 sc0 sc1
    v_exp_f32 v33, v33
    v_mfma_f32_16x16x32_bf16 v[36:39], v[56:59], a[136:139], v[36:39]
    ds_bpermute_b32 v120, v10, v6 offset:0
    v_exp_f32 v34, v34
    v_mfma_f32_16x16x32_bf16 v[36:39], v[60:63], a[140:143], v[36:39]
    ds_bpermute_b32 v121, v10, v6 offset:4
    v_exp_f32 v35, v35
    v_mfma_f32_16x16x32_bf16 v[48:51], v[64:67], a[72:75], -4.0
    ds_bpermute_b32 v122, v10, v6 offset:8
    v_cvt_pk_bf16_f32 v32, v32, v33
    v_cvt_pk_bf16_f32 v33, v34, v35
    v_mfma_f32_16x16x32_bf16 v[48:51], v[68:71], a[76:79], v[48:51]
    ds_read_b64_tr_b16 v[20:21], v2 offset:32
    ds_read_b64_tr_b16 v[22:23], v2 offset:1568
    ds_bpermute_b32 v123, v10, v6 offset:12
    v_mfma_f32_16x16x32_bf16 v[48:51], v[72:75], a[80:83], v[48:51]
    s_waitcnt lgkmcnt(10)
    buffer_store_dwordx4 v[148:151], v89, s[24:27], s73 offen offset:3200 sc0 sc1
    v_exp_f32 v36, v36
    v_mfma_f32_16x16x32_bf16 v[48:51], v[76:79], a[84:87], v[48:51]
    s_waitcnt lgkmcnt(6)
    v_exp_f32 v37, v37
    v_cvt_pk_bf16_f32 v160, v160, v164
    v_mfma_f32_16x16x32_bf16 v[48:51], v[40:43], a[88:91], v[48:51]
    v_exp_f32 v38, v38
    v_cvt_pk_bf16_f32 v164, v161, v165
    v_mfma_f32_16x16x32_bf16 v[48:51], v[44:47], a[92:95], v[48:51]
    v_exp_f32 v39, v39
    v_cvt_pk_bf16_f32 v161, v168, v172
    v_mfma_f32_16x16x32_bf16 v[52:55], v[64:67], a[96:99], -4.0
    v_cvt_pk_bf16_f32 v36, v36, v37
    v_cvt_pk_bf16_f32 v37, v38, v39
    v_cvt_pk_bf16_f32 v165, v169, v173
    v_mfma_f32_16x16x32_bf16 v[52:55], v[68:71], a[100:103], v[52:55]
    ds_read_b64_tr_b16 v[24:25], v2 offset:64
    ds_read_b64_tr_b16 v[26:27], v2 offset:1600
    ds_write_b64 v0, v[160:161] offset:12800
    v_mfma_f32_16x16x32_bf16 v[52:55], v[72:75], a[104:107], v[52:55]
    ds_write_b64 v0, v[164:165] offset:12960
    v_exp_f32 v48, v48
    v_mfma_f32_16x16x32_bf16 v[52:55], v[76:79], a[108:111], v[52:55]
    v_exp_f32 v49, v49
    v_mul_f32 v162, v106, v162
    v_mfma_f32_16x16x32_bf16 v[52:55], v[40:43], a[112:115], v[52:55]
    v_exp_f32 v50, v50
    v_mul_f32 v163, v107, v163
    v_mfma_f32_16x16x32_bf16 v[52:55], v[44:47], a[116:119], v[52:55]
    v_exp_f32 v51, v51
    v_mul_f32 v166, v106, v166
    v_mfma_f32_16x16x32_bf16 v[56:59], v[64:67], a[120:123], -4.0
    v_cvt_pk_bf16_f32 v30, v48, v49
    v_cvt_pk_bf16_f32 v31, v50, v51
    v_mul_f32 v167, v107, v167
    v_mfma_f32_16x16x32_bf16 v[56:59], v[68:71], a[124:127], v[56:59]
    ds_read_b64_tr_b16 v[60:61], v2 offset:96
    ds_read_b64_tr_b16 v[62:63], v2 offset:1632
    v_mul_f32 v170, v106, v170
    v_mfma_f32_16x16x32_bf16 v[56:59], v[72:75], a[128:131], v[56:59]
    v_exp_f32 v52, v52
    v_mul_f32 v171, v107, v171
    v_mfma_f32_16x16x32_bf16 v[56:59], v[76:79], a[132:135], v[56:59]
    v_exp_f32 v53, v53
    v_mul_f32 v174, v106, v174
    v_mfma_f32_16x16x32_bf16 v[56:59], v[40:43], a[136:139], v[56:59]
    v_exp_f32 v54, v54
    v_mul_f32 v175, v107, v175
    v_mfma_f32_16x16x32_bf16 v[56:59], v[44:47], a[140:143], v[56:59]
    v_exp_f32 v55, v55
    v_cvt_pk_bf16_f32 v162, v162, v166
    v_mfma_f32_16x16x32_bf16 v[48:51], v[12:15], v[28:31], 0
    v_cvt_pk_bf16_f32 v34, v52, v53
    v_cvt_pk_bf16_f32 v35, v54, v55
    v_cvt_pk_bf16_f32 v166, v163, v167
    v_mfma_f32_16x16x32_bf16 a[240:243], v[28:31], v[16:19], a[240:243]
    s_waitcnt lgkmcnt(2)
    ds_read_b64_tr_b16 v[64:65], v2 offset:128
    ds_read_b64_tr_b16 v[66:67], v2 offset:1664
    v_cvt_pk_bf16_f32 v163, v170, v174
    v_mfma_f32_16x16x32_bf16 a[244:247], v[28:31], v[20:23], a[244:247]
    v_exp_f32 v56, v56
    v_cvt_pk_bf16_f32 v167, v171, v175
    v_mfma_f32_16x16x32_bf16 a[248:251], v[28:31], v[24:27], a[248:251]
    ds_write_b64 v0, v[162:163] offset:13120
    v_exp_f32 v57, v57
    v_mfma_f32_16x16x32_bf16 v[52:55], v[12:15], v[32:35], 0
    ds_write_b64 v0, v[166:167] offset:13280
    v_exp_f32 v58, v58
    v_mfma_f32_16x16x32_bf16 a[200:203], v[32:35], v[24:27], a[200:203]
    ds_read_b64_tr_b16 v[160:161], v88 offset:12800
    v_exp_f32 v59, v59
    v_mfma_f32_16x16x32_bf16 a[196:199], v[32:35], v[20:23], a[196:199]
    ds_read_b64_tr_b16 v[162:163], v88 offset:12832
    v_cvt_pk_bf16_f32 v38, v56, v57
    v_cvt_pk_bf16_f32 v39, v58, v59
    v_mfma_f32_16x16x32_bf16 a[192:195], v[32:35], v[16:19], a[192:195]
    s_nop 0
    ds_read_b64_tr_b16 v[68:69], v2 offset:160
    ds_read_b64_tr_b16 v[70:71], v2 offset:1696
    ds_read_b64_tr_b16 v[164:165], v88 offset:14080
    v_mfma_f32_16x16x32_bf16 a[144:147], v[36:39], v[16:19], a[144:147]
    ds_read_b64_tr_b16 v[72:73], v2 offset:192
    ds_read_b64_tr_b16 v[74:75], v2 offset:1728
    ds_read_b64_tr_b16 v[166:167], v88 offset:14112
    v_mfma_f32_16x16x32_bf16 a[148:151], v[36:39], v[20:23], a[148:151]
    v_add_f32 v7, v7, v48
    v_add_f32 v8, v8, v52
    v_mul_f32 v176, v120, v176
    v_mfma_f32_16x16x32_bf16 a[152:155], v[36:39], v[24:27], a[152:155]
    s_waitcnt lgkmcnt(13)
    ds_read_b64_tr_b16 v[76:77], v2 offset:224
    ds_read_b64_tr_b16 v[78:79], v2 offset:1760
    v_mul_f32 v177, v121, v177
    v_mfma_f32_16x16x32_bf16 v[56:59], v[12:15], v[36:39], 0
    s_waitcnt lgkmcnt(11)
    v_mul_f32 v180, v120, v180
    v_mul_f32 v181, v121, v181
    v_mul_f32 v184, v120, v184
    v_mfma_f32_16x16x32_bf16 a[252:255], v[28:31], v[60:63], a[252:255]
    ds_read_b64_tr_b16 v[16:17], v2 offset:256
    ds_read_b64_tr_b16 v[18:19], v2 offset:1792
    v_mul_f32 v185, v121, v185
    v_mfma_f32_16x16x32_bf16 v[224:227], v[28:31], v[64:67], v[224:227]
    s_waitcnt lgkmcnt(8)
    v_mul_f32 v188, v120, v188
    v_mul_f32 v189, v121, v189
    v_cvt_pk_bf16_f32 v176, v176, v180
    v_mfma_f32_16x16x32_bf16 v[228:231], v[28:31], v[68:71], v[228:231]
    buffer_store_dwordx4 v[160:163], v89, s[24:27], s73 offen offset:256 sc0 sc1
    ds_read_b64_tr_b16 v[20:21], v2 offset:288
    ds_read_b64_tr_b16 v[22:23], v2 offset:1824
    v_mfma_f32_16x16x32_bf16 a[212:215], v[32:35], v[68:71], a[212:215]
    v_cvt_pk_bf16_f32 v180, v177, v181
    v_cvt_pk_bf16_f32 v177, v184, v188
    v_cvt_pk_bf16_f32 v181, v185, v189
    v_mfma_f32_16x16x32_bf16 a[208:211], v[32:35], v[64:67], a[208:211]
    ds_read_b64_tr_b16 v[24:25], v2 offset:320
    ds_read_b64_tr_b16 v[26:27], v2 offset:1856
    ds_write_b64 v0, v[176:177] offset:0
    v_mfma_f32_16x16x32_bf16 a[204:207], v[32:35], v[60:63], a[204:207]
    ds_write_b64 v0, v[180:181] offset:160
    v_add_f32 v9, v9, v56
    v_add_u32 v1, 0x6240, v1
    v_mfma_f32_16x16x32_bf16 a[156:159], v[36:39], v[60:63], a[156:159]
    v_mul_f32 v178, v122, v178
    v_mul_f32 v179, v123, v179
    v_mul_f32 v182, v122, v182
    v_mfma_f32_16x16x32_bf16 a[160:163], v[36:39], v[64:67], a[160:163]
    s_waitcnt lgkmcnt(10)
    buffer_store_dwordx4 v[164:167], v89, s[24:27], s73 offen offset:3328 sc0 sc1
    v_mfma_f32_16x16x32_bf16 a[164:167], v[36:39], v[68:71], a[164:167]
    v_mul_f32 v183, v123, v183
    v_mul_f32 v186, v122, v186
    v_mul_f32 v187, v123, v187
    v_mfma_f32_16x16x32_bf16 v[232:235], v[28:31], v[72:75], v[232:235]
    s_waitcnt lgkmcnt(6)
    ds_read_b64_tr_b16 v[64:65], v2 offset:352
    ds_read_b64_tr_b16 v[66:67], v2 offset:1888
    v_mul_f32 v190, v122, v190
    v_mfma_f32_16x16x32_bf16 v[236:239], v[28:31], v[76:79], v[236:239]
    v_mul_f32 v191, v123, v191
    v_cvt_pk_bf16_f32 v178, v178, v182
    v_cvt_pk_bf16_f32 v182, v179, v183
    v_mfma_f32_16x16x32_bf16 v[240:243], v[28:31], v[16:19], v[240:243]
    ds_read_b128 v[40:43], v1 offset:0
    ds_read_b128 v[44:47], v1 offset:64
    v_cvt_pk_bf16_f32 v179, v186, v190
    v_mfma_f32_16x16x32_bf16 a[224:227], v[32:35], v[16:19], a[224:227]
    v_add_u32 v2, 0x6240, v2
    v_cvt_pk_bf16_f32 v183, v187, v191
    v_mfma_f32_16x16x32_bf16 a[220:223], v[32:35], v[76:79], a[220:223]
    ds_read_b128 v[48:51], v1 offset:128
    ds_read_b128 v[52:55], v1 offset:192
    ds_write_b64 v0, v[178:179] offset:320
    v_mfma_f32_16x16x32_bf16 a[216:219], v[32:35], v[72:75], a[216:219]
    s_waitcnt lgkmcnt(12)
    ds_write_b64 v0, v[182:183] offset:480
    ds_read_b64_tr_b16 v[80:81], v88 offset:0
    ds_read_b64_tr_b16 v[82:83], v88 offset:32
    v_mfma_f32_16x16x32_bf16 a[168:171], v[36:39], v[72:75], a[168:171]
    s_waitcnt lgkmcnt(12)
    ds_read_b128 v[56:59], v1 offset:256
    ds_read_b128 v[60:63], v1 offset:320
    ds_read_b64_tr_b16 v[84:85], v88 offset:1280
    v_mfma_f32_16x16x32_bf16 a[172:175], v[36:39], v[76:79], a[172:175]
    s_waitcnt lgkmcnt(14)
    ds_read_b64_tr_b16 v[86:87], v88 offset:1312
    v_mul_f32 v192, v120, v192
    v_mul_f32 v193, v121, v193
    v_mfma_f32_16x16x32_bf16 a[176:179], v[36:39], v[16:19], a[176:179]
    v_mul_f32 v196, v120, v196
    v_mul_f32 v197, v121, v197
    v_mul_f32 v200, v120, v200
    v_mfma_f32_16x16x32_bf16 v[244:247], v[28:31], v[20:23], v[244:247]
    v_mul_f32 v201, v121, v201
    v_mul_f32 v204, v120, v204
    v_mul_f32 v205, v121, v205
    v_mfma_f32_16x16x32_bf16 v[248:251], v[28:31], v[24:27], v[248:251]
    s_waitcnt lgkmcnt(10)
    v_cvt_pk_bf16_f32 v192, v192, v196
    v_cvt_pk_bf16_f32 v196, v193, v197
    v_cvt_pk_bf16_f32 v193, v200, v204
    v_mfma_f32_16x16x32_bf16 v[252:255], v[28:31], v[64:67], v[252:255]
    s_waitcnt lgkmcnt(4)
    buffer_store_dwordx4 v[80:83], v89, s[24:27], s74 offen offset:0 sc0 sc1
    v_mfma_f32_16x16x32_bf16 a[236:239], v[32:35], v[64:67], a[236:239]
    v_cvt_pk_bf16_f32 v197, v201, v205
    v_mfma_f32_16x16x32_bf16 a[232:235], v[32:35], v[24:27], a[232:235]
    ds_write_b64 v0, v[192:193] offset:2560
    ds_write_b64 v0, v[196:197] offset:2720
    v_mul_f32 v194, v122, v194
    v_mfma_f32_16x16x32_bf16 a[228:231], v[32:35], v[20:23], a[228:231]
    v_mul_f32 v195, v123, v195
    v_mul_f32 v198, v122, v198
    v_mul_f32 v199, v123, v199
    v_mfma_f32_16x16x32_bf16 a[180:183], v[36:39], v[20:23], a[180:183]
    v_mul_f32 v202, v122, v202
    v_mul_f32 v203, v123, v203
    v_mul_f32 v206, v122, v206
    v_mfma_f32_16x16x32_bf16 a[184:187], v[36:39], v[24:27], a[184:187]
    s_waitcnt lgkmcnt(2)
    buffer_store_dwordx4 v[84:87], v89, s[24:27], s74 offen offset:3072 sc0 sc1
    v_mfma_f32_16x16x32_bf16 a[188:191], v[36:39], v[64:67], a[188:191]
    v_mul_f32 v207, v123, v207
    v_cvt_pk_bf16_f32 v194, v194, v198
    v_cvt_pk_bf16_f32 v198, v195, v199
    v_mfma_f32_16x16x32_bf16 v[28:31], v[40:43], a[72:75], -4.0
    ds_read_b128 v[64:67], v1 offset:1536
    ds_read_b128 v[68:71], v1 offset:1600
    v_mfma_f32_16x16x32_bf16 v[28:31], v[44:47], a[76:79], v[28:31]
    ds_read_b128 v[72:75], v1 offset:1664
    ds_read_b128 v[76:79], v1 offset:1728
    v_mfma_f32_16x16x32_bf16 v[28:31], v[48:51], a[80:83], v[28:31]
    v_cvt_pk_bf16_f32 v195, v202, v206
    v_cvt_pk_bf16_f32 v199, v203, v207
    v_mfma_f32_16x16x32_bf16 v[28:31], v[52:55], a[84:87], v[28:31]
    ds_write_b64 v0, v[194:195] offset:2880
    ds_write_b64 v0, v[198:199] offset:3040
    v_mfma_f32_16x16x32_bf16 v[28:31], v[56:59], a[88:91], v[28:31]
    ds_read_b64_tr_b16 v[96:97], v88 offset:2560
    ds_read_b64_tr_b16 v[98:99], v88 offset:2592
    v_mfma_f32_16x16x32_bf16 v[28:31], v[60:63], a[92:95], v[28:31]
    ds_read_b64_tr_b16 v[100:101], v88 offset:3840
    ds_read_b64_tr_b16 v[102:103], v88 offset:3872
    v_mfma_f32_16x16x32_bf16 v[32:35], v[40:43], a[96:99], -4.0
    v_mul_f32 v208, v120, v208
    v_mul_f32 v209, v121, v209
    v_mfma_f32_16x16x32_bf16 v[32:35], v[44:47], a[100:103], v[32:35]
    ds_read_b64_tr_b16 v[16:17], v2 offset:0
    ds_read_b64_tr_b16 v[18:19], v2 offset:1536
    v_mfma_f32_16x16x32_bf16 v[32:35], v[48:51], a[104:107], v[32:35]
    v_exp_f32 v28, v28
    v_mfma_f32_16x16x32_bf16 v[32:35], v[52:55], a[108:111], v[32:35]
    v_exp_f32 v29, v29
    v_mfma_f32_16x16x32_bf16 v[32:35], v[56:59], a[112:115], v[32:35]
    v_exp_f32 v30, v30
    v_mfma_f32_16x16x32_bf16 v[32:35], v[60:63], a[116:119], v[32:35]
    v_exp_f32 v31, v31
    v_mfma_f32_16x16x32_bf16 v[36:39], v[40:43], a[120:123], -4.0
    v_cvt_pk_bf16_f32 v28, v28, v29
    v_cvt_pk_bf16_f32 v29, v30, v31
    v_mfma_f32_16x16x32_bf16 v[36:39], v[44:47], a[124:127], v[36:39]
    s_waitcnt lgkmcnt(13)
    ds_read_b128 v[40:43], v1 offset:1792
    ds_read_b128 v[44:47], v1 offset:1856
    v_mfma_f32_16x16x32_bf16 v[36:39], v[48:51], a[128:131], v[36:39]
    v_exp_f32 v32, v32
    v_mfma_f32_16x16x32_bf16 v[36:39], v[52:55], a[132:135], v[36:39]
    v_exp_f32 v33, v33
    v_mfma_f32_16x16x32_bf16 v[36:39], v[56:59], a[136:139], v[36:39]
    v_exp_f32 v34, v34
    v_mfma_f32_16x16x32_bf16 v[36:39], v[60:63], a[140:143], v[36:39]
    s_waitcnt lgkmcnt(2)
    v_exp_f32 v35, v35
    v_mfma_f32_16x16x32_bf16 v[48:51], v[64:67], a[72:75], -4.0
    v_cvt_pk_bf16_f32 v32, v32, v33
    v_cvt_pk_bf16_f32 v33, v34, v35
    v_mfma_f32_16x16x32_bf16 v[48:51], v[68:71], a[76:79], v[48:51]
    ds_read_b64_tr_b16 v[20:21], v2 offset:32
    ds_read_b64_tr_b16 v[22:23], v2 offset:1568
    v_mfma_f32_16x16x32_bf16 v[48:51], v[72:75], a[80:83], v[48:51]
    v_exp_f32 v36, v36
    v_mfma_f32_16x16x32_bf16 v[48:51], v[76:79], a[84:87], v[48:51]
    s_waitcnt lgkmcnt(2)
    v_exp_f32 v37, v37
    v_mfma_f32_16x16x32_bf16 v[48:51], v[40:43], a[88:91], v[48:51]
    v_exp_f32 v38, v38
    v_mfma_f32_16x16x32_bf16 v[48:51], v[44:47], a[92:95], v[48:51]
    v_exp_f32 v39, v39
    v_mfma_f32_16x16x32_bf16 v[52:55], v[64:67], a[96:99], -4.0
    v_cvt_pk_bf16_f32 v36, v36, v37
    v_cvt_pk_bf16_f32 v37, v38, v39
    v_mfma_f32_16x16x32_bf16 v[52:55], v[68:71], a[100:103], v[52:55]
    ds_read_b64_tr_b16 v[24:25], v2 offset:64
    ds_read_b64_tr_b16 v[26:27], v2 offset:1600
    v_mfma_f32_16x16x32_bf16 v[52:55], v[72:75], a[104:107], v[52:55]
    v_exp_f32 v48, v48
    v_mfma_f32_16x16x32_bf16 v[52:55], v[76:79], a[108:111], v[52:55]
    v_exp_f32 v49, v49
    v_mfma_f32_16x16x32_bf16 v[52:55], v[40:43], a[112:115], v[52:55]
    v_exp_f32 v50, v50
    v_mfma_f32_16x16x32_bf16 v[52:55], v[44:47], a[116:119], v[52:55]
    v_exp_f32 v51, v51
    v_mfma_f32_16x16x32_bf16 v[56:59], v[64:67], a[120:123], -4.0
    v_cvt_pk_bf16_f32 v30, v48, v49
    v_cvt_pk_bf16_f32 v31, v50, v51
    v_mfma_f32_16x16x32_bf16 v[56:59], v[68:71], a[124:127], v[56:59]
    ds_read_b64_tr_b16 v[60:61], v2 offset:96
    ds_read_b64_tr_b16 v[62:63], v2 offset:1632
    v_mfma_f32_16x16x32_bf16 v[56:59], v[72:75], a[128:131], v[56:59]
    v_exp_f32 v52, v52
    v_mfma_f32_16x16x32_bf16 v[56:59], v[76:79], a[132:135], v[56:59]
    v_exp_f32 v53, v53
    v_mfma_f32_16x16x32_bf16 v[56:59], v[40:43], a[136:139], v[56:59]
    v_exp_f32 v54, v54
    v_mfma_f32_16x16x32_bf16 v[56:59], v[44:47], a[140:143], v[56:59]
    v_exp_f32 v55, v55
    v_mfma_f32_16x16x32_bf16 v[48:51], v[12:15], v[28:31], 0
    v_cvt_pk_bf16_f32 v34, v52, v53
    v_cvt_pk_bf16_f32 v35, v54, v55
    v_mfma_f32_16x16x32_bf16 a[240:243], v[28:31], v[16:19], a[240:243]
    s_waitcnt lgkmcnt(2)
    ds_read_b64_tr_b16 v[64:65], v2 offset:128
    ds_read_b64_tr_b16 v[66:67], v2 offset:1664
    v_mfma_f32_16x16x32_bf16 a[244:247], v[28:31], v[20:23], a[244:247]
    v_exp_f32 v56, v56
    v_mfma_f32_16x16x32_bf16 a[248:251], v[28:31], v[24:27], a[248:251]
    v_exp_f32 v57, v57
    v_mfma_f32_16x16x32_bf16 v[52:55], v[12:15], v[32:35], 0
    v_exp_f32 v58, v58
    v_mfma_f32_16x16x32_bf16 a[200:203], v[32:35], v[24:27], a[200:203]
    v_exp_f32 v59, v59
    v_mfma_f32_16x16x32_bf16 a[196:199], v[32:35], v[20:23], a[196:199]
    v_cvt_pk_bf16_f32 v38, v56, v57
    v_cvt_pk_bf16_f32 v39, v58, v59
    v_mfma_f32_16x16x32_bf16 a[192:195], v[32:35], v[16:19], a[192:195]
    s_nop 0
    ds_read_b64_tr_b16 v[68:69], v2 offset:160
    ds_read_b64_tr_b16 v[70:71], v2 offset:1696
    v_mfma_f32_16x16x32_bf16 a[144:147], v[36:39], v[16:19], a[144:147]
    ds_read_b64_tr_b16 v[72:73], v2 offset:192
    ds_read_b64_tr_b16 v[74:75], v2 offset:1728
    v_mfma_f32_16x16x32_bf16 a[148:151], v[36:39], v[20:23], a[148:151]
    v_add_f32 v7, v7, v48
    v_add_f32 v8, v8, v52
    v_mfma_f32_16x16x32_bf16 a[152:155], v[36:39], v[24:27], a[152:155]
    ds_read_b64_tr_b16 v[76:77], v2 offset:224
    ds_read_b64_tr_b16 v[78:79], v2 offset:1760
    v_mfma_f32_16x16x32_bf16 v[56:59], v[12:15], v[36:39], 0
    s_waitcnt lgkmcnt(6)
    v_mul_f32 v212, v120, v212
    v_mul_f32 v213, v121, v213
    v_mfma_f32_16x16x32_bf16 a[252:255], v[28:31], v[60:63], a[252:255]
    ds_read_b64_tr_b16 v[16:17], v2 offset:256
    ds_read_b64_tr_b16 v[18:19], v2 offset:1792
    v_mfma_f32_16x16x32_bf16 v[224:227], v[28:31], v[64:67], v[224:227]
    s_waitcnt lgkmcnt(6)
    v_mul_f32 v216, v120, v216
    v_mul_f32 v217, v121, v217
    v_mfma_f32_16x16x32_bf16 v[228:231], v[28:31], v[68:71], v[228:231]
    ds_read_b64_tr_b16 v[20:21], v2 offset:288
    ds_read_b64_tr_b16 v[22:23], v2 offset:1824
    v_mfma_f32_16x16x32_bf16 a[212:215], v[32:35], v[68:71], a[212:215]
    v_mul_f32 v220, v120, v220
    v_mul_f32 v221, v121, v221
    v_mfma_f32_16x16x32_bf16 a[208:211], v[32:35], v[64:67], a[208:211]
    ds_read_b64_tr_b16 v[24:25], v2 offset:320
    ds_read_b64_tr_b16 v[26:27], v2 offset:1856
    v_mfma_f32_16x16x32_bf16 a[204:207], v[32:35], v[60:63], a[204:207]
    v_add_f32 v9, v9, v56
    v_add_u32 v1, 0x6240, v1
    v_mfma_f32_16x16x32_bf16 a[156:159], v[36:39], v[60:63], a[156:159]
    buffer_store_dwordx4 v[96:99], v89, s[24:27], s74 offen offset:128 sc0 sc1
    v_mfma_f32_16x16x32_bf16 a[160:163], v[36:39], v[64:67], a[160:163]
    v_cvt_pk_bf16_f32 v208, v208, v212
    v_cvt_pk_bf16_f32 v212, v209, v213
    v_mfma_f32_16x16x32_bf16 a[164:167], v[36:39], v[68:71], a[164:167]
    s_waitcnt lgkmcnt(4)
    v_cvt_pk_bf16_f32 v209, v216, v220
    v_cvt_pk_bf16_f32 v213, v217, v221
    v_mfma_f32_16x16x32_bf16 v[232:235], v[28:31], v[72:75], v[232:235]
    ds_read_b64_tr_b16 v[64:65], v2 offset:352
    ds_read_b64_tr_b16 v[66:67], v2 offset:1888
    v_mfma_f32_16x16x32_bf16 v[236:239], v[28:31], v[76:79], v[236:239]
    ds_write_b64 v0, v[208:209] offset:5120
    ds_write_b64 v0, v[212:213] offset:5280
    v_mfma_f32_16x16x32_bf16 v[240:243], v[28:31], v[16:19], v[240:243]
    ds_read_b128 v[40:43], v1 offset:0
    ds_read_b128 v[44:47], v1 offset:64
    v_mfma_f32_16x16x32_bf16 a[224:227], v[32:35], v[16:19], a[224:227]
    v_add_u32 v2, 0x6240, v2
    v_mul_f32 v210, v122, v210
    v_mfma_f32_16x16x32_bf16 a[220:223], v[32:35], v[76:79], a[220:223]
    ds_read_b128 v[48:51], v1 offset:128
    ds_read_b128 v[52:55], v1 offset:192
    v_mfma_f32_16x16x32_bf16 a[216:219], v[32:35], v[72:75], a[216:219]
    buffer_store_dwordx4 v[100:103], v89, s[24:27], s74 offen offset:3200 sc0 sc1
    v_mfma_f32_16x16x32_bf16 a[168:171], v[36:39], v[72:75], a[168:171]
    ds_read_b128 v[56:59], v1 offset:256
    ds_read_b128 v[60:63], v1 offset:320
    v_mfma_f32_16x16x32_bf16 a[172:175], v[36:39], v[76:79], a[172:175]
    v_mul_f32 v211, v123, v211
    v_mul_f32 v214, v122, v214
    v_mfma_f32_16x16x32_bf16 a[176:179], v[36:39], v[16:19], a[176:179]
    s_waitcnt lgkmcnt(8)
    v_mul_f32 v215, v123, v215
    v_mul_f32 v218, v122, v218
    v_mfma_f32_16x16x32_bf16 v[244:247], v[28:31], v[20:23], v[244:247]
    v_mul_f32 v219, v123, v219
    v_mul_f32 v222, v122, v222
    v_mfma_f32_16x16x32_bf16 v[248:251], v[28:31], v[24:27], v[248:251]
    v_mul_f32 v223, v123, v223
    v_cvt_pk_bf16_f32 v210, v210, v214
    v_mfma_f32_16x16x32_bf16 v[252:255], v[28:31], v[64:67], v[252:255]
    v_cvt_pk_bf16_f32 v214, v211, v215
    v_cvt_pk_bf16_f32 v211, v218, v222
    v_mfma_f32_16x16x32_bf16 a[236:239], v[32:35], v[64:67], a[236:239]
    v_cvt_pk_bf16_f32 v215, v219, v223
    v_mfma_f32_16x16x32_bf16 a[232:235], v[32:35], v[24:27], a[232:235]
    ds_write_b64 v0, v[210:211] offset:5440
    ds_write_b64 v0, v[214:215] offset:5600
    v_mfma_f32_16x16x32_bf16 a[228:231], v[32:35], v[20:23], a[228:231]
    ds_read_b64_tr_b16 v[112:113], v88 offset:5120
    ds_read_b64_tr_b16 v[114:115], v88 offset:5152
    v_mfma_f32_16x16x32_bf16 a[180:183], v[36:39], v[20:23], a[180:183]
    ds_read_b64_tr_b16 v[116:117], v88 offset:6400
    ds_read_b64_tr_b16 v[118:119], v88 offset:6432
    v_mfma_f32_16x16x32_bf16 a[184:187], v[36:39], v[24:27], a[184:187]
    v_mfma_f32_16x16x32_bf16 a[188:191], v[36:39], v[64:67], a[188:191]
    s_waitcnt lgkmcnt(6)
    v_mfma_f32_16x16x32_bf16 v[28:31], v[40:43], a[72:75], -4.0
    ds_read_b128 v[64:67], v1 offset:1536
    ds_read_b128 v[68:71], v1 offset:1600
    v_mfma_f32_16x16x32_bf16 v[28:31], v[44:47], a[76:79], v[28:31]
    ds_read_b128 v[72:75], v1 offset:1664
    ds_read_b128 v[76:79], v1 offset:1728
    v_mfma_f32_16x16x32_bf16 v[28:31], v[48:51], a[80:83], v[28:31]
    s_waitcnt lgkmcnt(6)
    buffer_store_dwordx4 v[112:115], v89, s[24:27], s74 offen offset:256 sc0 sc1
    v_mfma_f32_16x16x32_bf16 v[28:31], v[52:55], a[84:87], v[28:31]
    v_mfma_f32_16x16x32_bf16 v[28:31], v[56:59], a[88:91], v[28:31]
    v_mfma_f32_16x16x32_bf16 v[28:31], v[60:63], a[92:95], v[28:31]
    s_nop 0
    v_mfma_f32_16x16x32_bf16 v[32:35], v[40:43], a[96:99], -4.0
    s_nop 0
    v_mfma_f32_16x16x32_bf16 v[32:35], v[44:47], a[100:103], v[32:35]
    s_nop 0
    ds_read_b64_tr_b16 v[16:17], v2 offset:0
    ds_read_b64_tr_b16 v[18:19], v2 offset:1536
    v_mfma_f32_16x16x32_bf16 v[32:35], v[48:51], a[104:107], v[32:35]
    v_exp_f32 v28, v28
    v_mfma_f32_16x16x32_bf16 v[32:35], v[52:55], a[108:111], v[32:35]
    v_exp_f32 v29, v29
    v_mfma_f32_16x16x32_bf16 v[32:35], v[56:59], a[112:115], v[32:35]
    v_exp_f32 v30, v30
    v_mfma_f32_16x16x32_bf16 v[32:35], v[60:63], a[116:119], v[32:35]
    v_exp_f32 v31, v31
    v_mfma_f32_16x16x32_bf16 v[36:39], v[40:43], a[120:123], -4.0
    v_cvt_pk_bf16_f32 v28, v28, v29
    v_cvt_pk_bf16_f32 v29, v30, v31
    v_mfma_f32_16x16x32_bf16 v[36:39], v[44:47], a[124:127], v[36:39]
    ds_read_b128 v[40:43], v1 offset:1792
    ds_read_b128 v[44:47], v1 offset:1856
    v_mfma_f32_16x16x32_bf16 v[36:39], v[48:51], a[128:131], v[36:39]
    v_exp_f32 v32, v32
    v_mfma_f32_16x16x32_bf16 v[36:39], v[52:55], a[132:135], v[36:39]
    v_exp_f32 v33, v33
    v_mfma_f32_16x16x32_bf16 v[36:39], v[56:59], a[136:139], v[36:39]
    v_exp_f32 v34, v34
    v_mfma_f32_16x16x32_bf16 v[36:39], v[60:63], a[140:143], v[36:39]
    s_waitcnt lgkmcnt(2)
    v_exp_f32 v35, v35
    v_mfma_f32_16x16x32_bf16 v[48:51], v[64:67], a[72:75], -4.0
    v_cvt_pk_bf16_f32 v32, v32, v33
    v_cvt_pk_bf16_f32 v33, v34, v35
    v_mfma_f32_16x16x32_bf16 v[48:51], v[68:71], a[76:79], v[48:51]
    ds_read_b64_tr_b16 v[20:21], v2 offset:32
    ds_read_b64_tr_b16 v[22:23], v2 offset:1568
    v_mfma_f32_16x16x32_bf16 v[48:51], v[72:75], a[80:83], v[48:51]
    v_exp_f32 v36, v36
    v_mfma_f32_16x16x32_bf16 v[48:51], v[76:79], a[84:87], v[48:51]
    s_waitcnt lgkmcnt(2)
    v_exp_f32 v37, v37
    v_mfma_f32_16x16x32_bf16 v[48:51], v[40:43], a[88:91], v[48:51]
    v_exp_f32 v38, v38
    v_mfma_f32_16x16x32_bf16 v[48:51], v[44:47], a[92:95], v[48:51]
    v_exp_f32 v39, v39
    v_mfma_f32_16x16x32_bf16 v[52:55], v[64:67], a[96:99], -4.0
    v_cvt_pk_bf16_f32 v36, v36, v37
    v_cvt_pk_bf16_f32 v37, v38, v39
    v_mfma_f32_16x16x32_bf16 v[52:55], v[68:71], a[100:103], v[52:55]
    ds_read_b64_tr_b16 v[24:25], v2 offset:64
    ds_read_b64_tr_b16 v[26:27], v2 offset:1600
    v_mfma_f32_16x16x32_bf16 v[52:55], v[72:75], a[104:107], v[52:55]
    v_exp_f32 v48, v48
    v_mfma_f32_16x16x32_bf16 v[52:55], v[76:79], a[108:111], v[52:55]
    v_exp_f32 v49, v49
    v_mfma_f32_16x16x32_bf16 v[52:55], v[40:43], a[112:115], v[52:55]
    v_exp_f32 v50, v50
    v_mfma_f32_16x16x32_bf16 v[52:55], v[44:47], a[116:119], v[52:55]
    v_exp_f32 v51, v51
    v_mfma_f32_16x16x32_bf16 v[56:59], v[64:67], a[120:123], -4.0
    v_cvt_pk_bf16_f32 v30, v48, v49
    v_cvt_pk_bf16_f32 v31, v50, v51
    v_mfma_f32_16x16x32_bf16 v[56:59], v[68:71], a[124:127], v[56:59]
    ds_read_b64_tr_b16 v[60:61], v2 offset:96
    ds_read_b64_tr_b16 v[62:63], v2 offset:1632
    v_mfma_f32_16x16x32_bf16 v[56:59], v[72:75], a[128:131], v[56:59]
    v_exp_f32 v52, v52
    v_mfma_f32_16x16x32_bf16 v[56:59], v[76:79], a[132:135], v[56:59]
    v_exp_f32 v53, v53
    v_mfma_f32_16x16x32_bf16 v[56:59], v[40:43], a[136:139], v[56:59]
    v_exp_f32 v54, v54
    v_mfma_f32_16x16x32_bf16 v[56:59], v[44:47], a[140:143], v[56:59]
    v_exp_f32 v55, v55
    v_mfma_f32_16x16x32_bf16 v[48:51], v[12:15], v[28:31], 0
    v_cvt_pk_bf16_f32 v34, v52, v53
    v_cvt_pk_bf16_f32 v35, v54, v55
    v_mfma_f32_16x16x32_bf16 a[240:243], v[28:31], v[16:19], a[240:243]
    s_waitcnt lgkmcnt(2)
    ds_read_b64_tr_b16 v[64:65], v2 offset:128
    ds_read_b64_tr_b16 v[66:67], v2 offset:1664
    v_mfma_f32_16x16x32_bf16 a[244:247], v[28:31], v[20:23], a[244:247]
    v_exp_f32 v56, v56
    v_mfma_f32_16x16x32_bf16 a[248:251], v[28:31], v[24:27], a[248:251]
    v_exp_f32 v57, v57
    v_mfma_f32_16x16x32_bf16 v[52:55], v[12:15], v[32:35], 0
    v_exp_f32 v58, v58
    v_mfma_f32_16x16x32_bf16 a[200:203], v[32:35], v[24:27], a[200:203]
    v_exp_f32 v59, v59
    v_mfma_f32_16x16x32_bf16 a[196:199], v[32:35], v[20:23], a[196:199]
    v_cvt_pk_bf16_f32 v38, v56, v57
    v_cvt_pk_bf16_f32 v39, v58, v59
    v_mfma_f32_16x16x32_bf16 a[192:195], v[32:35], v[16:19], a[192:195]
    s_nop 0
    ds_read_b64_tr_b16 v[68:69], v2 offset:160
    ds_read_b64_tr_b16 v[70:71], v2 offset:1696
    v_mfma_f32_16x16x32_bf16 a[144:147], v[36:39], v[16:19], a[144:147]
    ds_read_b64_tr_b16 v[72:73], v2 offset:192
    ds_read_b64_tr_b16 v[74:75], v2 offset:1728
    v_mfma_f32_16x16x32_bf16 a[148:151], v[36:39], v[20:23], a[148:151]
    v_add_f32 v7, v7, v48
    v_add_f32 v8, v8, v52
    v_mfma_f32_16x16x32_bf16 a[152:155], v[36:39], v[24:27], a[152:155]
    ds_read_b64_tr_b16 v[76:77], v2 offset:224
    ds_read_b64_tr_b16 v[78:79], v2 offset:1760
    v_mfma_f32_16x16x32_bf16 v[56:59], v[12:15], v[36:39], 0
    s_waitcnt lgkmcnt(6)
    buffer_store_dwordx4 v[116:119], v89, s[24:27], s74 offen offset:3328 sc0 sc1
    v_mfma_f32_16x16x32_bf16 a[252:255], v[28:31], v[60:63], a[252:255]
    ds_read_b64_tr_b16 v[16:17], v2 offset:256
    ds_read_b64_tr_b16 v[18:19], v2 offset:1792
    v_mfma_f32_16x16x32_bf16 v[224:227], v[28:31], v[64:67], v[224:227]
    s_waitcnt lgkmcnt(6)
    v_mfma_f32_16x16x32_bf16 v[228:231], v[28:31], v[68:71], v[228:231]
    ds_read_b64_tr_b16 v[20:21], v2 offset:288
    ds_read_b64_tr_b16 v[22:23], v2 offset:1824
    v_mfma_f32_16x16x32_bf16 a[212:215], v[32:35], v[68:71], a[212:215]
    v_mfma_f32_16x16x32_bf16 a[208:211], v[32:35], v[64:67], a[208:211]
    ds_read_b64_tr_b16 v[24:25], v2 offset:320
    ds_read_b64_tr_b16 v[26:27], v2 offset:1856
    v_mfma_f32_16x16x32_bf16 a[204:207], v[32:35], v[60:63], a[204:207]
    v_add_f32 v9, v9, v56
    v_mfma_f32_16x16x32_bf16 a[156:159], v[36:39], v[60:63], a[156:159]
    ds_read_b64_tr_b16 v[40:41], v2 offset:352
    ds_read_b64_tr_b16 v[42:43], v2 offset:1888
    v_mfma_f32_16x16x32_bf16 a[160:163], v[36:39], v[64:67], a[160:163]
    v_add_f32 v57, v7, v8
    v_min3_f32 v58, v7, v8, v9
    v_mfma_f32_16x16x32_bf16 a[164:167], v[36:39], v[68:71], a[164:167]
    s_waitcnt lgkmcnt(6)
    v_add_f32 v57, v57, v9
    v_cmp_gt_f32 s[70:71], s42, v58
    v_mfma_f32_16x16x32_bf16 v[232:235], v[28:31], v[72:75], v[232:235]
    v_cmp_nge_f32 s[50:51], s41, v57
    v_mfma_f32_16x16x32_bf16 v[236:239], v[28:31], v[76:79], v[236:239]
    v_rcp_f32 v7, v7
    v_mfma_f32_16x16x32_bf16 v[240:243], v[28:31], v[16:19], v[240:243]
    s_waitcnt lgkmcnt(4)
    v_rcp_f32 v8, v8
    v_mfma_f32_16x16x32_bf16 v[244:247], v[28:31], v[20:23], v[244:247]
    s_waitcnt lgkmcnt(2)
    v_rcp_f32 v9, v9
    v_mfma_f32_16x16x32_bf16 v[248:251], v[28:31], v[24:27], v[248:251]
    s_waitcnt lgkmcnt(0)
    v_mfma_f32_16x16x32_bf16 v[252:255], v[28:31], v[40:43], v[252:255]
    ds_bpermute_b32 v104, v10, v7 offset:0
    ds_bpermute_b32 v105, v10, v7 offset:4
    v_mfma_f32_16x16x32_bf16 a[236:239], v[32:35], v[40:43], a[236:239]
    s_or_b64 s[50:51], s[50:51], s[70:71]
    ds_bpermute_b32 v106, v10, v7 offset:8
    ds_bpermute_b32 v107, v10, v7 offset:12
    v_mfma_f32_16x16x32_bf16 a[232:235], v[32:35], v[24:27], a[232:235]
    s_or_b64 s[48:49], s[48:49], s[50:51]
    v_mfma_f32_16x16x32_bf16 a[228:231], v[32:35], v[20:23], a[228:231]
    v_mfma_f32_16x16x32_bf16 a[224:227], v[32:35], v[16:19], a[224:227]
    v_mfma_f32_16x16x32_bf16 a[220:223], v[32:35], v[76:79], a[220:223]
    v_mfma_f32_16x16x32_bf16 a[216:219], v[32:35], v[72:75], a[216:219]
    s_waitcnt lgkmcnt(2)
    v_mul_f32 v224, v104, v224
    v_mul_f32 v225, v105, v225
    v_mfma_f32_16x16x32_bf16 a[168:171], v[36:39], v[72:75], a[168:171]
    v_mul_f32 v228, v104, v228
    v_mul_f32 v229, v105, v229
    v_mfma_f32_16x16x32_bf16 a[172:175], v[36:39], v[76:79], a[172:175]
    v_mul_f32 v232, v104, v232
    v_mul_f32 v233, v105, v233
    v_mfma_f32_16x16x32_bf16 a[176:179], v[36:39], v[16:19], a[176:179]
    v_mul_f32 v236, v104, v236
    v_mul_f32 v237, v105, v237
    v_mfma_f32_16x16x32_bf16 a[180:183], v[36:39], v[20:23], a[180:183]
    v_cvt_pk_bf16_f32 v224, v224, v228
    v_cvt_pk_bf16_f32 v228, v225, v229
    v_mfma_f32_16x16x32_bf16 a[184:187], v[36:39], v[24:27], a[184:187]
    v_cvt_pk_bf16_f32 v225, v232, v236
    v_cvt_pk_bf16_f32 v229, v233, v237
    v_mfma_f32_16x16x32_bf16 a[188:191], v[36:39], v[40:43], a[188:191]
    ds_write_b64 v0, v[224:225] offset:10240
    ds_write_b64 v0, v[228:229] offset:10400
    s_cmp_lg_u64 s[48:49], 0
    s_cbranch_scc1 L_slow
    s_waitcnt lgkmcnt(2)
    v_pk_mul_f32 v[226:227], v[106:107], v[226:227]
    v_pk_mul_f32 v[230:231], v[106:107], v[230:231]
    v_pk_mul_f32 v[234:235], v[106:107], v[234:235]
    v_pk_mul_f32 v[238:239], v[106:107], v[238:239]
    v_cvt_pk_bf16_f32 v226, v226, v230
    v_cvt_pk_bf16_f32 v230, v227, v231
    v_cvt_pk_bf16_f32 v227, v234, v238
    v_cvt_pk_bf16_f32 v231, v235, v239
    ds_write_b64 v0, v[226:227] offset:10560
    ds_write_b64 v0, v[230:231] offset:10720
    ds_read_b64_tr_b16 v[144:145], v88 offset:10240
    ds_read_b64_tr_b16 v[146:147], v88 offset:10272
    ds_read_b64_tr_b16 v[148:149], v88 offset:11520
    ds_read_b64_tr_b16 v[150:151], v88 offset:11552
    v_pk_mul_f32 v[240:241], v[104:105], v[240:241]
    v_pk_mul_f32 v[244:245], v[104:105], v[244:245]
    v_pk_mul_f32 v[248:249], v[104:105], v[248:249]
    v_pk_mul_f32 v[252:253], v[104:105], v[252:253]
    s_waitcnt lgkmcnt(2)
    buffer_store_dwordx4 v[144:147], v89, s[24:27], s75 offen offset:128 nt
    s_waitcnt lgkmcnt(0)
    buffer_store_dwordx4 v[148:151], v89, s[24:27], s75 offen offset:3200 nt
    v_cvt_pk_bf16_f32 v240, v240, v244
    v_cvt_pk_bf16_f32 v244, v241, v245
    v_cvt_pk_bf16_f32 v241, v248, v252
    v_cvt_pk_bf16_f32 v245, v249, v253
    ds_write_b64 v0, v[240:241] offset:12800
    ds_write_b64 v0, v[244:245] offset:12960
    v_pk_mul_f32 v[242:243], v[106:107], v[242:243]
    v_pk_mul_f32 v[246:247], v[106:107], v[246:247]
    v_pk_mul_f32 v[250:251], v[106:107], v[250:251]
    v_pk_mul_f32 v[254:255], v[106:107], v[254:255]
    v_cvt_pk_bf16_f32 v242, v242, v246
    v_cvt_pk_bf16_f32 v246, v243, v247
    v_cvt_pk_bf16_f32 v243, v250, v254
    v_cvt_pk_bf16_f32 v247, v251, v255
    ds_write_b64 v0, v[242:243] offset:13120
    ds_write_b64 v0, v[246:247] offset:13280
    ds_read_b64_tr_b16 v[160:161], v88 offset:12800
    ds_read_b64_tr_b16 v[162:163], v88 offset:12832
    ds_read_b64_tr_b16 v[164:165], v88 offset:14080
    ds_read_b64_tr_b16 v[166:167], v88 offset:14112
    v_accvgpr_read_b32 v192, a240
    v_accvgpr_read_b32 v193, a241
    v_accvgpr_read_b32 v196, a244
    v_accvgpr_read_b32 v197, a245
    v_accvgpr_read_b32 v200, a248
    v_accvgpr_read_b32 v201, a249
    v_accvgpr_read_b32 v204, a252
    v_accvgpr_read_b32 v205, a253
    v_pk_mul_f32 v[192:193], v[104:105], v[192:193]
    v_pk_mul_f32 v[196:197], v[104:105], v[196:197]
    v_pk_mul_f32 v[200:201], v[104:105], v[200:201]
    v_pk_mul_f32 v[204:205], v[104:105], v[204:205]
    s_waitcnt lgkmcnt(2)
    buffer_store_dwordx4 v[160:163], v89, s[24:27], s75 offen offset:256 nt
    s_waitcnt lgkmcnt(0)
    buffer_store_dwordx4 v[164:167], v89, s[24:27], s75 offen offset:3328 nt
    ds_bpermute_b32 v120, v10, v8 offset:0
    ds_bpermute_b32 v121, v10, v8 offset:4
    ds_bpermute_b32 v122, v10, v8 offset:8
    ds_bpermute_b32 v123, v10, v8 offset:12
    v_cvt_pk_bf16_f32 v192, v192, v196
    v_cvt_pk_bf16_f32 v196, v193, v197
    v_cvt_pk_bf16_f32 v193, v200, v204
    v_cvt_pk_bf16_f32 v197, v201, v205
    ds_write_b64 v0, v[192:193] offset:7680
    ds_write_b64 v0, v[196:197] offset:7840
    v_accvgpr_read_b32 v194, a242
    v_accvgpr_read_b32 v195, a243
    v_accvgpr_read_b32 v198, a246
    v_accvgpr_read_b32 v199, a247
    v_accvgpr_read_b32 v202, a250
    v_accvgpr_read_b32 v203, a251
    v_accvgpr_read_b32 v206, a254
    v_accvgpr_read_b32 v207, a255
    v_pk_mul_f32 v[194:195], v[106:107], v[194:195]
    v_pk_mul_f32 v[198:199], v[106:107], v[198:199]
    v_pk_mul_f32 v[202:203], v[106:107], v[202:203]
    v_pk_mul_f32 v[206:207], v[106:107], v[206:207]
    v_cvt_pk_bf16_f32 v194, v194, v198
    v_cvt_pk_bf16_f32 v198, v195, v199
    v_cvt_pk_bf16_f32 v195, v202, v206
    v_cvt_pk_bf16_f32 v199, v203, v207
    ds_write_b64 v0, v[194:195] offset:8000
    ds_write_b64 v0, v[198:199] offset:8160
    ds_read_b64_tr_b16 v[128:129], v88 offset:7680
    ds_read_b64_tr_b16 v[130:131], v88 offset:7712
    ds_read_b64_tr_b16 v[132:133], v88 offset:8960
    ds_read_b64_tr_b16 v[134:135], v88 offset:8992
    v_accvgpr_read_b32 v176, a192
    v_accvgpr_read_b32 v177, a193
    v_accvgpr_read_b32 v180, a196
    v_accvgpr_read_b32 v181, a197
    v_accvgpr_read_b32 v184, a200
    v_accvgpr_read_b32 v185, a201
    v_accvgpr_read_b32 v188, a204
    v_accvgpr_read_b32 v189, a205
    s_waitcnt lgkmcnt(10)
    v_pk_mul_f32 v[176:177], v[120:121], v[176:177]
    v_pk_mul_f32 v[180:181], v[120:121], v[180:181]
    v_pk_mul_f32 v[184:185], v[120:121], v[184:185]
    v_pk_mul_f32 v[188:189], v[120:121], v[188:189]
    s_waitcnt lgkmcnt(2)
    buffer_store_dwordx4 v[128:131], v89, s[24:27], s75 offen offset:0 nt
    s_waitcnt lgkmcnt(0)
    buffer_store_dwordx4 v[132:135], v89, s[24:27], s75 offen offset:3072 nt
    v_cvt_pk_bf16_f32 v176, v176, v180
    v_cvt_pk_bf16_f32 v180, v177, v181
    v_cvt_pk_bf16_f32 v177, v184, v188
    v_cvt_pk_bf16_f32 v181, v185, v189
    ds_write_b64 v0, v[176:177] offset:0
    ds_write_b64 v0, v[180:181] offset:160
    v_accvgpr_read_b32 v178, a194
    v_accvgpr_read_b32 v179, a195
    v_accvgpr_read_b32 v182, a198
    v_accvgpr_read_b32 v183, a199
    v_accvgpr_read_b32 v186, a202
    v_accvgpr_read_b32 v187, a203
    v_accvgpr_read_b32 v190, a206
    v_accvgpr_read_b32 v191, a207
    v_pk_mul_f32 v[178:179], v[122:123], v[178:179]
    v_pk_mul_f32 v[182:183], v[122:123], v[182:183]
    v_pk_mul_f32 v[186:187], v[122:123], v[186:187]
    v_pk_mul_f32 v[190:191], v[122:123], v[190:191]
    v_cvt_pk_bf16_f32 v178, v178, v182
    v_cvt_pk_bf16_f32 v182, v179, v183
    v_cvt_pk_bf16_f32 v179, v186, v190
    v_cvt_pk_bf16_f32 v183, v187, v191
    ds_write_b64 v0, v[178:179] offset:320
    ds_write_b64 v0, v[182:183] offset:480
    ds_read_b64_tr_b16 v[80:81], v88 offset:0
    ds_read_b64_tr_b16 v[82:83], v88 offset:32
    ds_read_b64_tr_b16 v[84:85], v88 offset:1280
    ds_read_b64_tr_b16 v[86:87], v88 offset:1312
    v_accvgpr_read_b32 v192, a208
    v_accvgpr_read_b32 v193, a209
    v_accvgpr_read_b32 v196, a212
    v_accvgpr_read_b32 v197, a213
    v_accvgpr_read_b32 v200, a216
    v_accvgpr_read_b32 v201, a217
    v_accvgpr_read_b32 v204, a220
    v_accvgpr_read_b32 v205, a221
    v_pk_mul_f32 v[192:193], v[120:121], v[192:193]
    v_pk_mul_f32 v[196:197], v[120:121], v[196:197]
    v_pk_mul_f32 v[200:201], v[120:121], v[200:201]
    v_pk_mul_f32 v[204:205], v[120:121], v[204:205]
    s_waitcnt lgkmcnt(2)
    buffer_store_dwordx4 v[80:83], v89, s[24:27], s76 offen offset:0 nt
    s_waitcnt lgkmcnt(0)
    buffer_store_dwordx4 v[84:87], v89, s[24:27], s76 offen offset:3072 nt
    v_cvt_pk_bf16_f32 v192, v192, v196
    v_cvt_pk_bf16_f32 v196, v193, v197
    v_cvt_pk_bf16_f32 v193, v200, v204
    v_cvt_pk_bf16_f32 v197, v201, v205
    ds_write_b64 v0, v[192:193] offset:2560
    ds_write_b64 v0, v[196:197] offset:2720
    v_accvgpr_read_b32 v194, a210
    v_accvgpr_read_b32 v195, a211
    v_accvgpr_read_b32 v198, a214
    v_accvgpr_read_b32 v199, a215
    v_accvgpr_read_b32 v202, a218
    v_accvgpr_read_b32 v203, a219
    v_accvgpr_read_b32 v206, a222
    v_accvgpr_read_b32 v207, a223
    v_pk_mul_f32 v[194:195], v[122:123], v[194:195]
    v_pk_mul_f32 v[198:199], v[122:123], v[198:199]
    v_pk_mul_f32 v[202:203], v[122:123], v[202:203]
    v_pk_mul_f32 v[206:207], v[122:123], v[206:207]
    v_cvt_pk_bf16_f32 v194, v194, v198
    v_cvt_pk_bf16_f32 v198, v195, v199
    v_cvt_pk_bf16_f32 v195, v202, v206
    v_cvt_pk_bf16_f32 v199, v203, v207
    ds_write_b64 v0, v[194:195] offset:2880
    ds_write_b64 v0, v[198:199] offset:3040
    ds_read_b64_tr_b16 v[96:97], v88 offset:2560
    ds_read_b64_tr_b16 v[98:99], v88 offset:2592
    ds_read_b64_tr_b16 v[100:101], v88 offset:3840
    ds_read_b64_tr_b16 v[102:103], v88 offset:3872
    v_accvgpr_read_b32 v176, a224
    v_accvgpr_read_b32 v177, a225
    v_accvgpr_read_b32 v180, a228
    v_accvgpr_read_b32 v181, a229
    v_accvgpr_read_b32 v184, a232
    v_accvgpr_read_b32 v185, a233
    v_accvgpr_read_b32 v188, a236
    v_accvgpr_read_b32 v189, a237
    v_pk_mul_f32 v[176:177], v[120:121], v[176:177]
    v_pk_mul_f32 v[180:181], v[120:121], v[180:181]
    v_pk_mul_f32 v[184:185], v[120:121], v[184:185]
    v_pk_mul_f32 v[188:189], v[120:121], v[188:189]
    s_waitcnt lgkmcnt(2)
    buffer_store_dwordx4 v[96:99], v89, s[24:27], s76 offen offset:128 nt
    s_waitcnt lgkmcnt(0)
    buffer_store_dwordx4 v[100:103], v89, s[24:27], s76 offen offset:3200 nt
    ds_bpermute_b32 v104, v10, v9 offset:0
    ds_bpermute_b32 v105, v10, v9 offset:4
    ds_bpermute_b32 v106, v10, v9 offset:8
    ds_bpermute_b32 v107, v10, v9 offset:12
    v_cvt_pk_bf16_f32 v176, v176, v180
    v_cvt_pk_bf16_f32 v180, v177, v181
    v_cvt_pk_bf16_f32 v177, v184, v188
    v_cvt_pk_bf16_f32 v181, v185, v189
    ds_write_b64 v0, v[176:177] offset:5120
    ds_write_b64 v0, v[180:181] offset:5280
    v_accvgpr_read_b32 v178, a226
    v_accvgpr_read_b32 v179, a227
    v_accvgpr_read_b32 v182, a230
    v_accvgpr_read_b32 v183, a231
    v_accvgpr_read_b32 v186, a234
    v_accvgpr_read_b32 v187, a235
    v_accvgpr_read_b32 v190, a238
    v_accvgpr_read_b32 v191, a239
    v_pk_mul_f32 v[178:179], v[122:123], v[178:179]
    v_pk_mul_f32 v[182:183], v[122:123], v[182:183]
    v_pk_mul_f32 v[186:187], v[122:123], v[186:187]
    v_pk_mul_f32 v[190:191], v[122:123], v[190:191]
    v_cvt_pk_bf16_f32 v178, v178, v182
    v_cvt_pk_bf16_f32 v182, v179, v183
    v_cvt_pk_bf16_f32 v179, v186, v190
    v_cvt_pk_bf16_f32 v183, v187, v191
    ds_write_b64 v0, v[178:179] offset:5440
    ds_write_b64 v0, v[182:183] offset:5600
    ds_read_b64_tr_b16 v[112:113], v88 offset:5120
    ds_read_b64_tr_b16 v[114:115], v88 offset:5152
    ds_read_b64_tr_b16 v[116:117], v88 offset:6400
    ds_read_b64_tr_b16 v[118:119], v88 offset:6432
    v_accvgpr_read_b32 v192, a144
    v_accvgpr_read_b32 v193, a145
    v_accvgpr_read_b32 v196, a148
    v_accvgpr_read_b32 v197, a149
    v_accvgpr_read_b32 v200, a152
    v_accvgpr_read_b32 v201, a153
    v_accvgpr_read_b32 v204, a156
    v_accvgpr_read_b32 v205, a157
    s_waitcnt lgkmcnt(10)
    v_pk_mul_f32 v[192:193], v[104:105], v[192:193]
    v_pk_mul_f32 v[196:197], v[104:105], v[196:197]
    v_pk_mul_f32 v[200:201], v[104:105], v[200:201]
    v_pk_mul_f32 v[204:205], v[104:105], v[204:205]
    s_waitcnt lgkmcnt(2)
    buffer_store_dwordx4 v[112:115], v89, s[24:27], s76 offen offset:256 nt
    s_waitcnt lgkmcnt(0)
    buffer_store_dwordx4 v[116:119], v89, s[24:27], s76 offen offset:3328 nt
    v_cvt_pk_bf16_f32 v192, v192, v196
    v_cvt_pk_bf16_f32 v196, v193, v197
    v_cvt_pk_bf16_f32 v193, v200, v204
    v_cvt_pk_bf16_f32 v197, v201, v205
    ds_write_b64 v0, v[192:193] offset:7680
    ds_write_b64 v0, v[196:197] offset:7840
    v_accvgpr_read_b32 v194, a146
    v_accvgpr_read_b32 v195, a147
    v_accvgpr_read_b32 v198, a150
    v_accvgpr_read_b32 v199, a151
    v_accvgpr_read_b32 v202, a154
    v_accvgpr_read_b32 v203, a155
    v_accvgpr_read_b32 v206, a158
    v_accvgpr_read_b32 v207, a159
    v_pk_mul_f32 v[194:195], v[106:107], v[194:195]
    v_pk_mul_f32 v[198:199], v[106:107], v[198:199]
    v_pk_mul_f32 v[202:203], v[106:107], v[202:203]
    v_pk_mul_f32 v[206:207], v[106:107], v[206:207]
    v_cvt_pk_bf16_f32 v194, v194, v198
    v_cvt_pk_bf16_f32 v198, v195, v199
    v_cvt_pk_bf16_f32 v195, v202, v206
    v_cvt_pk_bf16_f32 v199, v203, v207
    ds_write_b64 v0, v[194:195] offset:8000
    ds_write_b64 v0, v[198:199] offset:8160
    ds_read_b64_tr_b16 v[128:129], v88 offset:7680
    ds_read_b64_tr_b16 v[130:131], v88 offset:7712
    ds_read_b64_tr_b16 v[132:133], v88 offset:8960
    ds_read_b64_tr_b16 v[134:135], v88 offset:8992
    v_accvgpr_read_b32 v176, a160
    v_accvgpr_read_b32 v177, a161
    v_accvgpr_read_b32 v180, a164
    v_accvgpr_read_b32 v181, a165
    v_accvgpr_read_b32 v184, a168
    v_accvgpr_read_b32 v185, a169
    v_accvgpr_read_b32 v188, a172
    v_accvgpr_read_b32 v189, a173
    v_pk_mul_f32 v[176:177], v[104:105], v[176:177]
    v_pk_mul_f32 v[180:181], v[104:105], v[180:181]
    v_pk_mul_f32 v[184:185], v[104:105], v[184:185]
    v_pk_mul_f32 v[188:189], v[104:105], v[188:189]
    s_waitcnt lgkmcnt(2)
    buffer_store_dwordx4 v[128:131], v89, s[24:27], s77 offen offset:0 nt
    s_waitcnt lgkmcnt(0)
    buffer_store_dwordx4 v[132:135], v89, s[24:27], s77 offen offset:3072 nt
    v_cvt_pk_bf16_f32 v176, v176, v180
    v_cvt_pk_bf16_f32 v180, v177, v181
    v_cvt_pk_bf16_f32 v177, v184, v188
    v_cvt_pk_bf16_f32 v181, v185, v189
    ds_write_b64 v0, v[176:177] offset:10240
    ds_write_b64 v0, v[180:181] offset:10400
    v_accvgpr_read_b32 v178, a162
    v_accvgpr_read_b32 v179, a163
    v_accvgpr_read_b32 v182, a166
    v_accvgpr_read_b32 v183, a167
    v_accvgpr_read_b32 v186, a170
    v_accvgpr_read_b32 v187, a171
    v_accvgpr_read_b32 v190, a174
    v_accvgpr_read_b32 v191, a175
    v_pk_mul_f32 v[178:179], v[106:107], v[178:179]
    v_pk_mul_f32 v[182:183], v[106:107], v[182:183]
    v_pk_mul_f32 v[186:187], v[106:107], v[186:187]
    v_pk_mul_f32 v[190:191], v[106:107], v[190:191]
    v_cvt_pk_bf16_f32 v178, v178, v182
    v_cvt_pk_bf16_f32 v182, v179, v183
    v_cvt_pk_bf16_f32 v179, v186, v190
    v_cvt_pk_bf16_f32 v183, v187, v191
    ds_write_b64 v0, v[178:179] offset:10560
    ds_write_b64 v0, v[182:183] offset:10720
    ds_read_b64_tr_b16 v[144:145], v88 offset:10240
    ds_read_b64_tr_b16 v[146:147], v88 offset:10272
    ds_read_b64_tr_b16 v[148:149], v88 offset:11520
    ds_read_b64_tr_b16 v[150:151], v88 offset:11552
    v_accvgpr_read_b32 v192, a176
    v_accvgpr_read_b32 v193, a177
    v_accvgpr_read_b32 v196, a180
    v_accvgpr_read_b32 v197, a181
    v_accvgpr_read_b32 v200, a184
    v_accvgpr_read_b32 v201, a185
    v_accvgpr_read_b32 v204, a188
    v_accvgpr_read_b32 v205, a189
    v_pk_mul_f32 v[192:193], v[104:105], v[192:193]
    v_pk_mul_f32 v[196:197], v[104:105], v[196:197]
    v_pk_mul_f32 v[200:201], v[104:105], v[200:201]
    v_pk_mul_f32 v[204:205], v[104:105], v[204:205]
    s_waitcnt lgkmcnt(2)
    buffer_store_dwordx4 v[144:147], v89, s[24:27], s77 offen offset:128 nt
    s_waitcnt lgkmcnt(0)
    buffer_store_dwordx4 v[148:151], v89, s[24:27], s77 offen offset:3200 nt
    v_cvt_pk_bf16_f32 v192, v192, v196
    v_cvt_pk_bf16_f32 v196, v193, v197
    v_cvt_pk_bf16_f32 v193, v200, v204
    v_cvt_pk_bf16_f32 v197, v201, v205
    ds_write_b64 v0, v[192:193] offset:12800
    ds_write_b64 v0, v[196:197] offset:12960
    v_accvgpr_read_b32 v194, a178
    v_accvgpr_read_b32 v195, a179
    v_accvgpr_read_b32 v198, a182
    v_accvgpr_read_b32 v199, a183
    v_accvgpr_read_b32 v202, a186
    v_accvgpr_read_b32 v203, a187
    v_accvgpr_read_b32 v206, a190
    v_accvgpr_read_b32 v207, a191
    v_pk_mul_f32 v[194:195], v[106:107], v[194:195]
    v_pk_mul_f32 v[198:199], v[106:107], v[198:199]
    v_pk_mul_f32 v[202:203], v[106:107], v[202:203]
    v_pk_mul_f32 v[206:207], v[106:107], v[206:207]
    v_cvt_pk_bf16_f32 v194, v194, v198
    v_cvt_pk_bf16_f32 v198, v195, v199
    v_cvt_pk_bf16_f32 v195, v202, v206
    v_cvt_pk_bf16_f32 v199, v203, v207
    ds_write_b64 v0, v[194:195] offset:13120
    ds_write_b64 v0, v[198:199] offset:13280
    ds_read_b64_tr_b16 v[160:161], v88 offset:12800
    ds_read_b64_tr_b16 v[162:163], v88 offset:12832
    ds_read_b64_tr_b16 v[164:165], v88 offset:14080
    ds_read_b64_tr_b16 v[166:167], v88 offset:14112
    s_waitcnt lgkmcnt(2)
    buffer_store_dwordx4 v[160:163], v89, s[24:27], s77 offen offset:256 nt
    s_waitcnt lgkmcnt(0)
    buffer_store_dwordx4 v[164:167], v89, s[24:27], s77 offen offset:3328 nt
L_fin:
L_end:
    s_endpgm
L_slow:
    s_waitcnt lgkmcnt(0)
    s_nop 7
    v_mbcnt_lo_u32_b32 v0, -1, 0
    v_mbcnt_hi_u32_b32 v0, -1, v0
    v_and_b32 v10, 3, v0
    v_mul_u32_u24 v1, 3104, v10
    v_lshlrev_b32 v2, 3, v10
    v_bfe_u32 v10, v0, 2, 2
    v_mul_u32_u24 v11, 384, v10
    v_add_u32 v1, v1, v11
    v_mul_u32_u24 v11, 3104, v10
    v_add_u32 v2, v2, v11
    v_lshrrev_b32 v10, 4, v0
    v_lshl_add_u32 v1, v10, 4, v1
    v_mul_u32_u24 v11, 384, v10
    v_add_u32 v2, v2, v11
    v_add_u32 v1, s46, v1
    v_add_u32 v2, s46, v2
    v_lshlrev_b32 v3, 4, v0
    v_xor_b32 v16, 16, v0
    v_lshlrev_b32 v16, 2, v16
    v_xor_b32 v17, 32, v0
    v_lshlrev_b32 v17, 2, v17
    v_mov_b32 v76, 0xff800000
    v_mov_b32 v77, 0xff800000
    v_mov_b32 v78, 0xff800000
    v_mov_b32 v79, 0xff800000
    v_mov_b32 v10, 0xff800000
    v_mov_b32 v11, 0xff800000
    s_mov_b32 s47, 0
L_slow_max:
    s_add_u32 m0, s46, 0
    s_add_u32 s39, s47, 0
    buffer_load_dwordx4 v3, s[16:19], s39 offen offset:0 lds
    buffer_load_dwordx4 v3, s[16:19], s39 offen offset:1024 lds
    buffer_load_dwordx4 v3, s[16:19], s39 offen offset:2048 lds
    s_add_u32 m0, s46, 3104
    s_add_u32 s39, s47, 3072
    buffer_load_dwordx4 v3, s[16:19], s39 offen offset:0 lds
    buffer_load_dwordx4 v3, s[16:19], s39 offen offset:1024 lds
    buffer_load_dwordx4 v3, s[16:19], s39 offen offset:2048 lds
    s_add_u32 m0, s46, 6208
    s_add_u32 s39, s47, 6144
    buffer_load_dwordx4 v3, s[16:19], s39 offen offset:0 lds
    buffer_load_dwordx4 v3, s[16:19], s39 offen offset:1024 lds
    buffer_load_dwordx4 v3, s[16:19], s39 offen offset:2048 lds
    s_add_u32 m0, s46, 9312
    s_add_u32 s39, s47, 9216
    buffer_load_dwordx4 v3, s[16:19], s39 offen offset:0 lds
    buffer_load_dwordx4 v3, s[16:19], s39 offen offset:1024 lds
    buffer_load_dwordx4 v3, s[16:19], s39 offen offset:2048 lds
    s_waitcnt vmcnt(0)
    ds_read_b128 v[40:43], v1 offset:0
    ds_read_b128 v[44:47], v1 offset:64
    ds_read_b128 v[48:51], v1 offset:128
    ds_read_b128 v[52:55], v1 offset:192
    ds_read_b128 v[56:59], v1 offset:256
    ds_read_b128 v[60:63], v1 offset:320
    s_waitcnt lgkmcnt(0)
    v_mfma_f32_16x16x32_bf16 v[64:67], v[40:43], a[0:3], 0
    v_mfma_f32_16x16x32_bf16 v[64:67], v[44:47], a[4:7], v[64:67]
    v_mfma_f32_16x16x32_bf16 v[64:67], v[48:51], a[8:11], v[64:67]
    v_mfma_f32_16x16x32_bf16 v[64:67], v[52:55], a[12:15], v[64:67]
    v_mfma_f32_16x16x32_bf16 v[64:67], v[56:59], a[16:19], v[64:67]
    v_mfma_f32_16x16x32_bf16 v[64:67], v[60:63], a[20:23], v[64:67]
    s_nop 7
    v_max3_f32 v76, v76, v64, v65
    v_max3_f32 v76, v76, v66, v67
    v_mfma_f32_16x16x32_bf16 v[64:67], v[40:43], a[24:27], 0
    v_mfma_f32_16x16x32_bf16 v[64:67], v[44:47], a[28:31], v[64:67]
    v_mfma_f32_16x16x32_bf16 v[64:67], v[48:51], a[32:35], v[64:67]
    v_mfma_f32_16x16x32_bf16 v[64:67], v[52:55], a[36:39], v[64:67]
    v_mfma_f32_16x16x32_bf16 v[64:67], v[56:59], a[40:43], v[64:67]
    v_mfma_f32_16x16x32_bf16 v[64:67], v[60:63], a[44:47], v[64:67]
    s_nop 7
    v_max3_f32 v77, v77, v64, v65
    v_max3_f32 v77, v77, v66, v67
    v_mfma_f32_16x16x32_bf16 v[64:67], v[40:43], a[48:51], 0
    v_mfma_f32_16x16x32_bf16 v[64:67], v[44:47], a[52:55], v[64:67]
    v_mfma_f32_16x16x32_bf16 v[64:67], v[48:51], a[56:59], v[64:67]
    v_mfma_f32_16x16x32_bf16 v[64:67], v[52:55], a[60:63], v[64:67]
    v_mfma_f32_16x16x32_bf16 v[64:67], v[56:59], a[64:67], v[64:67]
    v_mfma_f32_16x16x32_bf16 v[64:67], v[60:63], a[68:71], v[64:67]
    s_nop 7
    v_max3_f32 v78, v78, v64, v65
    v_max3_f32 v78, v78, v66, v67
    v_mfma_f32_16x16x32_bf16 v[64:67], v[40:43], a[72:75], 0
    v_mfma_f32_16x16x32_bf16 v[64:67], v[44:47], a[76:79], v[64:67]
    v_mfma_f32_16x16x32_bf16 v[64:67], v[48:51], a[80:83], v[64:67]
    v_mfma_f32_16x16x32_bf16 v[64:67], v[52:55], a[84:87], v[64:67]
    v_mfma_f32_16x16x32_bf16 v[64:67], v[56:59], a[88:91], v[64:67]
    v_mfma_f32_16x16x32_bf16 v[64:67], v[60:63], a[92:95], v[64:67]
    s_nop 7
    v_max3_f32 v79, v79, v64, v65
    v_max3_f32 v79, v79, v66, v67
    v_mfma_f32_16x16x32_bf16 v[64:67], v[40:43], a[96:99], 0
    v_mfma_f32_16x16x32_bf16 v[64:67], v[44:47], a[100:103], v[64:67]
    v_mfma_f32_16x16x32_bf16 v[64:67], v[48:51], a[104:107], v[64:67]
    v_mfma_f32_16x16x32_bf16 v[64:67], v[52:55], a[108:111], v[64:67]
    v_mfma_f32_16x16x32_bf16 v[64:67], v[56:59], a[112:115], v[64:67]
    v_mfma_f32_16x16x32_bf16 v[64:67], v[60:63], a[116:119], v[64:67]
    s_nop 7
    v_max3_f32 v10, v10, v64, v65
    v_max3_f32 v10, v10, v66, v67
    v_mfma_f32_16x16x32_bf16 v[64:67], v[40:43], a[120:123], 0
    v_mfma_f32_16x16x32_bf16 v[64:67], v[44:47], a[124:127], v[64:67]
    v_mfma_f32_16x16x32_bf16 v[64:67], v[48:51], a[128:131], v[64:67]
    v_mfma_f32_16x16x32_bf16 v[64:67], v[52:55], a[132:135], v[64:67]
    v_mfma_f32_16x16x32_bf16 v[64:67], v[56:59], a[136:139], v[64:67]
    v_mfma_f32_16x16x32_bf16 v[64:67], v[60:63], a[140:143], v[64:67]
    s_nop 7
    v_max3_f32 v11, v11, v64, v65
    v_max3_f32 v11, v11, v66, v67
    ds_read_b128 v[40:43], v1 offset:1536
    ds_read_b128 v[44:47], v1 offset:1600
    ds_read_b128 v[48:51], v1 offset:1664
    ds_read_b128 v[52:55], v1 offset:1728
    ds_read_b128 v[56:59], v1 offset:1792
    ds_read_b128 v[60:63], v1 offset:1856
    s_waitcnt lgkmcnt(0)
    v_mfma_f32_16x16x32_bf16 v[64:67], v[40:43], a[0:3], 0
    v_mfma_f32_16x16x32_bf16 v[64:67], v[44:47], a[4:7], v[64:67]
    v_mfma_f32_16x16x32_bf16 v[64:67], v[48:51], a[8:11], v[64:67]
    v_mfma_f32_16x16x32_bf16 v[64:67], v[52:55], a[12:15], v[64:67]
    v_mfma_f32_16x16x32_bf16 v[64:67], v[56:59], a[16:19], v[64:67]
    v_mfma_f32_16x16x32_bf16 v[64:67], v[60:63], a[20:23], v[64:67]
    s_nop 7
    v_max3_f32 v76, v76, v64, v65
    v_max3_f32 v76, v76, v66, v67
    v_mfma_f32_16x16x32_bf16 v[64:67], v[40:43], a[24:27], 0
    v_mfma_f32_16x16x32_bf16 v[64:67], v[44:47], a[28:31], v[64:67]
    v_mfma_f32_16x16x32_bf16 v[64:67], v[48:51], a[32:35], v[64:67]
    v_mfma_f32_16x16x32_bf16 v[64:67], v[52:55], a[36:39], v[64:67]
    v_mfma_f32_16x16x32_bf16 v[64:67], v[56:59], a[40:43], v[64:67]
    v_mfma_f32_16x16x32_bf16 v[64:67], v[60:63], a[44:47], v[64:67]
    s_nop 7
    v_max3_f32 v77, v77, v64, v65
    v_max3_f32 v77, v77, v66, v67
    v_mfma_f32_16x16x32_bf16 v[64:67], v[40:43], a[48:51], 0
    v_mfma_f32_16x16x32_bf16 v[64:67], v[44:47], a[52:55], v[64:67]
    v_mfma_f32_16x16x32_bf16 v[64:67], v[48:51], a[56:59], v[64:67]
    v_mfma_f32_16x16x32_bf16 v[64:67], v[52:55], a[60:63], v[64:67]
    v_mfma_f32_16x16x32_bf16 v[64:67], v[56:59], a[64:67], v[64:67]
    v_mfma_f32_16x16x32_bf16 v[64:67], v[60:63], a[68:71], v[64:67]
    s_nop 7
    v_max3_f32 v78, v78, v64, v65
    v_max3_f32 v78, v78, v66, v67
    v_mfma_f32_16x16x32_bf16 v[64:67], v[40:43], a[72:75], 0
    v_mfma_f32_16x16x32_bf16 v[64:67], v[44:47], a[76:79], v[64:67]
    v_mfma_f32_16x16x32_bf16 v[64:67], v[48:51], a[80:83], v[64:67]
    v_mfma_f32_16x16x32_bf16 v[64:67], v[52:55], a[84:87], v[64:67]
    v_mfma_f32_16x16x32_bf16 v[64:67], v[56:59], a[88:91], v[64:67]
    v_mfma_f32_16x16x32_bf16 v[64:67], v[60:63], a[92:95], v[64:67]
    s_nop 7
    v_max3_f32 v79, v79, v64, v65
    v_max3_f32 v79, v79, v66, v67
    v_mfma_f32_16x16x32_bf16 v[64:67], v[40:43], a[96:99], 0
    v_mfma_f32_16x16x32_bf16 v[64:67], v[44:47], a[100:103], v[64:67]
    v_mfma_f32_16x16x32_bf16 v[64:67], v[48:51], a[104:107], v[64:67]
    v_mfma_f32_16x16x32_bf16 v[64:67], v[52:55], a[108:111], v[64:67]
    v_mfma_f32_16x16x32_bf16 v[64:67], v[56:59], a[112:115], v[64:67]
    v_mfma_f32_16x16x32_bf16 v[64:67], v[60:63], a[116:119], v[64:67]
    s_nop 7
    v_max3_f32 v10, v10, v64, v65
    v_max3_f32 v10, v10, v66, v67
    v_mfma_f32_16x16x32_bf16 v[64:67], v[40:43], a[120:123], 0
    v_mfma_f32_16x16x32_bf16 v[64:67], v[44:47], a[124:127], v[64:67]
    v_mfma_f32_16x16x32_bf16 v[64:67], v[48:51], a[128:131], v[64:67]
    v_mfma_f32_16x16x32_bf16 v[64:67], v[52:55], a[132:135], v[64:67]
    v_mfma_f32_16x16x32_bf16 v[64:67], v[56:59], a[136:139], v[64:67]
    v_mfma_f32_16x16x32_bf16 v[64:67], v[60:63], a[140:143], v[64:67]
    s_nop 7
    v_max3_f32 v11, v11, v64, v65
    v_max3_f32 v11, v11, v66, v67
    s_add_u32 s47, s47, 12288
    s_cmp_lt_u32 s47, 393216
    s_cbranch_scc1 L_slow_max
    ds_bpermute_b32 v20, v16, v76
    ds_bpermute_b32 v21, v16, v77
    ds_bpermute_b32 v22, v16, v78
    ds_bpermute_b32 v23, v16, v79
    ds_bpermute_b32 v24, v16, v10
    ds_bpermute_b32 v25, v16, v11
    s_waitcnt lgkmcnt(0)
    v_max_f32 v76, v76, v20
    v_max_f32 v77, v77, v21
    v_max_f32 v78, v78, v22
    v_max_f32 v79, v79, v23
    v_max_f32 v10, v10, v24
    v_max_f32 v11, v11, v25
    ds_bpermute_b32 v20, v17, v76
    ds_bpermute_b32 v21, v17, v77
    ds_bpermute_b32 v22, v17, v78
    ds_bpermute_b32 v23, v17, v79
    ds_bpermute_b32 v24, v17, v10
    ds_bpermute_b32 v25, v17, v11
    s_waitcnt lgkmcnt(0)
    v_max_f32 v76, v76, v20
    v_max_f32 v77, v77, v21
    v_max_f32 v78, v78, v22
    v_max_f32 v79, v79, v23
    v_max_f32 v10, v10, v24
    v_max_f32 v11, v11, v25
    v_mov_b32 v4, 0
    v_mov_b32 v5, 0
    v_mov_b32 v6, 0
    v_mov_b32 v7, 0
    v_mov_b32 v8, 0
    v_mov_b32 v9, 0
    v_mov_b32 v80, 0
    v_mov_b32 v81, 0
    v_mov_b32 v82, 0
    v_mov_b32 v83, 0
    v_mov_b32 v84, 0
    v_mov_b32 v85, 0
    v_mov_b32 v86, 0
    v_mov_b32 v87, 0
    v_mov_b32 v88, 0
    v_mov_b32 v89, 0
    v_mov_b32 v90, 0
    v_mov_b32 v91, 0
    v_mov_b32 v92, 0
    v_mov_b32 v93, 0
    v_mov_b32 v94, 0
    v_mov_b32 v95, 0
    v_mov_b32 v96, 0
    v_mov_b32 v97, 0
    v_mov_b32 v98, 0
    v_mov_b32 v99, 0
    v_mov_b32 v100, 0
    v_mov_b32 v101, 0
    v_mov_b32 v102, 0
    v_mov_b32 v103, 0
    v_mov_b32 v104, 0
    v_mov_b32 v105, 0
    v_mov_b32 v106, 0
    v_mov_b32 v107, 0
    v_mov_b32 v108, 0
    v_mov_b32 v109, 0
    v_mov_b32 v110, 0
    v_mov_b32 v111, 0
    v_mov_b32 v112, 0
    v_mov_b32 v113, 0
    v_mov_b32 v114, 0
    v_mov_b32 v115, 0
    v_mov_b32 v116, 0
    v_mov_b32 v117, 0
    v_mov_b32 v118, 0
    v_mov_b32 v119, 0
    v_mov_b32 v120, 0
    v_mov_b32 v121, 0
    v_mov_b32 v122, 0
    v_mov_b32 v123, 0
    v_mov_b32 v124, 0
    v_mov_b32 v125, 0
    v_mov_b32 v126, 0
    v_mov_b32 v127, 0
    v_mov_b32 v128, 0
    v_mov_b32 v129, 0
    v_mov_b32 v130, 0
    v_mov_b32 v131, 0
    v_mov_b32 v132, 0
    v_mov_b32 v133, 0
    v_mov_b32 v134, 0
    v_mov_b32 v135, 0
    v_mov_b32 v136, 0
    v_mov_b32 v137, 0
    v_mov_b32 v138, 0
    v_mov_b32 v139, 0
    v_mov_b32 v140, 0
    v_mov_b32 v141, 0
    v_mov_b32 v142, 0
    v_mov_b32 v143, 0
    v_mov_b32 v144, 0
    v_mov_b32 v145, 0
    v_mov_b32 v146, 0
    v_mov_b32 v147, 0
    v_mov_b32 v148, 0
    v_mov_b32 v149, 0
    v_mov_b32 v150, 0
    v_mov_b32 v151, 0
    v_mov_b32 v152, 0
    v_mov_b32 v153, 0
    v_mov_b32 v154, 0
    v_mov_b32 v155, 0
    v_mov_b32 v156, 0
    v_mov_b32 v157, 0
    v_mov_b32 v158, 0
    v_mov_b32 v159, 0
    v_mov_b32 v160, 0
    v_mov_b32 v161, 0
    v_mov_b32 v162, 0
    v_mov_b32 v163, 0
    v_mov_b32 v164, 0
    v_mov_b32 v165, 0
    v_mov_b32 v166, 0
    v_mov_b32 v167, 0
    v_mov_b32 v168, 0
    v_mov_b32 v169, 0
    v_mov_b32 v170, 0
    v_mov_b32 v171, 0
    v_mov_b32 v172, 0
    v_mov_b32 v173, 0
    v_mov_b32 v174, 0
    v_mov_b32 v175, 0
    v_mov_b32 v176, 0
    v_mov_b32 v177, 0
    v_mov_b32 v178, 0
    v_mov_b32 v179, 0
    v_mov_b32 v180, 0
    v_mov_b32 v181, 0
    v_mov_b32 v182, 0
    v_mov_b32 v183, 0
    v_mov_b32 v184, 0
    v_mov_b32 v185, 0
    v_mov_b32 v186, 0
    v_mov_b32 v187, 0
    v_mov_b32 v188, 0
    v_mov_b32 v189, 0
    v_mov_b32 v190, 0
    v_mov_b32 v191, 0
    v_mov_b32 v192, 0
    v_mov_b32 v193, 0
    v_mov_b32 v194, 0
    v_mov_b32 v195, 0
    v_mov_b32 v196, 0
    v_mov_b32 v197, 0
    v_mov_b32 v198, 0
    v_mov_b32 v199, 0
    v_mov_b32 v200, 0
    v_mov_b32 v201, 0
    v_mov_b32 v202, 0
    v_mov_b32 v203, 0
    v_mov_b32 v204, 0
    v_mov_b32 v205, 0
    v_mov_b32 v206, 0
    v_mov_b32 v207, 0
    v_mov_b32 v208, 0
    v_mov_b32 v209, 0
    v_mov_b32 v210, 0
    v_mov_b32 v211, 0
    v_mov_b32 v212, 0
    v_mov_b32 v213, 0
    v_mov_b32 v214, 0
    v_mov_b32 v215, 0
    v_mov_b32 v216, 0
    v_mov_b32 v217, 0
    v_mov_b32 v218, 0
    v_mov_b32 v219, 0
    v_mov_b32 v220, 0
    v_mov_b32 v221, 0
    v_mov_b32 v222, 0
    v_mov_b32 v223, 0
    v_accvgpr_write_b32 a240, 0
    v_accvgpr_write_b32 a241, 0
    v_accvgpr_write_b32 a242, 0
    v_accvgpr_write_b32 a243, 0
    v_accvgpr_write_b32 a244, 0
    v_accvgpr_write_b32 a245, 0
    v_accvgpr_write_b32 a246, 0
    v_accvgpr_write_b32 a247, 0
    v_accvgpr_write_b32 a248, 0
    v_accvgpr_write_b32 a249, 0
    v_accvgpr_write_b32 a250, 0
    v_accvgpr_write_b32 a251, 0
    v_accvgpr_write_b32 a252, 0
    v_accvgpr_write_b32 a253, 0
    v_accvgpr_write_b32 a254, 0
    v_accvgpr_write_b32 a255, 0
    v_mov_b32 v224, 0
    v_mov_b32 v225, 0
    v_mov_b32 v226, 0
    v_mov_b32 v227, 0
    v_mov_b32 v228, 0
    v_mov_b32 v229, 0
    v_mov_b32 v230, 0
    v_mov_b32 v231, 0
    v_mov_b32 v232, 0
    v_mov_b32 v233, 0
    v_mov_b32 v234, 0
    v_mov_b32 v235, 0
    v_mov_b32 v236, 0
    v_mov_b32 v237, 0
    v_mov_b32 v238, 0
    v_mov_b32 v239, 0
    v_mov_b32 v240, 0
    v_mov_b32 v241, 0
    v_mov_b32 v242, 0
    v_mov_b32 v243, 0
    v_mov_b32 v244, 0
    v_mov_b32 v245, 0
    v_mov_b32 v246, 0
    v_mov_b32 v247, 0
    v_mov_b32 v248, 0
    v_mov_b32 v249, 0
    v_mov_b32 v250, 0
    v_mov_b32 v251, 0
    v_mov_b32 v252, 0
    v_mov_b32 v253, 0
    v_mov_b32 v254, 0
    v_mov_b32 v255, 0
    v_accvgpr_write_b32 a192, 0
    v_accvgpr_write_b32 a193, 0
    v_accvgpr_write_b32 a194, 0
    v_accvgpr_write_b32 a195, 0
    v_accvgpr_write_b32 a196, 0
    v_accvgpr_write_b32 a197, 0
    v_accvgpr_write_b32 a198, 0
    v_accvgpr_write_b32 a199, 0
    v_accvgpr_write_b32 a200, 0
    v_accvgpr_write_b32 a201, 0
    v_accvgpr_write_b32 a202, 0
    v_accvgpr_write_b32 a203, 0
    v_accvgpr_write_b32 a204, 0
    v_accvgpr_write_b32 a205, 0
    v_accvgpr_write_b32 a206, 0
    v_accvgpr_write_b32 a207, 0
    v_accvgpr_write_b32 a208, 0
    v_accvgpr_write_b32 a209, 0
    v_accvgpr_write_b32 a210, 0
    v_accvgpr_write_b32 a211, 0
    v_accvgpr_write_b32 a212, 0
    v_accvgpr_write_b32 a213, 0
    v_accvgpr_write_b32 a214, 0
    v_accvgpr_write_b32 a215, 0
    v_accvgpr_write_b32 a216, 0
    v_accvgpr_write_b32 a217, 0
    v_accvgpr_write_b32 a218, 0
    v_accvgpr_write_b32 a219, 0
    v_accvgpr_write_b32 a220, 0
    v_accvgpr_write_b32 a221, 0
    v_accvgpr_write_b32 a222, 0
    v_accvgpr_write_b32 a223, 0
    v_accvgpr_write_b32 a224, 0
    v_accvgpr_write_b32 a225, 0
    v_accvgpr_write_b32 a226, 0
    v_accvgpr_write_b32 a227, 0
    v_accvgpr_write_b32 a228, 0
    v_accvgpr_write_b32 a229, 0
    v_accvgpr_write_b32 a230, 0
    v_accvgpr_write_b32 a231, 0
    v_accvgpr_write_b32 a232, 0
    v_accvgpr_write_b32 a233, 0
    v_accvgpr_write_b32 a234, 0
    v_accvgpr_write_b32 a235, 0
    v_accvgpr_write_b32 a236, 0
    v_accvgpr_write_b32 a237, 0
    v_accvgpr_write_b32 a238, 0
    v_accvgpr_write_b32 a239, 0
    v_accvgpr_write_b32 a144, 0
    v_accvgpr_write_b32 a145, 0
    v_accvgpr_write_b32 a146, 0
    v_accvgpr_write_b32 a147, 0
    v_accvgpr_write_b32 a148, 0
    v_accvgpr_write_b32 a149, 0
    v_accvgpr_write_b32 a150, 0
    v_accvgpr_write_b32 a151, 0
    v_accvgpr_write_b32 a152, 0
    v_accvgpr_write_b32 a153, 0
    v_accvgpr_write_b32 a154, 0
    v_accvgpr_write_b32 a155, 0
    v_accvgpr_write_b32 a156, 0
    v_accvgpr_write_b32 a157, 0
    v_accvgpr_write_b32 a158, 0
    v_accvgpr_write_b32 a159, 0
    v_accvgpr_write_b32 a160, 0
    v_accvgpr_write_b32 a161, 0
    v_accvgpr_write_b32 a162, 0
    v_accvgpr_write_b32 a163, 0
    v_accvgpr_write_b32 a164, 0
    v_accvgpr_write_b32 a165, 0
    v_accvgpr_write_b32 a166, 0
    v_accvgpr_write_b32 a167, 0
    v_accvgpr_write_b32 a168, 0
    v_accvgpr_write_b32 a169, 0
    v_accvgpr_write_b32 a170, 0
    v_accvgpr_write_b32 a171, 0
    v_accvgpr_write_b32 a172, 0
    v_accvgpr_write_b32 a173, 0
    v_accvgpr_write_b32 a174, 0
    v_accvgpr_write_b32 a175, 0
    v_accvgpr_write_b32 a176, 0
    v_accvgpr_write_b32 a177, 0
    v_accvgpr_write_b32 a178, 0
    v_accvgpr_write_b32 a179, 0
    v_accvgpr_write_b32 a180, 0
    v_accvgpr_write_b32 a181, 0
    v_accvgpr_write_b32 a182, 0
    v_accvgpr_write_b32 a183, 0
    v_accvgpr_write_b32 a184, 0
    v_accvgpr_write_b32 a185, 0
    v_accvgpr_write_b32 a186, 0
    v_accvgpr_write_b32 a187, 0
    v_accvgpr_write_b32 a188, 0
    v_accvgpr_write_b32 a189, 0
    v_accvgpr_write_b32 a190, 0
    v_accvgpr_write_b32 a191, 0
    s_mov_b32 s47, 0
L_slow_main:
    s_add_u32 m0, s46, 0
    s_add_u32 s39, s47, 0
    buffer_load_dwordx4 v3, s[16:19], s39 offen offset:0 lds
    buffer_load_dwordx4 v3, s[16:19], s39 offen offset:1024 lds
    buffer_load_dwordx4 v3, s[16:19], s39 offen offset:2048 lds
    s_add_u32 m0, s46, 3104
    s_add_u32 s39, s47, 3072
    buffer_load_dwordx4 v3, s[16:19], s39 offen offset:0 lds
    buffer_load_dwordx4 v3, s[16:19], s39 offen offset:1024 lds
    buffer_load_dwordx4 v3, s[16:19], s39 offen offset:2048 lds
    s_add_u32 m0, s46, 6208
    s_add_u32 s39, s47, 6144
    buffer_load_dwordx4 v3, s[16:19], s39 offen offset:0 lds
    buffer_load_dwordx4 v3, s[16:19], s39 offen offset:1024 lds
    buffer_load_dwordx4 v3, s[16:19], s39 offen offset:2048 lds
    s_add_u32 m0, s46, 9312
    s_add_u32 s39, s47, 9216
    buffer_load_dwordx4 v3, s[16:19], s39 offen offset:0 lds
    buffer_load_dwordx4 v3, s[16:19], s39 offen offset:1024 lds
    buffer_load_dwordx4 v3, s[16:19], s39 offen offset:2048 lds
    s_waitcnt vmcnt(0)
    ds_read_b128 v[40:43], v1 offset:0
    ds_read_b128 v[44:47], v1 offset:64
    ds_read_b128 v[48:51], v1 offset:128
    ds_read_b128 v[52:55], v1 offset:192
    ds_read_b128 v[56:59], v1 offset:256
    ds_read_b128 v[60:63], v1 offset:320
    s_waitcnt lgkmcnt(0)
    v_mfma_f32_16x16x32_bf16 v[64:67], v[40:43], a[0:3], 0
    v_mfma_f32_16x16x32_bf16 v[64:67], v[44:47], a[4:7], v[64:67]
    v_mfma_f32_16x16x32_bf16 v[64:67], v[48:51], a[8:11], v[64:67]
    v_mfma_f32_16x16x32_bf16 v[64:67], v[52:55], a[12:15], v[64:67]
    v_mfma_f32_16x16x32_bf16 v[64:67], v[56:59], a[16:19], v[64:67]
    v_mfma_f32_16x16x32_bf16 v[64:67], v[60:63], a[20:23], v[64:67]
    s_nop 7
    v_sub_f32 v64, v64, v76
    v_sub_f32 v65, v65, v76
    v_sub_f32 v66, v66, v76
    v_sub_f32 v67, v67, v76
    v_exp_f32 v64, v64
    v_exp_f32 v65, v65
    v_exp_f32 v66, v66
    v_exp_f32 v67, v67
    s_nop 0
    v_cvt_pk_bf16_f32 v16, v64, v65
    v_cvt_pk_bf16_f32 v17, v66, v67
    v_mfma_f32_16x16x32_bf16 v[64:67], v[40:43], a[24:27], 0
    v_mfma_f32_16x16x32_bf16 v[64:67], v[44:47], a[28:31], v[64:67]
    v_mfma_f32_16x16x32_bf16 v[64:67], v[48:51], a[32:35], v[64:67]
    v_mfma_f32_16x16x32_bf16 v[64:67], v[52:55], a[36:39], v[64:67]
    v_mfma_f32_16x16x32_bf16 v[64:67], v[56:59], a[40:43], v[64:67]
    v_mfma_f32_16x16x32_bf16 v[64:67], v[60:63], a[44:47], v[64:67]
    s_nop 7
    v_sub_f32 v64, v64, v77
    v_sub_f32 v65, v65, v77
    v_sub_f32 v66, v66, v77
    v_sub_f32 v67, v67, v77
    v_exp_f32 v64, v64
    v_exp_f32 v65, v65
    v_exp_f32 v66, v66
    v_exp_f32 v67, v67
    s_nop 0
    v_cvt_pk_bf16_f32 v20, v64, v65
    v_cvt_pk_bf16_f32 v21, v66, v67
    v_mfma_f32_16x16x32_bf16 v[64:67], v[40:43], a[48:51], 0
    v_mfma_f32_16x16x32_bf16 v[64:67], v[44:47], a[52:55], v[64:67]
    v_mfma_f32_16x16x32_bf16 v[64:67], v[48:51], a[56:59], v[64:67]
    v_mfma_f32_16x16x32_bf16 v[64:67], v[52:55], a[60:63], v[64:67]
    v_mfma_f32_16x16x32_bf16 v[64:67], v[56:59], a[64:67], v[64:67]
    v_mfma_f32_16x16x32_bf16 v[64:67], v[60:63], a[68:71], v[64:67]
    s_nop 7
    v_sub_f32 v64, v64, v78
    v_sub_f32 v65, v65, v78
    v_sub_f32 v66, v66, v78
    v_sub_f32 v67, v67, v78
    v_exp_f32 v64, v64
    v_exp_f32 v65, v65
    v_exp_f32 v66, v66
    v_exp_f32 v67, v67
    s_nop 0
    v_cvt_pk_bf16_f32 v24, v64, v65
    v_cvt_pk_bf16_f32 v25, v66, v67
    v_mfma_f32_16x16x32_bf16 v[64:67], v[40:43], a[72:75], 0
    v_mfma_f32_16x16x32_bf16 v[64:67], v[44:47], a[76:79], v[64:67]
    v_mfma_f32_16x16x32_bf16 v[64:67], v[48:51], a[80:83], v[64:67]
    v_mfma_f32_16x16x32_bf16 v[64:67], v[52:55], a[84:87], v[64:67]
    v_mfma_f32_16x16x32_bf16 v[64:67], v[56:59], a[88:91], v[64:67]
    v_mfma_f32_16x16x32_bf16 v[64:67], v[60:63], a[92:95], v[64:67]
    s_nop 7
    v_sub_f32 v64, v64, v79
    v_sub_f32 v65, v65, v79
    v_sub_f32 v66, v66, v79
    v_sub_f32 v67, v67, v79
    v_exp_f32 v64, v64
    v_exp_f32 v65, v65
    v_exp_f32 v66, v66
    v_exp_f32 v67, v67
    s_nop 0
    v_cvt_pk_bf16_f32 v28, v64, v65
    v_cvt_pk_bf16_f32 v29, v66, v67
    v_mfma_f32_16x16x32_bf16 v[64:67], v[40:43], a[96:99], 0
    v_mfma_f32_16x16x32_bf16 v[64:67], v[44:47], a[100:103], v[64:67]
    v_mfma_f32_16x16x32_bf16 v[64:67], v[48:51], a[104:107], v[64:67]
    v_mfma_f32_16x16x32_bf16 v[64:67], v[52:55], a[108:111], v[64:67]
    v_mfma_f32_16x16x32_bf16 v[64:67], v[56:59], a[112:115], v[64:67]
    v_mfma_f32_16x16x32_bf16 v[64:67], v[60:63], a[116:119], v[64:67]
    s_nop 7
    v_sub_f32 v64, v64, v10
    v_sub_f32 v65, v65, v10
    v_sub_f32 v66, v66, v10
    v_sub_f32 v67, v67, v10
    v_exp_f32 v64, v64
    v_exp_f32 v65, v65
    v_exp_f32 v66, v66
    v_exp_f32 v67, v67
    s_nop 0
    v_cvt_pk_bf16_f32 v32, v64, v65
    v_cvt_pk_bf16_f32 v33, v66, v67
    v_mfma_f32_16x16x32_bf16 v[64:67], v[40:43], a[120:123], 0
    v_mfma_f32_16x16x32_bf16 v[64:67], v[44:47], a[124:127], v[64:67]
    v_mfma_f32_16x16x32_bf16 v[64:67], v[48:51], a[128:131], v[64:67]
    v_mfma_f32_16x16x32_bf16 v[64:67], v[52:55], a[132:135], v[64:67]
    v_mfma_f32_16x16x32_bf16 v[64:67], v[56:59], a[136:139], v[64:67]
    v_mfma_f32_16x16x32_bf16 v[64:67], v[60:63], a[140:143], v[64:67]
    s_nop 7
    v_sub_f32 v64, v64, v11
    v_sub_f32 v65, v65, v11
    v_sub_f32 v66, v66, v11
    v_sub_f32 v67, v67, v11
    v_exp_f32 v64, v64
    v_exp_f32 v65, v65
    v_exp_f32 v66, v66
    v_exp_f32 v67, v67
    s_nop 0
    v_cvt_pk_bf16_f32 v36, v64, v65
    v_cvt_pk_bf16_f32 v37, v66, v67
    ds_read_b128 v[40:43], v1 offset:1536
    ds_read_b128 v[44:47], v1 offset:1600
    ds_read_b128 v[48:51], v1 offset:1664
    ds_read_b128 v[52:55], v1 offset:1728
    ds_read_b128 v[56:59], v1 offset:1792
    ds_read_b128 v[60:63], v1 offset:1856
    s_waitcnt lgkmcnt(0)
    v_mfma_f32_16x16x32_bf16 v[64:67], v[40:43], a[0:3], 0
    v_mfma_f32_16x16x32_bf16 v[64:67], v[44:47], a[4:7], v[64:67]
    v_mfma_f32_16x16x32_bf16 v[64:67], v[48:51], a[8:11], v[64:67]
    v_mfma_f32_16x16x32_bf16 v[64:67], v[52:55], a[12:15], v[64:67]
    v_mfma_f32_16x16x32_bf16 v[64:67], v[56:59], a[16:19], v[64:67]
    v_mfma_f32_16x16x32_bf16 v[64:67], v[60:63], a[20:23], v[64:67]
    s_nop 7
    v_sub_f32 v64, v64, v76
    v_sub_f32 v65, v65, v76
    v_sub_f32 v66, v66, v76
    v_sub_f32 v67, v67, v76
    v_exp_f32 v64, v64
    v_exp_f32 v65, v65
    v_exp_f32 v66, v66
    v_exp_f32 v67, v67
    s_nop 0
    v_cvt_pk_bf16_f32 v18, v64, v65
    v_cvt_pk_bf16_f32 v19, v66, v67
    v_mfma_f32_16x16x32_bf16 v[64:67], v[40:43], a[24:27], 0
    v_mfma_f32_16x16x32_bf16 v[64:67], v[44:47], a[28:31], v[64:67]
    v_mfma_f32_16x16x32_bf16 v[64:67], v[48:51], a[32:35], v[64:67]
    v_mfma_f32_16x16x32_bf16 v[64:67], v[52:55], a[36:39], v[64:67]
    v_mfma_f32_16x16x32_bf16 v[64:67], v[56:59], a[40:43], v[64:67]
    v_mfma_f32_16x16x32_bf16 v[64:67], v[60:63], a[44:47], v[64:67]
    s_nop 7
    v_sub_f32 v64, v64, v77
    v_sub_f32 v65, v65, v77
    v_sub_f32 v66, v66, v77
    v_sub_f32 v67, v67, v77
    v_exp_f32 v64, v64
    v_exp_f32 v65, v65
    v_exp_f32 v66, v66
    v_exp_f32 v67, v67
    s_nop 0
    v_cvt_pk_bf16_f32 v22, v64, v65
    v_cvt_pk_bf16_f32 v23, v66, v67
    v_mfma_f32_16x16x32_bf16 v[64:67], v[40:43], a[48:51], 0
    v_mfma_f32_16x16x32_bf16 v[64:67], v[44:47], a[52:55], v[64:67]
    v_mfma_f32_16x16x32_bf16 v[64:67], v[48:51], a[56:59], v[64:67]
    v_mfma_f32_16x16x32_bf16 v[64:67], v[52:55], a[60:63], v[64:67]
    v_mfma_f32_16x16x32_bf16 v[64:67], v[56:59], a[64:67], v[64:67]
    v_mfma_f32_16x16x32_bf16 v[64:67], v[60:63], a[68:71], v[64:67]
    s_nop 7
    v_sub_f32 v64, v64, v78
    v_sub_f32 v65, v65, v78
    v_sub_f32 v66, v66, v78
    v_sub_f32 v67, v67, v78
    v_exp_f32 v64, v64
    v_exp_f32 v65, v65
    v_exp_f32 v66, v66
    v_exp_f32 v67, v67
    s_nop 0
    v_cvt_pk_bf16_f32 v26, v64, v65
    v_cvt_pk_bf16_f32 v27, v66, v67
    v_mfma_f32_16x16x32_bf16 v[64:67], v[40:43], a[72:75], 0
    v_mfma_f32_16x16x32_bf16 v[64:67], v[44:47], a[76:79], v[64:67]
    v_mfma_f32_16x16x32_bf16 v[64:67], v[48:51], a[80:83], v[64:67]
    v_mfma_f32_16x16x32_bf16 v[64:67], v[52:55], a[84:87], v[64:67]
    v_mfma_f32_16x16x32_bf16 v[64:67], v[56:59], a[88:91], v[64:67]
    v_mfma_f32_16x16x32_bf16 v[64:67], v[60:63], a[92:95], v[64:67]
    s_nop 7
    v_sub_f32 v64, v64, v79
    v_sub_f32 v65, v65, v79
    v_sub_f32 v66, v66, v79
    v_sub_f32 v67, v67, v79
    v_exp_f32 v64, v64
    v_exp_f32 v65, v65
    v_exp_f32 v66, v66
    v_exp_f32 v67, v67
    s_nop 0
    v_cvt_pk_bf16_f32 v30, v64, v65
    v_cvt_pk_bf16_f32 v31, v66, v67
    v_mfma_f32_16x16x32_bf16 v[64:67], v[40:43], a[96:99], 0
    v_mfma_f32_16x16x32_bf16 v[64:67], v[44:47], a[100:103], v[64:67]
    v_mfma_f32_16x16x32_bf16 v[64:67], v[48:51], a[104:107], v[64:67]
    v_mfma_f32_16x16x32_bf16 v[64:67], v[52:55], a[108:111], v[64:67]
    v_mfma_f32_16x16x32_bf16 v[64:67], v[56:59], a[112:115], v[64:67]
    v_mfma_f32_16x16x32_bf16 v[64:67], v[60:63], a[116:119], v[64:67]
    s_nop 7
    v_sub_f32 v64, v64, v10
    v_sub_f32 v65, v65, v10
    v_sub_f32 v66, v66, v10
    v_sub_f32 v67, v67, v10
    v_exp_f32 v64, v64
    v_exp_f32 v65, v65
    v_exp_f32 v66, v66
    v_exp_f32 v67, v67
    s_nop 0
    v_cvt_pk_bf16_f32 v34, v64, v65
    v_cvt_pk_bf16_f32 v35, v66, v67
    v_mfma_f32_16x16x32_bf16 v[64:67], v[40:43], a[120:123], 0
    v_mfma_f32_16x16x32_bf16 v[64:67], v[44:47], a[124:127], v[64:67]
    v_mfma_f32_16x16x32_bf16 v[64:67], v[48:51], a[128:131], v[64:67]
    v_mfma_f32_16x16x32_bf16 v[64:67], v[52:55], a[132:135], v[64:67]
    v_mfma_f32_16x16x32_bf16 v[64:67], v[56:59], a[136:139], v[64:67]
    v_mfma_f32_16x16x32_bf16 v[64:67], v[60:63], a[140:143], v[64:67]
    s_nop 7
    v_sub_f32 v64, v64, v11
    v_sub_f32 v65, v65, v11
    v_sub_f32 v66, v66, v11
    v_sub_f32 v67, v67, v11
    v_exp_f32 v64, v64
    v_exp_f32 v65, v65
    v_exp_f32 v66, v66
    v_exp_f32 v67, v67
    s_nop 0
    v_cvt_pk_bf16_f32 v38, v64, v65
    v_cvt_pk_bf16_f32 v39, v66, v67
    s_add_u32 m0, s46, 0
    s_add_u32 s39, s47, 0
    buffer_load_dwordx4 v3, s[20:23], s39 offen offset:0 lds
    buffer_load_dwordx4 v3, s[20:23], s39 offen offset:1024 lds
    buffer_load_dwordx4 v3, s[20:23], s39 offen offset:2048 lds
    s_add_u32 m0, s46, 3104
    s_add_u32 s39, s47, 3072
    buffer_load_dwordx4 v3, s[20:23], s39 offen offset:0 lds
    buffer_load_dwordx4 v3, s[20:23], s39 offen offset:1024 lds
    buffer_load_dwordx4 v3, s[20:23], s39 offen offset:2048 lds
    s_add_u32 m0, s46, 6208
    s_add_u32 s39, s47, 6144
    buffer_load_dwordx4 v3, s[20:23], s39 offen offset:0 lds
    buffer_load_dwordx4 v3, s[20:23], s39 offen offset:1024 lds
    buffer_load_dwordx4 v3, s[20:23], s39 offen offset:2048 lds
    s_add_u32 m0, s46, 9312
    s_add_u32 s39, s47, 9216
    buffer_load_dwordx4 v3, s[20:23], s39 offen offset:0 lds
    buffer_load_dwordx4 v3, s[20:23], s39 offen offset:1024 lds
    buffer_load_dwordx4 v3, s[20:23], s39 offen offset:2048 lds
    s_waitcnt vmcnt(0)
    v_mfma_f32_16x16x32_bf16 v[64:67], v[12:15], v[16:19], 0
    s_nop 7
    v_add_f32 v4, v4, v64
    v_mfma_f32_16x16x32_bf16 v[64:67], v[12:15], v[20:23], 0
    s_nop 7
    v_add_f32 v5, v5, v64
    v_mfma_f32_16x16x32_bf16 v[64:67], v[12:15], v[24:27], 0
    s_nop 7
    v_add_f32 v6, v6, v64
    v_mfma_f32_16x16x32_bf16 v[64:67], v[12:15], v[28:31], 0
    s_nop 7
    v_add_f32 v7, v7, v64
    v_mfma_f32_16x16x32_bf16 v[64:67], v[12:15], v[32:35], 0
    s_nop 7
    v_add_f32 v8, v8, v64
    v_mfma_f32_16x16x32_bf16 v[64:67], v[12:15], v[36:39], 0
    s_nop 7
    v_add_f32 v9, v9, v64
    ds_read_b64_tr_b16 v[68:69], v2 offset:0
    ds_read_b64_tr_b16 v[70:71], v2 offset:1536
    s_waitcnt lgkmcnt(0)
    v_mfma_f32_16x16x32_bf16 v[80:83], v[16:19], v[68:71], v[80:83]
    v_mfma_f32_16x16x32_bf16 v[128:131], v[20:23], v[68:71], v[128:131]
    v_mfma_f32_16x16x32_bf16 v[176:179], v[24:27], v[68:71], v[176:179]
    v_mfma_f32_16x16x32_bf16 a[240:243], v[28:31], v[68:71], a[240:243]
    v_mfma_f32_16x16x32_bf16 a[192:195], v[32:35], v[68:71], a[192:195]
    v_mfma_f32_16x16x32_bf16 a[144:147], v[36:39], v[68:71], a[144:147]
    ds_read_b64_tr_b16 v[72:73], v2 offset:32
    ds_read_b64_tr_b16 v[74:75], v2 offset:1568
    s_waitcnt lgkmcnt(0)
    v_mfma_f32_16x16x32_bf16 v[84:87], v[16:19], v[72:75], v[84:87]
    v_mfma_f32_16x16x32_bf16 v[132:135], v[20:23], v[72:75], v[132:135]
    v_mfma_f32_16x16x32_bf16 v[180:183], v[24:27], v[72:75], v[180:183]
    v_mfma_f32_16x16x32_bf16 a[244:247], v[28:31], v[72:75], a[244:247]
    v_mfma_f32_16x16x32_bf16 a[196:199], v[32:35], v[72:75], a[196:199]
    v_mfma_f32_16x16x32_bf16 a[148:151], v[36:39], v[72:75], a[148:151]
    ds_read_b64_tr_b16 v[68:69], v2 offset:64
    ds_read_b64_tr_b16 v[70:71], v2 offset:1600
    s_waitcnt lgkmcnt(0)
    v_mfma_f32_16x16x32_bf16 v[88:91], v[16:19], v[68:71], v[88:91]
    v_mfma_f32_16x16x32_bf16 v[136:139], v[20:23], v[68:71], v[136:139]
    v_mfma_f32_16x16x32_bf16 v[184:187], v[24:27], v[68:71], v[184:187]
    v_mfma_f32_16x16x32_bf16 a[248:251], v[28:31], v[68:71], a[248:251]
    v_mfma_f32_16x16x32_bf16 a[200:203], v[32:35], v[68:71], a[200:203]
    v_mfma_f32_16x16x32_bf16 a[152:155], v[36:39], v[68:71], a[152:155]
    ds_read_b64_tr_b16 v[72:73], v2 offset:96
    ds_read_b64_tr_b16 v[74:75], v2 offset:1632
    s_waitcnt lgkmcnt(0)
    v_mfma_f32_16x16x32_bf16 v[92:95], v[16:19], v[72:75], v[92:95]
    v_mfma_f32_16x16x32_bf16 v[140:143], v[20:23], v[72:75], v[140:143]
    v_mfma_f32_16x16x32_bf16 v[188:191], v[24:27], v[72:75], v[188:191]
    v_mfma_f32_16x16x32_bf16 a[252:255], v[28:31], v[72:75], a[252:255]
    v_mfma_f32_16x16x32_bf16 a[204:207], v[32:35], v[72:75], a[204:207]
    v_mfma_f32_16x16x32_bf16 a[156:159], v[36:39], v[72:75], a[156:159]
    ds_read_b64_tr_b16 v[68:69], v2 offset:128
    ds_read_b64_tr_b16 v[70:71], v2 offset:1664
    s_waitcnt lgkmcnt(0)
    v_mfma_f32_16x16x32_bf16 v[96:99], v[16:19], v[68:71], v[96:99]
    v_mfma_f32_16x16x32_bf16 v[144:147], v[20:23], v[68:71], v[144:147]
    v_mfma_f32_16x16x32_bf16 v[192:195], v[24:27], v[68:71], v[192:195]
    v_mfma_f32_16x16x32_bf16 v[224:227], v[28:31], v[68:71], v[224:227]
    v_mfma_f32_16x16x32_bf16 a[208:211], v[32:35], v[68:71], a[208:211]
    v_mfma_f32_16x16x32_bf16 a[160:163], v[36:39], v[68:71], a[160:163]
    ds_read_b64_tr_b16 v[72:73], v2 offset:160
    ds_read_b64_tr_b16 v[74:75], v2 offset:1696
    s_waitcnt lgkmcnt(0)
    v_mfma_f32_16x16x32_bf16 v[100:103], v[16:19], v[72:75], v[100:103]
    v_mfma_f32_16x16x32_bf16 v[148:151], v[20:23], v[72:75], v[148:151]
    v_mfma_f32_16x16x32_bf16 v[196:199], v[24:27], v[72:75], v[196:199]
    v_mfma_f32_16x16x32_bf16 v[228:231], v[28:31], v[72:75], v[228:231]
    v_mfma_f32_16x16x32_bf16 a[212:215], v[32:35], v[72:75], a[212:215]
    v_mfma_f32_16x16x32_bf16 a[164:167], v[36:39], v[72:75], a[164:167]
    ds_read_b64_tr_b16 v[68:69], v2 offset:192
    ds_read_b64_tr_b16 v[70:71], v2 offset:1728
    s_waitcnt lgkmcnt(0)
    v_mfma_f32_16x16x32_bf16 v[104:107], v[16:19], v[68:71], v[104:107]
    v_mfma_f32_16x16x32_bf16 v[152:155], v[20:23], v[68:71], v[152:155]
    v_mfma_f32_16x16x32_bf16 v[200:203], v[24:27], v[68:71], v[200:203]
    v_mfma_f32_16x16x32_bf16 v[232:235], v[28:31], v[68:71], v[232:235]
    v_mfma_f32_16x16x32_bf16 a[216:219], v[32:35], v[68:71], a[216:219]
    v_mfma_f32_16x16x32_bf16 a[168:171], v[36:39], v[68:71], a[168:171]
    ds_read_b64_tr_b16 v[72:73], v2 offset:224
    ds_read_b64_tr_b16 v[74:75], v2 offset:1760
    s_waitcnt lgkmcnt(0)
    v_mfma_f32_16x16x32_bf16 v[108:111], v[16:19], v[72:75], v[108:111]
    v_mfma_f32_16x16x32_bf16 v[156:159], v[20:23], v[72:75], v[156:159]
    v_mfma_f32_16x16x32_bf16 v[204:207], v[24:27], v[72:75], v[204:207]
    v_mfma_f32_16x16x32_bf16 v[236:239], v[28:31], v[72:75], v[236:239]
    v_mfma_f32_16x16x32_bf16 a[220:223], v[32:35], v[72:75], a[220:223]
    v_mfma_f32_16x16x32_bf16 a[172:175], v[36:39], v[72:75], a[172:175]
    ds_read_b64_tr_b16 v[68:69], v2 offset:256
    ds_read_b64_tr_b16 v[70:71], v2 offset:1792
    s_waitcnt lgkmcnt(0)
    v_mfma_f32_16x16x32_bf16 v[112:115], v[16:19], v[68:71], v[112:115]
    v_mfma_f32_16x16x32_bf16 v[160:163], v[20:23], v[68:71], v[160:163]
    v_mfma_f32_16x16x32_bf16 v[208:211], v[24:27], v[68:71], v[208:211]
    v_mfma_f32_16x16x32_bf16 v[240:243], v[28:31], v[68:71], v[240:243]
    v_mfma_f32_16x16x32_bf16 a[224:227], v[32:35], v[68:71], a[224:227]
    v_mfma_f32_16x16x32_bf16 a[176:179], v[36:39], v[68:71], a[176:179]
    ds_read_b64_tr_b16 v[72:73], v2 offset:288
    ds_read_b64_tr_b16 v[74:75], v2 offset:1824
    s_waitcnt lgkmcnt(0)
    v_mfma_f32_16x16x32_bf16 v[116:119], v[16:19], v[72:75], v[116:119]
    v_mfma_f32_16x16x32_bf16 v[164:167], v[20:23], v[72:75], v[164:167]
    v_mfma_f32_16x16x32_bf16 v[212:215], v[24:27], v[72:75], v[212:215]
    v_mfma_f32_16x16x32_bf16 v[244:247], v[28:31], v[72:75], v[244:247]
    v_mfma_f32_16x16x32_bf16 a[228:231], v[32:35], v[72:75], a[228:231]
    v_mfma_f32_16x16x32_bf16 a[180:183], v[36:39], v[72:75], a[180:183]
    ds_read_b64_tr_b16 v[68:69], v2 offset:320
    ds_read_b64_tr_b16 v[70:71], v2 offset:1856
    s_waitcnt lgkmcnt(0)
    v_mfma_f32_16x16x32_bf16 v[120:123], v[16:19], v[68:71], v[120:123]
    v_mfma_f32_16x16x32_bf16 v[168:171], v[20:23], v[68:71], v[168:171]
    v_mfma_f32_16x16x32_bf16 v[216:219], v[24:27], v[68:71], v[216:219]
    v_mfma_f32_16x16x32_bf16 v[248:251], v[28:31], v[68:71], v[248:251]
    v_mfma_f32_16x16x32_bf16 a[232:235], v[32:35], v[68:71], a[232:235]
    v_mfma_f32_16x16x32_bf16 a[184:187], v[36:39], v[68:71], a[184:187]
    ds_read_b64_tr_b16 v[72:73], v2 offset:352
    ds_read_b64_tr_b16 v[74:75], v2 offset:1888
    s_waitcnt lgkmcnt(0)
    v_mfma_f32_16x16x32_bf16 v[124:127], v[16:19], v[72:75], v[124:127]
    v_mfma_f32_16x16x32_bf16 v[172:175], v[20:23], v[72:75], v[172:175]
    v_mfma_f32_16x16x32_bf16 v[220:223], v[24:27], v[72:75], v[220:223]
    v_mfma_f32_16x16x32_bf16 v[252:255], v[28:31], v[72:75], v[252:255]
    v_mfma_f32_16x16x32_bf16 a[236:239], v[32:35], v[72:75], a[236:239]
    v_mfma_f32_16x16x32_bf16 a[188:191], v[36:39], v[72:75], a[188:191]
    s_add_u32 s47, s47, 12288
    s_cmp_lt_u32 s47, 393216
    s_cbranch_scc1 L_slow_main
    v_rcp_f32 v4, v4
    v_rcp_f32 v5, v5
    v_rcp_f32 v6, v6
    v_rcp_f32 v7, v7
    v_rcp_f32 v8, v8
    v_rcp_f32 v9, v9
    v_mbcnt_lo_u32_b32 v10, -1, 0
    v_mbcnt_hi_u32_b32 v10, -1, v10
    v_and_b32 v0, 15, v10
    v_lshlrev_b32 v0, 3, v0
    v_and_b32 v10, 48, v10
    v_mad_u32_u24 v0, v10, 40, v0
    v_add_u32 v0, s46, v0
    ds_bpermute_b32 v11, v10, v4 offset:0
    ds_bpermute_b32 v3, v10, v4 offset:4
    s_waitcnt lgkmcnt(1)
    v_mul_f32 v80, v11, v80
    s_waitcnt lgkmcnt(0)
    v_mul_f32 v81, v3, v81
    v_mul_f32 v84, v11, v84
    v_mul_f32 v85, v3, v85
    v_mul_f32 v88, v11, v88
    v_mul_f32 v89, v3, v89
    v_mul_f32 v92, v11, v92
    v_mul_f32 v93, v3, v93
    v_cvt_pk_bf16_f32 v80, v80, v84
    v_cvt_pk_bf16_f32 v84, v81, v85
    v_cvt_pk_bf16_f32 v81, v88, v92
    v_cvt_pk_bf16_f32 v85, v89, v93
    ds_write_b64 v0, v[80:81] offset:0
    ds_write_b64 v0, v[84:85] offset:160
    v_mul_f32 v96, v11, v96
    v_mul_f32 v97, v3, v97
    v_mul_f32 v100, v11, v100
    v_mul_f32 v101, v3, v101
    v_mul_f32 v104, v11, v104
    v_mul_f32 v105, v3, v105
    v_mul_f32 v108, v11, v108
    v_mul_f32 v109, v3, v109
    v_cvt_pk_bf16_f32 v96, v96, v100
    v_cvt_pk_bf16_f32 v100, v97, v101
    v_cvt_pk_bf16_f32 v97, v104, v108
    v_cvt_pk_bf16_f32 v101, v105, v109
    ds_write_b64 v0, v[96:97] offset:2560
    ds_write_b64 v0, v[100:101] offset:2720
    v_mul_f32 v112, v11, v112
    v_mul_f32 v113, v3, v113
    v_mul_f32 v116, v11, v116
    v_mul_f32 v117, v3, v117
    v_mul_f32 v120, v11, v120
    v_mul_f32 v121, v3, v121
    v_mul_f32 v124, v11, v124
    v_mul_f32 v125, v3, v125
    v_cvt_pk_bf16_f32 v112, v112, v116
    v_cvt_pk_bf16_f32 v116, v113, v117
    v_cvt_pk_bf16_f32 v113, v120, v124
    v_cvt_pk_bf16_f32 v117, v121, v125
    ds_write_b64 v0, v[112:113] offset:5120
    ds_write_b64 v0, v[116:117] offset:5280
    ds_bpermute_b32 v120, v10, v4 offset:8
    ds_bpermute_b32 v121, v10, v4 offset:12
    v_mbcnt_lo_u32_b32 v92, -1, 0
    v_mbcnt_hi_u32_b32 v92, -1, v92
    v_bfe_u32 v88, v92, 4, 1
    v_lshrrev_b32 v93, 5, v92
    v_lshl_add_u32 v88, v88, 1, v93
    v_bfe_u32 v93, v92, 3, 1
    v_lshl_add_u32 v93, v88, 1, v93
    v_mul_u32_u24 v89, 384, v93
    v_and_b32 v93, 3, v92
    v_lshl_add_u32 v89, v93, 5, v89
    v_bfe_u32 v93, v92, 2, 1
    v_lshl_add_u32 v89, v93, 4, v89
    v_bfe_u32 v93, v92, 1, 1
    v_lshl_add_u32 v88, v88, 1, v93
    v_mul_u32_u24 v88, 160, v88
    v_and_b32 v93, 1, v92
    v_lshl_add_u32 v88, v93, 6, v88
    v_bfe_u32 v93, v92, 2, 2
    v_lshl_add_u32 v88, v93, 3, v88
    v_add_u32 v88, s46, v88
    s_waitcnt lgkmcnt(1)
    v_mul_f32 v82, v120, v82
    s_waitcnt lgkmcnt(0)
    v_mul_f32 v83, v121, v83
    v_mul_f32 v86, v120, v86
    v_mul_f32 v87, v121, v87
    v_mul_f32 v90, v120, v90
    v_mul_f32 v91, v121, v91
    v_mul_f32 v94, v120, v94
    v_mul_f32 v95, v121, v95
    v_cvt_pk_bf16_f32 v82, v82, v86
    v_cvt_pk_bf16_f32 v86, v83, v87
    v_cvt_pk_bf16_f32 v83, v90, v94
    v_cvt_pk_bf16_f32 v87, v91, v95
    ds_write_b64 v0, v[82:83] offset:320
    ds_write_b64 v0, v[86:87] offset:480
    ds_read_b64_tr_b16 v[80:81], v88 offset:0
    ds_read_b64_tr_b16 v[82:83], v88 offset:32
    ds_read_b64_tr_b16 v[84:85], v88 offset:1280
    ds_read_b64_tr_b16 v[86:87], v88 offset:1312
    v_mul_f32 v98, v120, v98
    v_mul_f32 v99, v121, v99
    v_mul_f32 v102, v120, v102
    v_mul_f32 v103, v121, v103
    v_mul_f32 v106, v120, v106
    v_mul_f32 v107, v121, v107
    v_mul_f32 v110, v120, v110
    v_mul_f32 v111, v121, v111
    s_waitcnt lgkmcnt(2)
    buffer_store_dwordx4 v[80:83], v89, s[24:27], s72 offen offset:0 sc0 sc1
    s_waitcnt lgkmcnt(0)
    buffer_store_dwordx4 v[84:87], v89, s[24:27], s72 offen offset:3072 sc0 sc1
    v_cvt_pk_bf16_f32 v98, v98, v102
    v_cvt_pk_bf16_f32 v102, v99, v103
    v_cvt_pk_bf16_f32 v99, v106, v110
    v_cvt_pk_bf16_f32 v103, v107, v111
    ds_write_b64 v0, v[98:99] offset:2880
    ds_write_b64 v0, v[102:103] offset:3040
    ds_read_b64_tr_b16 v[96:97], v88 offset:2560
    ds_read_b64_tr_b16 v[98:99], v88 offset:2592
    ds_read_b64_tr_b16 v[100:101], v88 offset:3840
    ds_read_b64_tr_b16 v[102:103], v88 offset:3872
    v_mul_f32 v114, v120, v114
    v_mul_f32 v115, v121, v115
    v_mul_f32 v118, v120, v118
    v_mul_f32 v119, v121, v119
    v_mul_f32 v122, v120, v122
    v_mul_f32 v123, v121, v123
    v_mul_f32 v126, v120, v126
    v_mul_f32 v127, v121, v127
    s_waitcnt lgkmcnt(2)
    buffer_store_dwordx4 v[96:99], v89, s[24:27], s72 offen offset:128 sc0 sc1
    s_waitcnt lgkmcnt(0)
    buffer_store_dwordx4 v[100:103], v89, s[24:27], s72 offen offset:3200 sc0 sc1
    ds_bpermute_b32 v104, v10, v5 offset:0
    ds_bpermute_b32 v105, v10, v5 offset:4
    ds_bpermute_b32 v106, v10, v5 offset:8
    ds_bpermute_b32 v107, v10, v5 offset:12
    v_cvt_pk_bf16_f32 v114, v114, v118
    v_cvt_pk_bf16_f32 v118, v115, v119
    v_cvt_pk_bf16_f32 v115, v122, v126
    v_cvt_pk_bf16_f32 v119, v123, v127
    ds_write_b64 v0, v[114:115] offset:5440
    ds_write_b64 v0, v[118:119] offset:5600
    ds_read_b64_tr_b16 v[112:113], v88 offset:5120
    ds_read_b64_tr_b16 v[114:115], v88 offset:5152
    ds_read_b64_tr_b16 v[116:117], v88 offset:6400
    ds_read_b64_tr_b16 v[118:119], v88 offset:6432
    s_waitcnt lgkmcnt(9)
    v_mul_f32 v128, v104, v128
    s_waitcnt lgkmcnt(8)
    v_mul_f32 v129, v105, v129
    v_mul_f32 v132, v104, v132
    v_mul_f32 v133, v105, v133
    v_mul_f32 v136, v104, v136
    v_mul_f32 v137, v105, v137
    v_mul_f32 v140, v104, v140
    v_mul_f32 v141, v105, v141
    s_waitcnt lgkmcnt(2)
    buffer_store_dwordx4 v[112:115], v89, s[24:27], s72 offen offset:256 sc0 sc1
    s_waitcnt lgkmcnt(0)
    buffer_store_dwordx4 v[116:119], v89, s[24:27], s72 offen offset:3328 sc0 sc1
    v_cvt_pk_bf16_f32 v128, v128, v132
    v_cvt_pk_bf16_f32 v132, v129, v133
    v_cvt_pk_bf16_f32 v129, v136, v140
    v_cvt_pk_bf16_f32 v133, v137, v141
    ds_write_b64 v0, v[128:129] offset:7680
    ds_write_b64 v0, v[132:133] offset:7840
    v_mul_f32 v130, v106, v130
    v_mul_f32 v131, v107, v131
    v_mul_f32 v134, v106, v134
    v_mul_f32 v135, v107, v135
    v_mul_f32 v138, v106, v138
    v_mul_f32 v139, v107, v139
    v_mul_f32 v142, v106, v142
    v_mul_f32 v143, v107, v143
    v_cvt_pk_bf16_f32 v130, v130, v134
    v_cvt_pk_bf16_f32 v134, v131, v135
    v_cvt_pk_bf16_f32 v131, v138, v142
    v_cvt_pk_bf16_f32 v135, v139, v143
    ds_write_b64 v0, v[130:131] offset:8000
    ds_write_b64 v0, v[134:135] offset:8160
    ds_read_b64_tr_b16 v[128:129], v88 offset:7680
    ds_read_b64_tr_b16 v[130:131], v88 offset:7712
    ds_read_b64_tr_b16 v[132:133], v88 offset:8960
    ds_read_b64_tr_b16 v[134:135], v88 offset:8992
    v_mul_f32 v144, v104, v144
    v_mul_f32 v145, v105, v145
    v_mul_f32 v148, v104, v148
    v_mul_f32 v149, v105, v149
    v_mul_f32 v152, v104, v152
    v_mul_f32 v153, v105, v153
    v_mul_f32 v156, v104, v156
    v_mul_f32 v157, v105, v157
    s_waitcnt lgkmcnt(2)
    buffer_store_dwordx4 v[128:131], v89, s[24:27], s73 offen offset:0 sc0 sc1
    s_waitcnt lgkmcnt(0)
    buffer_store_dwordx4 v[132:135], v89, s[24:27], s73 offen offset:3072 sc0 sc1
    v_cvt_pk_bf16_f32 v144, v144, v148
    v_cvt_pk_bf16_f32 v148, v145, v149
    v_cvt_pk_bf16_f32 v145, v152, v156
    v_cvt_pk_bf16_f32 v149, v153, v157
    ds_write_b64 v0, v[144:145] offset:10240
    ds_write_b64 v0, v[148:149] offset:10400
    v_mul_f32 v146, v106, v146
    v_mul_f32 v147, v107, v147
    v_mul_f32 v150, v106, v150
    v_mul_f32 v151, v107, v151
    v_mul_f32 v154, v106, v154
    v_mul_f32 v155, v107, v155
    v_mul_f32 v158, v106, v158
    v_mul_f32 v159, v107, v159
    v_cvt_pk_bf16_f32 v146, v146, v150
    v_cvt_pk_bf16_f32 v150, v147, v151
    v_cvt_pk_bf16_f32 v147, v154, v158
    v_cvt_pk_bf16_f32 v151, v155, v159
    ds_write_b64 v0, v[146:147] offset:10560
    ds_write_b64 v0, v[150:151] offset:10720
    ds_read_b64_tr_b16 v[144:145], v88 offset:10240
    ds_read_b64_tr_b16 v[146:147], v88 offset:10272
    ds_read_b64_tr_b16 v[148:149], v88 offset:11520
    ds_read_b64_tr_b16 v[150:151], v88 offset:11552
    v_mul_f32 v160, v104, v160
    v_mul_f32 v161, v105, v161
    v_mul_f32 v164, v104, v164
    v_mul_f32 v165, v105, v165
    v_mul_f32 v168, v104, v168
    v_mul_f32 v169, v105, v169
    v_mul_f32 v172, v104, v172
    v_mul_f32 v173, v105, v173
    s_waitcnt lgkmcnt(2)
    buffer_store_dwordx4 v[144:147], v89, s[24:27], s73 offen offset:128 sc0 sc1
    s_waitcnt lgkmcnt(0)
    buffer_store_dwordx4 v[148:151], v89, s[24:27], s73 offen offset:3200 sc0 sc1
    ds_bpermute_b32 v120, v10, v6 offset:0
    ds_bpermute_b32 v121, v10, v6 offset:4
    ds_bpermute_b32 v122, v10, v6 offset:8
    ds_bpermute_b32 v123, v10, v6 offset:12
    v_cvt_pk_bf16_f32 v160, v160, v164
    v_cvt_pk_bf16_f32 v164, v161, v165
    v_cvt_pk_bf16_f32 v161, v168, v172
    v_cvt_pk_bf16_f32 v165, v169, v173
    ds_write_b64 v0, v[160:161] offset:12800
    ds_write_b64 v0, v[164:165] offset:12960
    v_mul_f32 v162, v106, v162
    v_mul_f32 v163, v107, v163
    v_mul_f32 v166, v106, v166
    v_mul_f32 v167, v107, v167
    v_mul_f32 v170, v106, v170
    v_mul_f32 v171, v107, v171
    v_mul_f32 v174, v106, v174
    v_mul_f32 v175, v107, v175
    v_cvt_pk_bf16_f32 v162, v162, v166
    v_cvt_pk_bf16_f32 v166, v163, v167
    v_cvt_pk_bf16_f32 v163, v170, v174
    v_cvt_pk_bf16_f32 v167, v171, v175
    ds_write_b64 v0, v[162:163] offset:13120
    ds_write_b64 v0, v[166:167] offset:13280
    ds_read_b64_tr_b16 v[160:161], v88 offset:12800
    ds_read_b64_tr_b16 v[162:163], v88 offset:12832
    ds_read_b64_tr_b16 v[164:165], v88 offset:14080
    ds_read_b64_tr_b16 v[166:167], v88 offset:14112
    s_waitcnt lgkmcnt(11)
    v_mul_f32 v176, v120, v176
    s_waitcnt lgkmcnt(10)
    v_mul_f32 v177, v121, v177
    v_mul_f32 v180, v120, v180
    v_mul_f32 v181, v121, v181
    v_mul_f32 v184, v120, v184
    v_mul_f32 v185, v121, v185
    v_mul_f32 v188, v120, v188
    v_mul_f32 v189, v121, v189
    s_waitcnt lgkmcnt(2)
    buffer_store_dwordx4 v[160:163], v89, s[24:27], s73 offen offset:256 sc0 sc1
    s_waitcnt lgkmcnt(0)
    buffer_store_dwordx4 v[164:167], v89, s[24:27], s73 offen offset:3328 sc0 sc1
    v_cvt_pk_bf16_f32 v176, v176, v180
    v_cvt_pk_bf16_f32 v180, v177, v181
    v_cvt_pk_bf16_f32 v177, v184, v188
    v_cvt_pk_bf16_f32 v181, v185, v189
    ds_write_b64 v0, v[176:177] offset:0
    ds_write_b64 v0, v[180:181] offset:160
    v_mul_f32 v178, v122, v178
    v_mul_f32 v179, v123, v179
    v_mul_f32 v182, v122, v182
    v_mul_f32 v183, v123, v183
    v_mul_f32 v186, v122, v186
    v_mul_f32 v187, v123, v187
    v_mul_f32 v190, v122, v190
    v_mul_f32 v191, v123, v191
    v_cvt_pk_bf16_f32 v178, v178, v182
    v_cvt_pk_bf16_f32 v182, v179, v183
    v_cvt_pk_bf16_f32 v179, v186, v190
    v_cvt_pk_bf16_f32 v183, v187, v191
    ds_write_b64 v0, v[178:179] offset:320
    ds_write_b64 v0, v[182:183] offset:480
    ds_read_b64_tr_b16 v[80:81], v88 offset:0
    ds_read_b64_tr_b16 v[82:83], v88 offset:32
    ds_read_b64_tr_b16 v[84:85], v88 offset:1280
    ds_read_b64_tr_b16 v[86:87], v88 offset:1312
    v_mul_f32 v192, v120, v192
    v_mul_f32 v193, v121, v193
    v_mul_f32 v196, v120, v196
    v_mul_f32 v197, v121, v197
    v_mul_f32 v200, v120, v200
    v_mul_f32 v201, v121, v201
    v_mul_f32 v204, v120, v204
    v_mul_f32 v205, v121, v205
    s_waitcnt lgkmcnt(2)
    buffer_store_dwordx4 v[80:83], v89, s[24:27], s74 offen offset:0 sc0 sc1
    s_waitcnt lgkmcnt(0)
    buffer_store_dwordx4 v[84:87], v89, s[24:27], s74 offen offset:3072 sc0 sc1
    v_cvt_pk_bf16_f32 v192, v192, v196
    v_cvt_pk_bf16_f32 v196, v193, v197
    v_cvt_pk_bf16_f32 v193, v200, v204
    v_cvt_pk_bf16_f32 v197, v201, v205
    ds_write_b64 v0, v[192:193] offset:2560
    ds_write_b64 v0, v[196:197] offset:2720
    v_mul_f32 v194, v122, v194
    v_mul_f32 v195, v123, v195
    v_mul_f32 v198, v122, v198
    v_mul_f32 v199, v123, v199
    v_mul_f32 v202, v122, v202
    v_mul_f32 v203, v123, v203
    v_mul_f32 v206, v122, v206
    v_mul_f32 v207, v123, v207
    v_cvt_pk_bf16_f32 v194, v194, v198
    v_cvt_pk_bf16_f32 v198, v195, v199
    v_cvt_pk_bf16_f32 v195, v202, v206
    v_cvt_pk_bf16_f32 v199, v203, v207
    ds_write_b64 v0, v[194:195] offset:2880
    ds_write_b64 v0, v[198:199] offset:3040
    ds_read_b64_tr_b16 v[96:97], v88 offset:2560
    ds_read_b64_tr_b16 v[98:99], v88 offset:2592
    ds_read_b64_tr_b16 v[100:101], v88 offset:3840
    ds_read_b64_tr_b16 v[102:103], v88 offset:3872
    v_mul_f32 v208, v120, v208
    v_mul_f32 v209, v121, v209
    v_mul_f32 v212, v120, v212
    v_mul_f32 v213, v121, v213
    v_mul_f32 v216, v120, v216
    v_mul_f32 v217, v121, v217
    v_mul_f32 v220, v120, v220
    v_mul_f32 v221, v121, v221
    s_waitcnt lgkmcnt(2)
    buffer_store_dwordx4 v[96:99], v89, s[24:27], s74 offen offset:128 sc0 sc1
    s_waitcnt lgkmcnt(0)
    buffer_store_dwordx4 v[100:103], v89, s[24:27], s74 offen offset:3200 sc0 sc1
    ds_bpermute_b32 v104, v10, v7 offset:0
    ds_bpermute_b32 v105, v10, v7 offset:4
    ds_bpermute_b32 v106, v10, v7 offset:8
    ds_bpermute_b32 v107, v10, v7 offset:12
    v_cvt_pk_bf16_f32 v208, v208, v212
    v_cvt_pk_bf16_f32 v212, v209, v213
    v_cvt_pk_bf16_f32 v209, v216, v220
    v_cvt_pk_bf16_f32 v213, v217, v221
    ds_write_b64 v0, v[208:209] offset:5120
    ds_write_b64 v0, v[212:213] offset:5280
    v_mul_f32 v210, v122, v210
    v_mul_f32 v211, v123, v211
    v_mul_f32 v214, v122, v214
    v_mul_f32 v215, v123, v215
    v_mul_f32 v218, v122, v218
    v_mul_f32 v219, v123, v219
    v_mul_f32 v222, v122, v222
    v_mul_f32 v223, v123, v223
    v_cvt_pk_bf16_f32 v210, v210, v214
    v_cvt_pk_bf16_f32 v214, v211, v215
    v_cvt_pk_bf16_f32 v211, v218, v222
    v_cvt_pk_bf16_f32 v215, v219, v223
    ds_write_b64 v0, v[210:211] offset:5440
    ds_write_b64 v0, v[214:215] offset:5600
    ds_read_b64_tr_b16 v[112:113], v88 offset:5120
    ds_read_b64_tr_b16 v[114:115], v88 offset:5152
    ds_read_b64_tr_b16 v[116:117], v88 offset:6400
    ds_read_b64_tr_b16 v[118:119], v88 offset:6432
    s_waitcnt lgkmcnt(11)
    v_mul_f32 v224, v104, v224
    s_waitcnt lgkmcnt(10)
    v_mul_f32 v225, v105, v225
    v_mul_f32 v228, v104, v228
    v_mul_f32 v229, v105, v229
    v_mul_f32 v232, v104, v232
    v_mul_f32 v233, v105, v233
    v_mul_f32 v236, v104, v236
    v_mul_f32 v237, v105, v237
    s_waitcnt lgkmcnt(2)
    buffer_store_dwordx4 v[112:115], v89, s[24:27], s74 offen offset:256 sc0 sc1
    s_waitcnt lgkmcnt(0)
    buffer_store_dwordx4 v[116:119], v89, s[24:27], s74 offen offset:3328 sc0 sc1
    v_cvt_pk_bf16_f32 v224, v224, v228
    v_cvt_pk_bf16_f32 v228, v225, v229
    v_cvt_pk_bf16_f32 v225, v232, v236
    v_cvt_pk_bf16_f32 v229, v233, v237
    ds_write_b64 v0, v[224:225] offset:10240
    ds_write_b64 v0, v[228:229] offset:10400
    v_mul_f32 v226, v106, v226
    v_mul_f32 v227, v107, v227
    v_mul_f32 v230, v106, v230
    v_mul_f32 v231, v107, v231
    v_mul_f32 v234, v106, v234
    v_mul_f32 v235, v107, v235
    v_mul_f32 v238, v106, v238
    v_mul_f32 v239, v107, v239
    v_cvt_pk_bf16_f32 v226, v226, v230
    v_cvt_pk_bf16_f32 v230, v227, v231
    v_cvt_pk_bf16_f32 v227, v234, v238
    v_cvt_pk_bf16_f32 v231, v235, v239
    ds_write_b64 v0, v[226:227] offset:10560
    ds_write_b64 v0, v[230:231] offset:10720
    ds_read_b64_tr_b16 v[144:145], v88 offset:10240
    ds_read_b64_tr_b16 v[146:147], v88 offset:10272
    ds_read_b64_tr_b16 v[148:149], v88 offset:11520
    ds_read_b64_tr_b16 v[150:151], v88 offset:11552
    v_mul_f32 v240, v104, v240
    v_mul_f32 v241, v105, v241
    v_mul_f32 v244, v104, v244
    v_mul_f32 v245, v105, v245
    v_mul_f32 v248, v104, v248
    v_mul_f32 v249, v105, v249
    v_mul_f32 v252, v104, v252
    v_mul_f32 v253, v105, v253
    s_waitcnt lgkmcnt(2)
    buffer_store_dwordx4 v[144:147], v89, s[24:27], s75 offen offset:128 nt
    s_waitcnt lgkmcnt(0)
    buffer_store_dwordx4 v[148:151], v89, s[24:27], s75 offen offset:3200 nt
    v_cvt_pk_bf16_f32 v240, v240, v244
    v_cvt_pk_bf16_f32 v244, v241, v245
    v_cvt_pk_bf16_f32 v241, v248, v252
    v_cvt_pk_bf16_f32 v245, v249, v253
    ds_write_b64 v0, v[240:241] offset:12800
    ds_write_b64 v0, v[244:245] offset:12960
    v_mul_f32 v242, v106, v242
    v_mul_f32 v243, v107, v243
    v_mul_f32 v246, v106, v246
    v_mul_f32 v247, v107, v247
    v_mul_f32 v250, v106, v250
    v_mul_f32 v251, v107, v251
    v_mul_f32 v254, v106, v254
    v_mul_f32 v255, v107, v255
    v_cvt_pk_bf16_f32 v242, v242, v246
    v_cvt_pk_bf16_f32 v246, v243, v247
    v_cvt_pk_bf16_f32 v243, v250, v254
    v_cvt_pk_bf16_f32 v247, v251, v255
    ds_write_b64 v0, v[242:243] offset:13120
    ds_write_b64 v0, v[246:247] offset:13280
    ds_read_b64_tr_b16 v[160:161], v88 offset:12800
    ds_read_b64_tr_b16 v[162:163], v88 offset:12832
    ds_read_b64_tr_b16 v[164:165], v88 offset:14080
    ds_read_b64_tr_b16 v[166:167], v88 offset:14112
    v_accvgpr_read_b32 v192, a240
    v_accvgpr_read_b32 v193, a241
    v_accvgpr_read_b32 v196, a244
    v_accvgpr_read_b32 v197, a245
    v_accvgpr_read_b32 v200, a248
    v_accvgpr_read_b32 v201, a249
    v_accvgpr_read_b32 v204, a252
    v_accvgpr_read_b32 v205, a253
    v_mul_f32 v192, v104, v192
    v_mul_f32 v193, v105, v193
    v_mul_f32 v196, v104, v196
    v_mul_f32 v197, v105, v197
    v_mul_f32 v200, v104, v200
    v_mul_f32 v201, v105, v201
    v_mul_f32 v204, v104, v204
    v_mul_f32 v205, v105, v205
    s_waitcnt lgkmcnt(2)
    buffer_store_dwordx4 v[160:163], v89, s[24:27], s75 offen offset:256 nt
    s_waitcnt lgkmcnt(0)
    buffer_store_dwordx4 v[164:167], v89, s[24:27], s75 offen offset:3328 nt
    ds_bpermute_b32 v120, v10, v8 offset:0
    ds_bpermute_b32 v121, v10, v8 offset:4
    ds_bpermute_b32 v122, v10, v8 offset:8
    ds_bpermute_b32 v123, v10, v8 offset:12
    v_cvt_pk_bf16_f32 v192, v192, v196
    v_cvt_pk_bf16_f32 v196, v193, v197
    v_cvt_pk_bf16_f32 v193, v200, v204
    v_cvt_pk_bf16_f32 v197, v201, v205
    ds_write_b64 v0, v[192:193] offset:7680
    ds_write_b64 v0, v[196:197] offset:7840
    v_accvgpr_read_b32 v194, a242
    v_accvgpr_read_b32 v195, a243
    v_accvgpr_read_b32 v198, a246
    v_accvgpr_read_b32 v199, a247
    v_accvgpr_read_b32 v202, a250
    v_accvgpr_read_b32 v203, a251
    v_accvgpr_read_b32 v206, a254
    v_accvgpr_read_b32 v207, a255
    v_mul_f32 v194, v106, v194
    v_mul_f32 v195, v107, v195
    v_mul_f32 v198, v106, v198
    v_mul_f32 v199, v107, v199
    v_mul_f32 v202, v106, v202
    v_mul_f32 v203, v107, v203
    v_mul_f32 v206, v106, v206
    v_mul_f32 v207, v107, v207
    v_cvt_pk_bf16_f32 v194, v194, v198
    v_cvt_pk_bf16_f32 v198, v195, v199
    v_cvt_pk_bf16_f32 v195, v202, v206
    v_cvt_pk_bf16_f32 v199, v203, v207
    ds_write_b64 v0, v[194:195] offset:8000
    ds_write_b64 v0, v[198:199] offset:8160
    ds_read_b64_tr_b16 v[128:129], v88 offset:7680
    ds_read_b64_tr_b16 v[130:131], v88 offset:7712
    ds_read_b64_tr_b16 v[132:133], v88 offset:8960
    ds_read_b64_tr_b16 v[134:135], v88 offset:8992
    v_accvgpr_read_b32 v176, a192
    v_accvgpr_read_b32 v177, a193
    v_accvgpr_read_b32 v180, a196
    v_accvgpr_read_b32 v181, a197
    v_accvgpr_read_b32 v184, a200
    v_accvgpr_read_b32 v185, a201
    v_accvgpr_read_b32 v188, a204
    v_accvgpr_read_b32 v189, a205
    s_waitcnt lgkmcnt(11)
    v_mul_f32 v176, v120, v176
    s_waitcnt lgkmcnt(10)
    v_mul_f32 v177, v121, v177
    v_mul_f32 v180, v120, v180
    v_mul_f32 v181, v121, v181
    v_mul_f32 v184, v120, v184
    v_mul_f32 v185, v121, v185
    v_mul_f32 v188, v120, v188
    v_mul_f32 v189, v121, v189
    s_waitcnt lgkmcnt(2)
    buffer_store_dwordx4 v[128:131], v89, s[24:27], s75 offen offset:0 nt
    s_waitcnt lgkmcnt(0)
    buffer_store_dwordx4 v[132:135], v89, s[24:27], s75 offen offset:3072 nt
    v_cvt_pk_bf16_f32 v176, v176, v180
    v_cvt_pk_bf16_f32 v180, v177, v181
    v_cvt_pk_bf16_f32 v177, v184, v188
    v_cvt_pk_bf16_f32 v181, v185, v189
    ds_write_b64 v0, v[176:177] offset:0
    ds_write_b64 v0, v[180:181] offset:160
    v_accvgpr_read_b32 v178, a194
    v_accvgpr_read_b32 v179, a195
    v_accvgpr_read_b32 v182, a198
    v_accvgpr_read_b32 v183, a199
    v_accvgpr_read_b32 v186, a202
    v_accvgpr_read_b32 v187, a203
    v_accvgpr_read_b32 v190, a206
    v_accvgpr_read_b32 v191, a207
    v_mul_f32 v178, v122, v178
    v_mul_f32 v179, v123, v179
    v_mul_f32 v182, v122, v182
    v_mul_f32 v183, v123, v183
    v_mul_f32 v186, v122, v186
    v_mul_f32 v187, v123, v187
    v_mul_f32 v190, v122, v190
    v_mul_f32 v191, v123, v191
    v_cvt_pk_bf16_f32 v178, v178, v182
    v_cvt_pk_bf16_f32 v182, v179, v183
    v_cvt_pk_bf16_f32 v179, v186, v190
    v_cvt_pk_bf16_f32 v183, v187, v191
    ds_write_b64 v0, v[178:179] offset:320
    ds_write_b64 v0, v[182:183] offset:480
    ds_read_b64_tr_b16 v[80:81], v88 offset:0
    ds_read_b64_tr_b16 v[82:83], v88 offset:32
    ds_read_b64_tr_b16 v[84:85], v88 offset:1280
    ds_read_b64_tr_b16 v[86:87], v88 offset:1312
    v_accvgpr_read_b32 v192, a208
    v_accvgpr_read_b32 v193, a209
    v_accvgpr_read_b32 v196, a212
    v_accvgpr_read_b32 v197, a213
    v_accvgpr_read_b32 v200, a216
    v_accvgpr_read_b32 v201, a217
    v_accvgpr_read_b32 v204, a220
    v_accvgpr_read_b32 v205, a221
    v_mul_f32 v192, v120, v192
    v_mul_f32 v193, v121, v193
    v_mul_f32 v196, v120, v196
    v_mul_f32 v197, v121, v197
    v_mul_f32 v200, v120, v200
    v_mul_f32 v201, v121, v201
    v_mul_f32 v204, v120, v204
    v_mul_f32 v205, v121, v205
    s_waitcnt lgkmcnt(2)
    buffer_store_dwordx4 v[80:83], v89, s[24:27], s76 offen offset:0 nt
    s_waitcnt lgkmcnt(0)
    buffer_store_dwordx4 v[84:87], v89, s[24:27], s76 offen offset:3072 nt
    v_cvt_pk_bf16_f32 v192, v192, v196
    v_cvt_pk_bf16_f32 v196, v193, v197
    v_cvt_pk_bf16_f32 v193, v200, v204
    v_cvt_pk_bf16_f32 v197, v201, v205
    ds_write_b64 v0, v[192:193] offset:2560
    ds_write_b64 v0, v[196:197] offset:2720
    v_accvgpr_read_b32 v194, a210
    v_accvgpr_read_b32 v195, a211
    v_accvgpr_read_b32 v198, a214
    v_accvgpr_read_b32 v199, a215
    v_accvgpr_read_b32 v202, a218
    v_accvgpr_read_b32 v203, a219
    v_accvgpr_read_b32 v206, a222
    v_accvgpr_read_b32 v207, a223
    v_mul_f32 v194, v122, v194
    v_mul_f32 v195, v123, v195
    v_mul_f32 v198, v122, v198
    v_mul_f32 v199, v123, v199
    v_mul_f32 v202, v122, v202
    v_mul_f32 v203, v123, v203
    v_mul_f32 v206, v122, v206
    v_mul_f32 v207, v123, v207
    v_cvt_pk_bf16_f32 v194, v194, v198
    v_cvt_pk_bf16_f32 v198, v195, v199
    v_cvt_pk_bf16_f32 v195, v202, v206
    v_cvt_pk_bf16_f32 v199, v203, v207
    ds_write_b64 v0, v[194:195] offset:2880
    ds_write_b64 v0, v[198:199] offset:3040
    ds_read_b64_tr_b16 v[96:97], v88 offset:2560
    ds_read_b64_tr_b16 v[98:99], v88 offset:2592
    ds_read_b64_tr_b16 v[100:101], v88 offset:3840
    ds_read_b64_tr_b16 v[102:103], v88 offset:3872
    v_accvgpr_read_b32 v176, a224
    v_accvgpr_read_b32 v177, a225
    v_accvgpr_read_b32 v180, a228
    v_accvgpr_read_b32 v181, a229
    v_accvgpr_read_b32 v184, a232
    v_accvgpr_read_b32 v185, a233
    v_accvgpr_read_b32 v188, a236
    v_accvgpr_read_b32 v189, a237
    v_mul_f32 v176, v120, v176
    v_mul_f32 v177, v121, v177
    v_mul_f32 v180, v120, v180
    v_mul_f32 v181, v121, v181
    v_mul_f32 v184, v120, v184
    v_mul_f32 v185, v121, v185
    v_mul_f32 v188, v120, v188
    v_mul_f32 v189, v121, v189
    s_waitcnt lgkmcnt(2)
    buffer_store_dwordx4 v[96:99], v89, s[24:27], s76 offen offset:128 nt
    s_waitcnt lgkmcnt(0)
    buffer_store_dwordx4 v[100:103], v89, s[24:27], s76 offen offset:3200 nt
    ds_bpermute_b32 v104, v10, v9 offset:0
    ds_bpermute_b32 v105, v10, v9 offset:4
    ds_bpermute_b32 v106, v10, v9 offset:8
    ds_bpermute_b32 v107, v10, v9 offset:12
    v_cvt_pk_bf16_f32 v176, v176, v180
    v_cvt_pk_bf16_f32 v180, v177, v181
    v_cvt_pk_bf16_f32 v177, v184, v188
    v_cvt_pk_bf16_f32 v181, v185, v189
    ds_write_b64 v0, v[176:177] offset:5120
    ds_write_b64 v0, v[180:181] offset:5280
    v_accvgpr_read_b32 v178, a226
    v_accvgpr_read_b32 v179, a227
    v_accvgpr_read_b32 v182, a230
    v_accvgpr_read_b32 v183, a231
    v_accvgpr_read_b32 v186, a234
    v_accvgpr_read_b32 v187, a235
    v_accvgpr_read_b32 v190, a238
    v_accvgpr_read_b32 v191, a239
    v_mul_f32 v178, v122, v178
    v_mul_f32 v179, v123, v179
    v_mul_f32 v182, v122, v182
    v_mul_f32 v183, v123, v183
    v_mul_f32 v186, v122, v186
    v_mul_f32 v187, v123, v187
    v_mul_f32 v190, v122, v190
    v_mul_f32 v191, v123, v191
    v_cvt_pk_bf16_f32 v178, v178, v182
    v_cvt_pk_bf16_f32 v182, v179, v183
    v_cvt_pk_bf16_f32 v179, v186, v190
    v_cvt_pk_bf16_f32 v183, v187, v191
    ds_write_b64 v0, v[178:179] offset:5440
    ds_write_b64 v0, v[182:183] offset:5600
    ds_read_b64_tr_b16 v[112:113], v88 offset:5120
    ds_read_b64_tr_b16 v[114:115], v88 offset:5152
    ds_read_b64_tr_b16 v[116:117], v88 offset:6400
    ds_read_b64_tr_b16 v[118:119], v88 offset:6432
    v_accvgpr_read_b32 v192, a144
    v_accvgpr_read_b32 v193, a145
    v_accvgpr_read_b32 v196, a148
    v_accvgpr_read_b32 v197, a149
    v_accvgpr_read_b32 v200, a152
    v_accvgpr_read_b32 v201, a153
    v_accvgpr_read_b32 v204, a156
    v_accvgpr_read_b32 v205, a157
    s_waitcnt lgkmcnt(11)
    v_mul_f32 v192, v104, v192
    s_waitcnt lgkmcnt(10)
    v_mul_f32 v193, v105, v193
    v_mul_f32 v196, v104, v196
    v_mul_f32 v197, v105, v197
    v_mul_f32 v200, v104, v200
    v_mul_f32 v201, v105, v201
    v_mul_f32 v204, v104, v204
    v_mul_f32 v205, v105, v205
    s_waitcnt lgkmcnt(2)
    buffer_store_dwordx4 v[112:115], v89, s[24:27], s76 offen offset:256 nt
    s_waitcnt lgkmcnt(0)
    buffer_store_dwordx4 v[116:119], v89, s[24:27], s76 offen offset:3328 nt
    v_cvt_pk_bf16_f32 v192, v192, v196
    v_cvt_pk_bf16_f32 v196, v193, v197
    v_cvt_pk_bf16_f32 v193, v200, v204
    v_cvt_pk_bf16_f32 v197, v201, v205
    ds_write_b64 v0, v[192:193] offset:7680
    ds_write_b64 v0, v[196:197] offset:7840
    v_accvgpr_read_b32 v194, a146
    v_accvgpr_read_b32 v195, a147
    v_accvgpr_read_b32 v198, a150
    v_accvgpr_read_b32 v199, a151
    v_accvgpr_read_b32 v202, a154
    v_accvgpr_read_b32 v203, a155
    v_accvgpr_read_b32 v206, a158
    v_accvgpr_read_b32 v207, a159
    v_mul_f32 v194, v106, v194
    v_mul_f32 v195, v107, v195
    v_mul_f32 v198, v106, v198
    v_mul_f32 v199, v107, v199
    v_mul_f32 v202, v106, v202
    v_mul_f32 v203, v107, v203
    v_mul_f32 v206, v106, v206
    v_mul_f32 v207, v107, v207
    v_cvt_pk_bf16_f32 v194, v194, v198
    v_cvt_pk_bf16_f32 v198, v195, v199
    v_cvt_pk_bf16_f32 v195, v202, v206
    v_cvt_pk_bf16_f32 v199, v203, v207
    ds_write_b64 v0, v[194:195] offset:8000
    ds_write_b64 v0, v[198:199] offset:8160
    ds_read_b64_tr_b16 v[128:129], v88 offset:7680
    ds_read_b64_tr_b16 v[130:131], v88 offset:7712
    ds_read_b64_tr_b16 v[132:133], v88 offset:8960
    ds_read_b64_tr_b16 v[134:135], v88 offset:8992
    v_accvgpr_read_b32 v176, a160
    v_accvgpr_read_b32 v177, a161
    v_accvgpr_read_b32 v180, a164
    v_accvgpr_read_b32 v181, a165
    v_accvgpr_read_b32 v184, a168
    v_accvgpr_read_b32 v185, a169
    v_accvgpr_read_b32 v188, a172
    v_accvgpr_read_b32 v189, a173
    v_mul_f32 v176, v104, v176
    v_mul_f32 v177, v105, v177
    v_mul_f32 v180, v104, v180
    v_mul_f32 v181, v105, v181
    v_mul_f32 v184, v104, v184
    v_mul_f32 v185, v105, v185
    v_mul_f32 v188, v104, v188
    v_mul_f32 v189, v105, v189
    s_waitcnt lgkmcnt(2)
    buffer_store_dwordx4 v[128:131], v89, s[24:27], s77 offen offset:0 nt
    s_waitcnt lgkmcnt(0)
    buffer_store_dwordx4 v[132:135], v89, s[24:27], s77 offen offset:3072 nt
    v_cvt_pk_bf16_f32 v176, v176, v180
    v_cvt_pk_bf16_f32 v180, v177, v181
    v_cvt_pk_bf16_f32 v177, v184, v188
    v_cvt_pk_bf16_f32 v181, v185, v189
    ds_write_b64 v0, v[176:177] offset:10240
    ds_write_b64 v0, v[180:181] offset:10400
    v_accvgpr_read_b32 v178, a162
    v_accvgpr_read_b32 v179, a163
    v_accvgpr_read_b32 v182, a166
    v_accvgpr_read_b32 v183, a167
    v_accvgpr_read_b32 v186, a170
    v_accvgpr_read_b32 v187, a171
    v_accvgpr_read_b32 v190, a174
    v_accvgpr_read_b32 v191, a175
    v_mul_f32 v178, v106, v178
    v_mul_f32 v179, v107, v179
    v_mul_f32 v182, v106, v182
    v_mul_f32 v183, v107, v183
    v_mul_f32 v186, v106, v186
    v_mul_f32 v187, v107, v187
    v_mul_f32 v190, v106, v190
    v_mul_f32 v191, v107, v191
    v_cvt_pk_bf16_f32 v178, v178, v182
    v_cvt_pk_bf16_f32 v182, v179, v183
    v_cvt_pk_bf16_f32 v179, v186, v190
    v_cvt_pk_bf16_f32 v183, v187, v191
    ds_write_b64 v0, v[178:179] offset:10560
    ds_write_b64 v0, v[182:183] offset:10720
    ds_read_b64_tr_b16 v[144:145], v88 offset:10240
    ds_read_b64_tr_b16 v[146:147], v88 offset:10272
    ds_read_b64_tr_b16 v[148:149], v88 offset:11520
    ds_read_b64_tr_b16 v[150:151], v88 offset:11552
    v_accvgpr_read_b32 v192, a176
    v_accvgpr_read_b32 v193, a177
    v_accvgpr_read_b32 v196, a180
    v_accvgpr_read_b32 v197, a181
    v_accvgpr_read_b32 v200, a184
    v_accvgpr_read_b32 v201, a185
    v_accvgpr_read_b32 v204, a188
    v_accvgpr_read_b32 v205, a189
    v_mul_f32 v192, v104, v192
    v_mul_f32 v193, v105, v193
    v_mul_f32 v196, v104, v196
    v_mul_f32 v197, v105, v197
    v_mul_f32 v200, v104, v200
    v_mul_f32 v201, v105, v201
    v_mul_f32 v204, v104, v204
    v_mul_f32 v205, v105, v205
    s_waitcnt lgkmcnt(2)
    buffer_store_dwordx4 v[144:147], v89, s[24:27], s77 offen offset:128 nt
    s_waitcnt lgkmcnt(0)
    buffer_store_dwordx4 v[148:151], v89, s[24:27], s77 offen offset:3200 nt
    v_cvt_pk_bf16_f32 v192, v192, v196
    v_cvt_pk_bf16_f32 v196, v193, v197
    v_cvt_pk_bf16_f32 v193, v200, v204
    v_cvt_pk_bf16_f32 v197, v201, v205
    ds_write_b64 v0, v[192:193] offset:12800
    ds_write_b64 v0, v[196:197] offset:12960
    v_accvgpr_read_b32 v194, a178
    v_accvgpr_read_b32 v195, a179
    v_accvgpr_read_b32 v198, a182
    v_accvgpr_read_b32 v199, a183
    v_accvgpr_read_b32 v202, a186
    v_accvgpr_read_b32 v203, a187
    v_accvgpr_read_b32 v206, a190
    v_accvgpr_read_b32 v207, a191
    v_mul_f32 v194, v106, v194
    v_mul_f32 v195, v107, v195
    v_mul_f32 v198, v106, v198
    v_mul_f32 v199, v107, v199
    v_mul_f32 v202, v106, v202
    v_mul_f32 v203, v107, v203
    v_mul_f32 v206, v106, v206
    v_mul_f32 v207, v107, v207
    v_cvt_pk_bf16_f32 v194, v194, v198
    v_cvt_pk_bf16_f32 v198, v195, v199
    v_cvt_pk_bf16_f32 v195, v202, v206
    v_cvt_pk_bf16_f32 v199, v203, v207
    ds_write_b64 v0, v[194:195] offset:13120
    ds_write_b64 v0, v[198:199] offset:13280
    ds_read_b64_tr_b16 v[160:161], v88 offset:12800
    ds_read_b64_tr_b16 v[162:163], v88 offset:12832
    ds_read_b64_tr_b16 v[164:165], v88 offset:14080
    ds_read_b64_tr_b16 v[166:167], v88 offset:14112
    s_waitcnt lgkmcnt(2)
    buffer_store_dwordx4 v[160:163], v89, s[24:27], s77 offen offset:256 nt
    s_waitcnt lgkmcnt(0)
    buffer_store_dwordx4 v[164:167], v89, s[24:27], s77 offen offset:3328 nt
    s_branch L_fin
.section .rodata,"a"
.p2align 6
.amdhsa_kernel standalone__gqa_softmax__near_ridge_kernel
  .amdhsa_next_free_vgpr 512
  .amdhsa_next_free_sgpr 102
  .amdhsa_accum_offset 256
  .amdhsa_group_segment_fixed_size 0
  .amdhsa_kernarg_size 48
  .amdhsa_user_sgpr_count 2
  .amdhsa_user_sgpr_kernarg_segment_ptr 1
  .amdhsa_system_sgpr_workgroup_id_x 1
.end_amdhsa_kernel
```
